```python
import torch

def _softmax(x, axis=-1):
    return torch.softmax(x, dim=axis)
def _gelu(x):
    return torch.nn.functional.gelu(x, approximate="tanh")
def _silu(x):
    return torch.nn.functional.silu(x)
def _sigmoid(x):
    return torch.sigmoid(x)
def _layernorm(x, axis=-1, eps=1e-5):
    m = x.mean(dim=axis, keepdim=True)
    v = x.var(dim=axis, keepdim=True, unbiased=False)
    return (x - m) / torch.sqrt(v + eps)
def _scatter_add(tgt, idx, src, axis=0):
    return tgt.clone().index_add_(axis, idx, src)
def _segment_sum(src, seg, n):
    out = torch.zeros((n,) + src.shape[1:], dtype=src.dtype)
    return out.index_add_(0, seg, src)
def _pad(x, pw):
    flat = tuple(v for pair in reversed(pw) for v in pair)
    return torch.nn.functional.pad(x, flat)

kernel_name = 'sequential_preLN__grouped_kv_mqa__glu_gated_glu__prompt'

def setup_inputs():

    _w = (lambda a: (lambda t: t.to(torch.bfloat16) if t.is_floating_point() else t)(torch.as_tensor(a)))
    def _A_setup():
        B, S, D, H = 1, 2048, 1024, 32
        Dh = D // H
        return {
            "x": _w((lambda *s: torch.randn(*s, dtype=torch.bfloat16) * 0.05)(B, S, D)),
            "wq": _w((lambda *s: torch.randn(*s, dtype=torch.bfloat16) * 0.05)(D, H * Dh)),
            "wk": _w((lambda *s: torch.randn(*s, dtype=torch.bfloat16) * 0.05)(D, Dh)),
            "wv": _w((lambda *s: torch.randn(*s, dtype=torch.bfloat16) * 0.05)(D, Dh)),
            "wo": _w((lambda *s: torch.randn(*s, dtype=torch.bfloat16) * 0.05)(H * Dh, D)),
        }
    _A_in = _A_setup()

    def _B_setup():
        B, S, D, F = 1, 2048, 1024, 3584
        return {
            "x": _w((lambda *s: torch.randn(*s, dtype=torch.bfloat16) * 0.05)(B, S, D)),
            "w_gate": _w((lambda *s: torch.randn(*s, dtype=torch.bfloat16) * 0.05)(D, F)),
            "w_up": _w((lambda *s: torch.randn(*s, dtype=torch.bfloat16) * 0.05)(D, F)),
            "w_down": _w((lambda *s: torch.randn(*s, dtype=torch.bfloat16) * 0.05)(F, D)),
        }
    _B_in = _B_setup()

    return {
        "A_x": _A_in["x"],
        "A_wq": _A_in["wq"],
        "A_wk": _A_in["wk"],
        "A_wv": _A_in["wv"],
        "A_wo": _A_in["wo"],
        "B_x": _B_in["x"],
        "B_w_gate": _B_in["w_gate"],
        "B_w_up": _B_in["w_up"],
        "B_w_down": _B_in["w_down"],
    }

def reference(A_x, A_wq, A_wk, A_wv, A_wo, B_x, B_w_gate, B_w_up, B_w_down):
    def _A_ref(x, wq, wk, wv, wo):
        B, S, D = x.shape
        H = 32
        Dh = D // H
        q = (lambda x, *d: x.permute(*d))((x @ wq).reshape(B, S, H, Dh), 0, 2, 1, 3)
        k = x @ wk
        v = x @ wv
        scores = torch.einsum("bhqd,bkd->bhqk", q, k) * (Dh ** -0.5)
        p = _softmax(scores, axis=-1)
        o = torch.einsum("bhqk,bkd->bhqd", p, v)
        return (lambda x, *d: x.permute(*d))(o, 0, 2, 1, 3).reshape(B, S, H * Dh) @ wo

    def _B_ref(x, w_gate, w_up, w_down):
        g = torch.einsum("bsd,df->bsf", x, w_gate)
        u = torch.einsum("bsd,df->bsf", x, w_up)
        h = _sigmoid(g) * u
        return torch.einsum("bsf,fd->bsd", h, w_down)

    x = A_x
    h = x + _A_ref(_layernorm(x, axis=-1), A_wq, A_wk, A_wv, A_wo)
    h2 = h + _B_ref(_layernorm(h, axis=-1), B_w_gate, B_w_up, B_w_down)
    return h2
```

```asm
; @launch kernel=attn_kernel grid=(256,1,1) block=(512,1,1) lds=163840
; @launch kernel=ffn_kernel grid=(256,1,1) block=(256,1,1) lds=163840
.amdgcn_target "amdgcn-amd-amdhsa--gfx950"
.text
.globl attn_kernel
.p2align 8
.type attn_kernel,@function
attn_kernel:
    s_cmp_ge_u32 s2, 256
    s_cbranch_scc1 L_end_attn_kernel
    s_load_dwordx2 s[4:5], s[0:1], 0
    s_load_dwordx2 s[8:9], s[0:1], 8
    s_load_dwordx4 s[24:27], s[0:1], 16
    s_load_dwordx2 s[16:17], s[0:1], 88
    s_load_dwordx2 s[30:31], s[0:1], 80
    s_lshl_b32 s36, s2, 7
    s_and_b32 s36, s36, 0x7c00
    v_lshl_add_u32 v6, v0, 1, s36
    v_and_b32 v6, -4, v6
    s_getpc_b64 s[20:21]
    global_load_dword v253, v6, s[20:21]
    v_lshrrev_b32 v7, 6, v0
    v_and_b32 v1, 63, v0
    v_readfirstlane_b32 s32, v7
    s_lshr_b32 s36, s2, 3
    s_and_b32 s34, s36, 3
    s_lshr_b32 s33, s36, 2
    s_and_b32 s36, s2, 1
    s_lshl_b32 s36, s36, 2
    s_add_u32 s34, s34, s36
    s_and_b32 s36, s2, 6
    s_lshl_b32 s36, s36, 2
    s_add_u32 s33, s33, s36
    v_lshrrev_b32 v2, 4, v1
    v_and_b32 v5, 15, v1
    v_lshlrev_b32 v9, 4, v1
    s_and_b32 s55, s32, 1
    s_bfe_u32 s56, s32, 0x10001
    s_cmp_ge_u32 s32, 4
    s_cbranch_scc1 L_f_help
    s_and_b32 s36, s34, 3
    s_lshl_b32 s37, s33, 2
    s_add_u32 s36, s36, s37
    s_lshl_b32 s36, s36, 15
    s_lshl_b32 s37, s32, 9
    s_add_u32 s36, s36, s37
    v_lshrrev_b32 v6, 3, v1
    v_lshlrev_b32 v6, 11, v6
    v_and_b32 v7, 7, v1
    v_xor_b32 v7, v7, v2
    v_lshl_add_u32 v6, v7, 4, v6
    v_add_u32 v244, s36, v6
    v_xor_b32 v7, 16448, v244
    s_lshl_b32 s49, s32, 13
    v_and_b32 v6, 32, v1
    v_xor_b32 v6, v6, v9
    s_lshl_b32 s39, s32, 14
    v_add_u32 v245, s39, v6
    s_lshr_b32 s36, s2, 3
    s_lshl_b32 s36, s36, 11
    v_lshlrev_b32 v6, 3, v0
    s_bitcmp1_b32 s34, 2
    s_waitcnt lgkmcnt(0)
    s_cselect_b32 s12, s26, s24
    s_cselect_b32 s13, s27, s25
    s_mov_b32 s14, 65536
    s_mov_b32 s15, 0x00020000
    s_mov_b32 s6, 4194304
    s_mov_b32 s7, 0x00020000
    buffer_load_dword v253, v6, s[12:15], s36 offen
    s_add_u32 m0, s49, 0
    s_nop 0
    buffer_load_dwordx4 v244, s[4:7], 0 offen offset:0 lds
    s_add_u32 m0, s49, 1024
    s_nop 0
    buffer_load_dwordx4 v7, s[4:7], 0 offen offset:0 lds
    s_add_u32 m0, s49, 1920
    s_nop 0
    buffer_load_dwordx4 v244, s[4:7], 0 offen offset:128 lds
    s_add_u32 m0, s49, 2944
    s_nop 0
    buffer_load_dwordx4 v7, s[4:7], 0 offen offset:128 lds
    s_add_u32 m0, s49, 3840
    s_nop 0
    buffer_load_dwordx4 v244, s[4:7], 0 offen offset:256 lds
    s_add_u32 m0, s49, 4864
    s_nop 0
    buffer_load_dwordx4 v7, s[4:7], 0 offen offset:256 lds
    s_add_u32 m0, s49, 5760
    s_nop 0
    buffer_load_dwordx4 v244, s[4:7], 0 offen offset:384 lds
    s_add_u32 m0, s49, 6784
    s_nop 0
    buffer_load_dwordx4 v7, s[4:7], 0 offen offset:384 lds
    s_branch L_f_comp
L_f_help:
    s_and_b32 s32, s32, 3
    v_lshrrev_b32 v6, 3, v1
    s_lshl_b32 s36, s55, 2
    v_add_u32 v7, s36, v2
    v_and_b32 v8, 7, v1
    v_xor_b32 v7, v7, v8
    s_lshl_b32 s36, s33, 6
    s_lshl_b32 s37, s32, 3
    s_add_u32 s36, s36, s37
    v_add_u32 v6, s36, v6
    v_lshlrev_b32 v6, 11, v6
    v_lshl_add_u32 v12, v7, 4, v6
    v_add_u32 v13, 0x10000, v12
    v_lshlrev_b32 v7, 1, v2
    v_xor_b32 v7, v7, v5
    s_lshl_b32 s36, s55, 3
    v_xor_b32 v7, s36, v7
    s_lshl_b32 s57, s55, 1
    s_add_u32 s57, s57, s56
    s_lshl_b32 s36, s57, 13
    s_lshl_b32 s37, s34, 8
    s_add_u32 s36, s36, s37
    v_lshlrev_b32 v6, 11, v2
    v_add_u32 v6, s36, v6
    v_lshl_add_u32 v14, v7, 4, v6
    v_add_u32 v15, 32768, v14
    v_add_u32 v16, 65536, v14
    v_add_u32 v17, 98304, v14
    s_sub_u32 s57, s57, s32
    s_lshl_b32 s57, s57, 10
    s_add_u32 s57, s57, 8192
    s_lshl_b32 s39, s32, 10
    s_mov_b32 s48, 12
    s_and_b32 s36, s33, 7
    s_lshl_b32 s49, s36, 8
    s_lshl_b32 s54, s36, 18
    s_waitcnt lgkmcnt(0)
    s_mov_b32 s6, 4194304
    s_mov_b32 s7, 0x00020000
    s_mov_b32 s10, 2097152
    s_mov_b32 s11, 0x00020000
    s_load_dwordx2 s[20:21], s[0:1], 32
    s_load_dwordx4 s[24:27], s[0:1], 48
    s_load_dwordx2 s[28:29], s[0:1], 64
    s_branch L_f_setup
L_f_comp:
    v_bfe_u32 v3, v1, 2, 2
    v_and_b32 v4, 3, v1
    v_and_b32 v8, 1, v2
    s_lshl_b32 s36, s32, 14
    s_add_u32 s36, s36, 98304
    v_lshlrev_b32 v6, 5, v8
    v_lshl_add_u32 v6, v4, 3, v6
    v_lshl_add_u32 v6, v3, 6, v6
    v_lshl_add_u32 v6, v2, 9, v6
    v_add_u32 v246, s36, v6
    v_xor_b32 v247, 32, v246
    v_mov_b32 v120, 0x3f803f80
    v_mov_b32 v121, 0x3f803f80
    v_mov_b32 v122, 0x3f803f80
    v_mov_b32 v123, 0x3f803f80
    s_mov_b32 s18, 75497472
    s_mov_b32 s19, 0x00020000
    s_add_u32 s72, s16, 4194304
    s_addc_u32 s73, s17, 0
    s_mov_b32 s74, 262144
    s_mov_b32 s75, 0x00020000
    s_lshl_b32 s36, s56, 10
    s_lshl_b32 s37, s55, 3
    s_add_u32 s36, s36, s37
    s_add_u32 s36, s36, 98304
    v_add_u32 v248, s36, v9
    v_lshlrev_b32 v249, 3, v5
    v_add_u32 v249, 102400, v249
    s_bfe_u32 s36, s34, 0x10001
    s_lshl_b32 s81, s33, 1
    s_add_u32 s81, s81, s36
    s_lshl_b32 s81, s81, 12
    s_and_b32 s37, s34, 1
    s_bitcmp1_b32 s34, 2
    s_cbranch_scc1 L_f_av
    s_lshl_b32 s37, s37, 8
    s_add_u32 s81, s81, s37
    s_lshl_b32 s36, s32, 2
    s_add_u32 s36, s36, 106496
    v_add_u32 v250, s36, v9
    v_add_u32 v251, 2, v250
    v_lshlrev_b32 v6, 10, v8
    v_lshrrev_b32 v7, 1, v2
    v_lshl_add_u32 v6, v7, 9, v6
    v_lshl_add_u32 v252, v5, 4, v6
    s_branch L_f_ax
L_f_av:
    s_lshl_b32 s37, s37, 10
    s_add_u32 s81, s81, s37
    s_add_u32 s81, s81, 2048
    v_lshlrev_b32 v6, 7, v8
    v_lshrrev_b32 v7, 1, v2
    v_lshl_add_u32 v6, v7, 6, v6
    v_bfe_u32 v7, v1, 3, 1
    v_lshl_add_u32 v6, v7, 9, v6
    v_and_b32 v7, 7, v1
    v_lshl_add_u32 v6, v7, 1, v6
    s_lshl_b32 s36, s56, 8
    s_lshl_b32 s37, s55, 5
    s_add_u32 s36, s36, s37
    s_add_u32 s36, s36, 106496
    v_add_u32 v250, s36, v6
    v_add_u32 v251, 16, v250
    v_mov_b32 v252, v9
L_f_ax:
    v_lshrrev_b32 v6, 1, v5
    v_xor_b32 v6, v6, v2
    v_lshlrev_b32 v6, 4, v6
    v_lshl_add_u32 v124, v5, 7, v6
    v_add_u32 v244, s49, v124
    v_xor_b32 v125, 64, v124
    v_lshlrev_b32 v6, 2, v8
    v_xor_b32 v6, v6, v3
    v_lshlrev_b32 v6, 5, v6
    v_lshl_add_u32 v6, v4, 3, v6
    v_lshl_add_u32 v6, v3, 8, v6
    v_lshl_add_u32 v6, v2, 11, v6
    s_lshl_b32 s36, s32, 6
    s_add_u32 s36, s36, 8192
    v_xor_b32 v126, s36, v6
    v_xor_b32 v127, 32, v126
    s_lshl_b32 s36, s56, 7
    v_xor_b32 v132, s36, v6
    v_xor_b32 v133, 32, v132
    v_xor_b32 v134, 64, v132
    v_xor_b32 v135, 96, v132
    v_mov_b32 v128, v124
    v_mov_b32 v129, v125
    v_mov_b32 v130, v126
    v_mov_b32 v131, v127
    v_mov_b32 v136, v132
    v_mov_b32 v137, v133
    v_mov_b32 v138, v134
    v_mov_b32 v139, v135
    v_mov_b64 v[28:29], 0
    v_mov_b64 v[30:31], 0
    v_mov_b64 v[32:33], 0
    v_mov_b64 v[34:35], 0
    v_mov_b64 v[36:37], 0
    v_mov_b64 v[38:39], 0
    v_mov_b64 v[40:41], 0
    v_mov_b64 v[42:43], 0
    v_mov_b64 v[44:45], 0
    v_mov_b64 v[46:47], 0
    v_mov_b64 v[48:49], 0
    v_mov_b64 v[50:51], 0
    v_mov_b64 v[52:53], 0
    v_mov_b64 v[54:55], 0
    v_mov_b64 v[56:57], 0
    v_mov_b64 v[58:59], 0
    v_mov_b64 v[60:61], 0
    v_mov_b64 v[62:63], 0
    v_mov_b64 v[64:65], 0
    v_mov_b64 v[66:67], 0
    v_mov_b64 v[68:69], 0
    v_mov_b64 v[70:71], 0
    v_mov_b64 v[72:73], 0
    v_mov_b64 v[74:75], 0
    v_mov_b64 v[76:77], 0
    v_mov_b64 v[78:79], 0
    v_mov_b64 v[80:81], 0
    v_mov_b64 v[82:83], 0
    v_mov_b64 v[84:85], 0
    v_mov_b64 v[86:87], 0
    v_mov_b64 v[88:89], 0
    v_mov_b64 v[90:91], 0
    v_mov_b64 v[92:93], 0
    v_mov_b64 v[94:95], 0
    v_mov_b64 v[96:97], 0
    v_mov_b64 v[98:99], 0
    v_mov_b64 v[100:101], 0
    v_mov_b64 v[102:103], 0
    v_mov_b64 v[104:105], 0
    v_mov_b64 v[106:107], 0
    v_mov_b64 v[108:109], 0
    v_mov_b64 v[110:111], 0
    v_mov_b64 v[112:113], 0
    v_mov_b64 v[114:115], 0
    v_and_b32 v6, 7, v1
    v_cmp_eq_u32 vcc, 0, v6
    v_mov_b32 v11, 0xdddd
    v_add_u32 v10, 98304, v9
    v_cndmask_b32 v116, 0, v120, vcc
    v_cndmask_b32 v117, 0, v120, vcc
    v_cmp_eq_u32 vcc, 4, v6
    v_and_b32 v6, 1, v5
    v_and_b32 v7, 2, v5
    v_cndmask_b32 v118, 0, v120, vcc
    v_cndmask_b32 v119, 0, v120, vcc
    v_cmp_eq_u32 s[66:67], 1, v6
    v_cmp_eq_u32 s[68:69], 2, v7
    v_cmp_eq_u32 s[82:83], v3, v2
    s_lshl_b32 s58, s33, 9
    s_add_u32 s58, s58, 56623104
    s_lshr_b32 s62, s34, 2
    s_lshl_b32 s62, s62, 5
    s_add_u32 s62, s62, s33
    s_lshl_b32 s62, s62, 9
    s_add_u32 s62, s62, 57671680
    v_lshrrev_b32 v6, 1, v2
    v_lshl_add_u32 v6, v8, 1, v6
    v_lshlrev_b32 v7, 4, v5
    v_lshl_add_u32 v254, v6, 8, v7
    v_lshlrev_b32 v7, 11, v5
    v_lshl_add_u32 v6, v6, 4, v7
    s_lshl_b32 s36, s33, 1
    s_add_u32 s36, s36, s55
    s_lshl_b32 s36, s36, 16
    s_lshl_b32 s37, s34, 1
    s_add_u32 s37, s37, s56
    s_lshl_b32 s37, s37, 7
    s_add_u32 s36, s36, s37
    v_add_u32 v255, s36, v6
    s_lshl_b32 s36, s33, 3
    s_add_u32 s36, s36, s34
    s_lshl_b32 s36, s36, 14
    s_lshl_b32 s37, s32, 12
    s_add_u32 s47, s36, s37
    s_add_u32 s47, s47, 5242880
    s_lshl_b32 s37, s56, 13
    s_add_u32 s36, s36, s37
    s_lshl_b32 s37, s55, 11
    s_add_u32 s36, s36, s37
    s_add_u32 s60, s36, 9437184
    s_add_u32 s61, s36, 9441280
    s_mov_b32 s38, 0
    s_mov_b32 s48, 7
    s_cmp_eq_u32 s32, 0
    s_cselect_b32 s80, 7, -1
    s_add_u32 m0, s39, 98304
    s_mov_b32 s54, 0
    buffer_load_dwordx4 v245, s[12:15], s54 offen offset:0 lds
    buffer_load_dwordx4 v245, s[12:15], s54 offen offset:1024 lds
    buffer_load_dwordx4 v245, s[12:15], s54 offen offset:2048 lds
    buffer_load_dwordx4 v245, s[12:15], s54 offen offset:3072 lds
    s_add_u32 m0, s39, 102400
    s_mov_b32 s54, 4096
    buffer_load_dwordx4 v245, s[12:15], s54 offen offset:0 lds
    buffer_load_dwordx4 v245, s[12:15], s54 offen offset:1024 lds
    buffer_load_dwordx4 v245, s[12:15], s54 offen offset:2048 lds
    buffer_load_dwordx4 v245, s[12:15], s54 offen offset:3072 lds
    v_xor_b32 v6, 64, v244
    s_waitcnt vmcnt(8)
    ds_read_b128 v[140:143], v244 offset:0
    ds_read_b128 v[144:147], v6 offset:0
    ds_read_b128 v[148:151], v244 offset:2048
    ds_read_b128 v[152:155], v6 offset:2048
    ds_read_b128 v[156:159], v244 offset:4096
    ds_read_b128 v[160:163], v6 offset:4096
    ds_read_b128 v[164:167], v244 offset:6144
    ds_read_b128 v[168:171], v6 offset:6144
    s_add_u32 m0, s39, 106496
    s_mov_b32 s54, 8192
    buffer_load_dwordx4 v245, s[12:15], s54 offen offset:0 lds
    buffer_load_dwordx4 v245, s[12:15], s54 offen offset:1024 lds
    buffer_load_dwordx4 v245, s[12:15], s54 offen offset:2048 lds
    buffer_load_dwordx4 v245, s[12:15], s54 offen offset:3072 lds
    s_waitcnt lgkmcnt(0)
    v_mfma_f32_16x16x32_bf16 v[240:243], v[140:143], v[140:143], 0
    v_mfma_f32_16x16x32_bf16 v[236:239], v[120:123], v[140:143], 0
    v_mfma_f32_16x16x32_bf16 v[240:243], v[144:147], v[144:147], v[240:243]
    v_mfma_f32_16x16x32_bf16 v[236:239], v[120:123], v[144:147], v[236:239]
    v_mfma_f32_16x16x32_bf16 v[240:243], v[148:151], v[148:151], v[240:243]
    v_mfma_f32_16x16x32_bf16 v[236:239], v[120:123], v[148:151], v[236:239]
    v_mfma_f32_16x16x32_bf16 v[240:243], v[152:155], v[152:155], v[240:243]
    v_mfma_f32_16x16x32_bf16 v[236:239], v[120:123], v[152:155], v[236:239]
    v_mfma_f32_16x16x32_bf16 v[240:243], v[156:159], v[156:159], v[240:243]
    v_mfma_f32_16x16x32_bf16 v[236:239], v[120:123], v[156:159], v[236:239]
    v_mfma_f32_16x16x32_bf16 v[240:243], v[160:163], v[160:163], v[240:243]
    v_mfma_f32_16x16x32_bf16 v[236:239], v[120:123], v[160:163], v[236:239]
    v_mfma_f32_16x16x32_bf16 v[240:243], v[164:167], v[164:167], v[240:243]
    v_mfma_f32_16x16x32_bf16 v[236:239], v[120:123], v[164:167], v[236:239]
    v_mfma_f32_16x16x32_bf16 v[240:243], v[168:171], v[168:171], v[240:243]
    v_mfma_f32_16x16x32_bf16 v[236:239], v[120:123], v[168:171], v[236:239]
    s_waitcnt vmcnt(8)
    ds_read_b64_tr_b16 v[172:173], v246 offset:0
    ds_read_b64_tr_b16 v[174:175], v246 offset:256
    ds_read_b64_tr_b16 v[176:177], v247 offset:0
    ds_read_b64_tr_b16 v[178:179], v247 offset:256
    ds_read_b64_tr_b16 v[180:181], v246 offset:2048
    ds_read_b64_tr_b16 v[182:183], v246 offset:2304
    ds_read_b64_tr_b16 v[184:185], v247 offset:2048
    ds_read_b64_tr_b16 v[186:187], v247 offset:2304
    s_add_u32 m0, s39, 110592
    s_mov_b32 s54, 12288
    buffer_load_dwordx4 v245, s[12:15], s54 offen offset:0 lds
    buffer_load_dwordx4 v245, s[12:15], s54 offen offset:1024 lds
    buffer_load_dwordx4 v245, s[12:15], s54 offen offset:2048 lds
    buffer_load_dwordx4 v245, s[12:15], s54 offen offset:3072 lds
    s_barrier
    s_add_u32 s36, s39, 98304
    v_add_u32 v245, s36, v9
    v_lshl_add_u32 v244, v5, 3, s36
    v_cndmask_b32 v6, v240, v241, s[66:67]
    v_cndmask_b32 v7, v242, v243, s[66:67]
    v_cndmask_b32 v237, v6, v7, s[68:69]
    s_waitcnt vmcnt(8) lgkmcnt(0)
    v_mfma_f32_16x16x32_bf16 v[12:15], v[172:175], v[140:143], 0
    ds_read_b64_tr_b16 v[188:189], v246 offset:4096
    ds_read_b64_tr_b16 v[190:191], v246 offset:4352
    v_mfma_f32_16x16x32_bf16 v[20:23], v[172:175], v[120:123], 0
    ds_read_b64_tr_b16 v[192:193], v247 offset:4096
    ds_read_b64_tr_b16 v[194:195], v247 offset:4352
    v_mfma_f32_16x16x32_bf16 v[16:19], v[176:179], v[140:143], 0
    ds_read_b64_tr_b16 v[196:197], v246 offset:6144
    v_mfma_f32_16x16x32_bf16 v[24:27], v[176:179], v[120:123], 0
    ds_read_b64_tr_b16 v[198:199], v246 offset:6400
    ds_read_b64_tr_b16 v[200:201], v247 offset:6144
    v_mfma_f32_16x16x32_bf16 v[12:15], v[180:183], v[144:147], v[12:15]
    ds_read_b64_tr_b16 v[202:203], v247 offset:6400
    v_mfma_f32_16x16x32_bf16 v[20:23], v[180:183], v[120:123], v[20:23]
    v_mfma_f32_16x16x32_bf16 v[16:19], v[184:187], v[144:147], v[16:19]
    v_mfma_f32_16x16x32_bf16 v[24:27], v[184:187], v[120:123], v[24:27]
    s_waitcnt vmcnt(4) lgkmcnt(0)
    v_mfma_f32_16x16x32_bf16 v[12:15], v[188:191], v[148:151], v[12:15]
    ds_read_b64_tr_b16 v[204:205], v246 offset:8192
    ds_read_b64_tr_b16 v[206:207], v246 offset:8448
    v_mfma_f32_16x16x32_bf16 v[20:23], v[188:191], v[120:123], v[20:23]
    ds_read_b64_tr_b16 v[208:209], v247 offset:8192
    ds_read_b64_tr_b16 v[210:211], v247 offset:8448
    v_mfma_f32_16x16x32_bf16 v[16:19], v[192:195], v[148:151], v[16:19]
    ds_read_b64_tr_b16 v[212:213], v246 offset:10240
    v_mfma_f32_16x16x32_bf16 v[24:27], v[192:195], v[120:123], v[24:27]
    ds_read_b64_tr_b16 v[214:215], v246 offset:10496
    ds_read_b64_tr_b16 v[216:217], v247 offset:10240
    v_mfma_f32_16x16x32_bf16 v[12:15], v[196:199], v[152:155], v[12:15]
    ds_read_b64_tr_b16 v[218:219], v247 offset:10496
    v_mfma_f32_16x16x32_bf16 v[20:23], v[196:199], v[120:123], v[20:23]
    v_mfma_f32_16x16x32_bf16 v[16:19], v[200:203], v[152:155], v[16:19]
    v_mfma_f32_16x16x32_bf16 v[24:27], v[200:203], v[120:123], v[24:27]
    s_waitcnt vmcnt(0) lgkmcnt(0)
    v_mfma_f32_16x16x32_bf16 v[12:15], v[204:207], v[156:159], v[12:15]
    ds_read_b64_tr_b16 v[220:221], v246 offset:12288
    ds_read_b64_tr_b16 v[222:223], v246 offset:12544
    v_mfma_f32_16x16x32_bf16 v[20:23], v[204:207], v[120:123], v[20:23]
    ds_read_b64_tr_b16 v[224:225], v247 offset:12288
    ds_read_b64_tr_b16 v[226:227], v247 offset:12544
    v_mfma_f32_16x16x32_bf16 v[16:19], v[208:211], v[156:159], v[16:19]
    ds_read_b64_tr_b16 v[228:229], v246 offset:14336
    v_mfma_f32_16x16x32_bf16 v[24:27], v[208:211], v[120:123], v[24:27]
    ds_read_b64_tr_b16 v[230:231], v246 offset:14592
    ds_read_b64_tr_b16 v[232:233], v247 offset:14336
    v_mfma_f32_16x16x32_bf16 v[12:15], v[212:215], v[160:163], v[12:15]
    ds_read_b64_tr_b16 v[234:235], v247 offset:14592
    v_mfma_f32_16x16x32_bf16 v[20:23], v[212:215], v[120:123], v[20:23]
    v_mfma_f32_16x16x32_bf16 v[16:19], v[216:219], v[160:163], v[16:19]
    v_mfma_f32_16x16x32_bf16 v[24:27], v[216:219], v[120:123], v[24:27]
    s_waitcnt lgkmcnt(0)
    v_mfma_f32_16x16x32_bf16 v[12:15], v[220:223], v[164:167], v[12:15]
    v_mfma_f32_16x16x32_bf16 v[20:23], v[220:223], v[120:123], v[20:23]
    v_mfma_f32_16x16x32_bf16 v[16:19], v[224:227], v[164:167], v[16:19]
    v_mfma_f32_16x16x32_bf16 v[24:27], v[224:227], v[120:123], v[24:27]
    v_mfma_f32_16x16x32_bf16 v[12:15], v[228:231], v[168:171], v[12:15]
    v_mfma_f32_16x16x32_bf16 v[20:23], v[228:231], v[120:123], v[20:23]
    v_mfma_f32_16x16x32_bf16 v[16:19], v[232:235], v[168:171], v[16:19]
    v_mfma_f32_16x16x32_bf16 v[24:27], v[232:235], v[120:123], v[24:27]
    s_mov_b64 exec, s[82:83]
    ds_write_b64 v244, v[236:237] offset:4096
    s_mov_b64 exec, -1
    s_nop 3
    ds_write_b128 v245, v[12:15] offset:0
    ds_write_b128 v245, v[16:19] offset:1024
    ds_write_b128 v245, v[20:23] offset:2048
    ds_write_b128 v245, v[24:27] offset:3072
    s_waitcnt lgkmcnt(0)
    s_branch L_isl0_over
.p2align 12
.fill 256, 4, 0xbf800000
L_isl0:
    s_branch L_f_back
L_isl0_over:
    s_barrier
    ds_read_b64 v[188:189], v249 offset:0
    ds_read_b64 v[190:191], v249 offset:16384
    ds_read_b64 v[192:193], v249 offset:32768
    ds_read_b64 v[194:195], v249 offset:49152
    ds_read_b64 v[196:197], v248 offset:0
    ds_read_b64 v[204:205], v248 offset:2048
    ds_read_b64 v[198:199], v248 offset:16384
    ds_read_b64 v[206:207], v248 offset:18432
    ds_read_b64 v[200:201], v248 offset:32768
    ds_read_b64 v[208:209], v248 offset:34816
    ds_read_b64 v[202:203], v248 offset:49152
    ds_read_b64 v[210:211], v248 offset:51200
    ds_read_b64_tr_b16 v[156:157], v130 offset:0
    ds_read_b64_tr_b16 v[158:159], v130 offset:1024
    ds_read_b64_tr_b16 v[160:161], v131 offset:0
    s_waitcnt lgkmcnt(11)
    v_add_f32 v188, v188, v190
    ds_read_b64_tr_b16 v[162:163], v131 offset:1024
    v_add_f32 v189, v189, v191
    ds_read_b128 v[140:143], v128 offset:0
    v_add_f32 v192, v192, v194
    ds_read_b128 v[144:147], v128 offset:2048
    v_add_f32 v193, v193, v195
    v_add_f32 v188, v188, v192
    ds_read_b128 v[148:151], v128 offset:4096
    v_add_f32 v189, v189, v193
    ds_read_b128 v[152:155], v128 offset:6144
    v_mul_f32 v188, 0xba800000, v188
    ds_read_b64_tr_b16 v[180:181], v130 offset:8192
    v_mul_f32 v189, 0x3a800000, v189
    v_fma_f32 v189, -v188, v188, v189
    ds_read_b64_tr_b16 v[182:183], v130 offset:9216
    v_max_f32 v189, 0, v189
    ds_read_b64_tr_b16 v[184:185], v131 offset:8192
    v_add_f32 v189, 0x3727c5ac, v189
    ds_read_b64_tr_b16 v[186:187], v131 offset:9216
    v_rsq_f32 v190, v189
    s_nop 0
    v_mul_f32 v189, v188, v190
    v_mov_b32 v188, v190
    s_waitcnt lgkmcnt(12)
    v_add_f32 v196, v196, v198
    ds_read_b128 v[164:167], v129 offset:0
    v_add_f32 v197, v197, v199
    v_add_f32 v200, v200, v202
    v_add_f32 v201, v201, v203
    ds_read_b128 v[168:171], v129 offset:2048
    v_add_f32 v196, v196, v200
    v_add_f32 v197, v197, v201
    v_add_f32 v204, v204, v206
    ds_read_b128 v[172:175], v129 offset:4096
    v_add_f32 v205, v205, v207
    v_add_f32 v208, v208, v210
    v_add_f32 v209, v209, v211
    ds_read_b128 v[176:179], v129 offset:6144
    v_add_f32 v204, v204, v208
    v_add_f32 v205, v205, v209
    v_mul_f32 v196, v188, v196
    v_fmac_f32 v196, v189, v204
    v_mul_f32 v197, v188, v197
    v_fmac_f32 v197, v189, v205
    v_cvt_pk_bf16_f32 v196, v196, v197
    ds_write_b16 v250, v196
    ds_write_b16_d16_hi v251, v196
    v_mov_b64 v[240:241], v[188:189]
    s_add_u32 s38, s38, 24576
    s_cmp_eq_u32 s38, 98304
    s_cselect_b32 s38, 0, s38
    v_add_u32 v128, s38, v124
    v_add_u32 v129, s38, v125
    v_add_u32 v130, s38, v126
    v_add_u32 v131, s38, v127
    v_lshlrev_b32 v248, 3, v1
    s_waitcnt lgkmcnt(0)
L_f_qloop:
    s_barrier
    v_mfma_f32_16x16x32_bf16 v[100:103], v[156:159], v[120:123], v[100:103]
    ds_read_b64_tr_b16 v[204:205], v130 offset:0
    ds_read_b64_tr_b16 v[206:207], v130 offset:1024
    v_mfma_f32_16x16x32_bf16 v[100:103], v[180:183], v[120:123], v[100:103]
    ds_read_b64_tr_b16 v[208:209], v131 offset:0
    v_mfma_f32_16x16x32_bf16 v[104:107], v[160:163], v[120:123], v[104:107]
    ds_read_b64_tr_b16 v[210:211], v131 offset:1024
    v_mfma_f32_16x16x32_bf16 v[104:107], v[184:187], v[120:123], v[104:107]
    ds_read_b128 v[188:191], v128 offset:0
    v_mfma_f32_16x16x32_bf16 v[68:71], v[156:159], v[140:143], v[68:71]
    ds_read_b128 v[192:195], v128 offset:2048
    ds_read_b128 v[196:199], v128 offset:4096
    v_mfma_f32_16x16x32_bf16 v[68:71], v[180:183], v[164:167], v[68:71]
    ds_read_b128 v[200:203], v128 offset:6144
    v_mfma_f32_16x16x32_bf16 v[84:87], v[160:163], v[140:143], v[84:87]
    ds_read_b64_tr_b16 v[228:229], v130 offset:8192
    v_mfma_f32_16x16x32_bf16 v[84:87], v[184:187], v[164:167], v[84:87]
    ds_read_b64_tr_b16 v[230:231], v130 offset:9216
    v_mfma_f32_16x16x32_bf16 v[88:91], v[160:163], v[144:147], v[88:91]
    ds_read_b64_tr_b16 v[232:233], v131 offset:8192
    ds_read_b64_tr_b16 v[234:235], v131 offset:9216
    v_mfma_f32_16x16x32_bf16 v[88:91], v[184:187], v[168:171], v[88:91]
    ds_read_b128 v[212:215], v129 offset:0
    v_mfma_f32_16x16x32_bf16 v[72:75], v[156:159], v[144:147], v[72:75]
    ds_read_b128 v[216:219], v129 offset:2048
    v_mfma_f32_16x16x32_bf16 v[72:75], v[180:183], v[168:171], v[72:75]
    ds_read_b128 v[220:223], v129 offset:4096
    v_mfma_f32_16x16x32_bf16 v[76:79], v[156:159], v[148:151], v[76:79]
    ds_read_b128 v[224:227], v129 offset:6144
    v_mfma_f32_16x16x32_bf16 v[76:79], v[180:183], v[172:175], v[76:79]
    v_mfma_f32_16x16x32_bf16 v[92:95], v[160:163], v[148:151], v[92:95]
    s_add_u32 s38, s38, 24576
    s_cmp_eq_u32 s38, 98304
    v_mfma_f32_16x16x32_bf16 v[92:95], v[184:187], v[172:175], v[92:95]
    s_cselect_b32 s38, 0, s38
    v_mfma_f32_16x16x32_bf16 v[96:99], v[160:163], v[152:155], v[96:99]
    v_add_u32 v128, s38, v124
    v_add_u32 v129, s38, v125
    v_mfma_f32_16x16x32_bf16 v[96:99], v[184:187], v[176:179], v[96:99]
    v_add_u32 v130, s38, v126
    v_add_u32 v131, s38, v127
    v_mfma_f32_16x16x32_bf16 v[80:83], v[156:159], v[152:155], v[80:83]
    s_cmp_eq_u32 s48, s80
    v_mfma_f32_16x16x32_bf16 v[80:83], v[180:183], v[176:179], v[80:83]
    s_cbranch_scc1 L_f_flag
L_f_flagged:
    s_waitcnt lgkmcnt(0)
    s_barrier
    v_mfma_f32_16x16x32_bf16 v[100:103], v[204:207], v[120:123], v[100:103]
    ds_read_b64_tr_b16 v[156:157], v130 offset:0
    ds_read_b64_tr_b16 v[158:159], v130 offset:1024
    v_mfma_f32_16x16x32_bf16 v[100:103], v[228:231], v[120:123], v[100:103]
    ds_read_b64_tr_b16 v[160:161], v131 offset:0
    v_mfma_f32_16x16x32_bf16 v[104:107], v[208:211], v[120:123], v[104:107]
    ds_read_b64_tr_b16 v[162:163], v131 offset:1024
    v_mfma_f32_16x16x32_bf16 v[104:107], v[232:235], v[120:123], v[104:107]
    ds_read_b128 v[140:143], v128 offset:0
    v_mfma_f32_16x16x32_bf16 v[68:71], v[204:207], v[188:191], v[68:71]
    ds_read_b128 v[144:147], v128 offset:2048
    ds_read_b128 v[148:151], v128 offset:4096
    v_mfma_f32_16x16x32_bf16 v[68:71], v[228:231], v[212:215], v[68:71]
    ds_read_b128 v[152:155], v128 offset:6144
    v_mfma_f32_16x16x32_bf16 v[84:87], v[208:211], v[188:191], v[84:87]
    ds_read_b64_tr_b16 v[180:181], v130 offset:8192
    v_mfma_f32_16x16x32_bf16 v[84:87], v[232:235], v[212:215], v[84:87]
    ds_read_b64_tr_b16 v[182:183], v130 offset:9216
    v_mfma_f32_16x16x32_bf16 v[88:91], v[208:211], v[192:195], v[88:91]
    ds_read_b64_tr_b16 v[184:185], v131 offset:8192
    ds_read_b64_tr_b16 v[186:187], v131 offset:9216
    v_mfma_f32_16x16x32_bf16 v[88:91], v[232:235], v[216:219], v[88:91]
    ds_read_b128 v[164:167], v129 offset:0
    v_mfma_f32_16x16x32_bf16 v[72:75], v[204:207], v[192:195], v[72:75]
    ds_read_b128 v[168:171], v129 offset:2048
    v_mfma_f32_16x16x32_bf16 v[72:75], v[228:231], v[216:219], v[72:75]
    ds_read_b128 v[172:175], v129 offset:4096
    v_mfma_f32_16x16x32_bf16 v[76:79], v[204:207], v[196:199], v[76:79]
    ds_read_b128 v[176:179], v129 offset:6144
    v_mfma_f32_16x16x32_bf16 v[76:79], v[228:231], v[220:223], v[76:79]
    v_mfma_f32_16x16x32_bf16 v[92:95], v[208:211], v[196:199], v[92:95]
    s_add_u32 s38, s38, 24576
    s_cmp_eq_u32 s38, 98304
    v_mfma_f32_16x16x32_bf16 v[92:95], v[232:235], v[220:223], v[92:95]
    s_cselect_b32 s38, 0, s38
    v_mfma_f32_16x16x32_bf16 v[96:99], v[208:211], v[200:203], v[96:99]
    v_add_u32 v128, s38, v124
    v_add_u32 v129, s38, v125
    v_mfma_f32_16x16x32_bf16 v[96:99], v[232:235], v[224:227], v[96:99]
    v_add_u32 v130, s38, v126
    v_add_u32 v131, s38, v127
    v_mfma_f32_16x16x32_bf16 v[80:83], v[204:207], v[200:203], v[80:83]
    s_sub_u32 s48, s48, 1
    s_cmp_lg_u32 s48, 0
    v_mfma_f32_16x16x32_bf16 v[80:83], v[228:231], v[224:227], v[80:83]
    s_waitcnt lgkmcnt(0)
    s_cbranch_scc1 L_f_qloop
    s_barrier
    buffer_load_dwordx2 v[108:109], v248, s[16:19], s62 offen sc1
    v_mfma_f32_16x16x32_bf16 v[100:103], v[156:159], v[120:123], v[100:103]
    ds_read_b64_tr_b16 v[204:205], v130 offset:0
    ds_read_b64_tr_b16 v[206:207], v130 offset:1024
    v_mfma_f32_16x16x32_bf16 v[100:103], v[180:183], v[120:123], v[100:103]
    ds_read_b64_tr_b16 v[208:209], v131 offset:0
    v_mfma_f32_16x16x32_bf16 v[104:107], v[160:163], v[120:123], v[104:107]
    ds_read_b64_tr_b16 v[210:211], v131 offset:1024
    ds_read_b128 v[188:191], v128 offset:0
    v_mfma_f32_16x16x32_bf16 v[104:107], v[184:187], v[120:123], v[104:107]
    ds_read_b128 v[192:195], v128 offset:2048
    v_mfma_f32_16x16x32_bf16 v[68:71], v[156:159], v[140:143], v[68:71]
    ds_read_b128 v[196:199], v128 offset:4096
    ds_read_b128 v[200:203], v128 offset:6144
    v_mfma_f32_16x16x32_bf16 v[68:71], v[180:183], v[164:167], v[68:71]
    ds_read_b64_tr_b16 v[228:229], v130 offset:8192
    v_mfma_f32_16x16x32_bf16 v[84:87], v[160:163], v[140:143], v[84:87]
    ds_read_b64_tr_b16 v[230:231], v130 offset:9216
    ds_read_b64_tr_b16 v[232:233], v131 offset:8192
    v_mfma_f32_16x16x32_bf16 v[84:87], v[184:187], v[164:167], v[84:87]
    ds_read_b64_tr_b16 v[234:235], v131 offset:9216
    v_mfma_f32_16x16x32_bf16 v[88:91], v[160:163], v[144:147], v[88:91]
    ds_read_b128 v[212:215], v129 offset:0
    ds_read_b128 v[216:219], v129 offset:2048
    v_mfma_f32_16x16x32_bf16 v[88:91], v[184:187], v[168:171], v[88:91]
    ds_read_b128 v[220:223], v129 offset:4096
    v_mfma_f32_16x16x32_bf16 v[72:75], v[156:159], v[144:147], v[72:75]
    ds_read_b128 v[224:227], v129 offset:6144
    v_mfma_f32_16x16x32_bf16 v[72:75], v[180:183], v[168:171], v[72:75]
    v_mfma_f32_16x16x32_bf16 v[76:79], v[156:159], v[148:151], v[76:79]
    v_mfma_f32_16x16x32_bf16 v[76:79], v[180:183], v[172:175], v[76:79]
    v_mfma_f32_16x16x32_bf16 v[92:95], v[160:163], v[148:151], v[92:95]
    v_mfma_f32_16x16x32_bf16 v[92:95], v[184:187], v[172:175], v[92:95]
    v_mfma_f32_16x16x32_bf16 v[96:99], v[160:163], v[152:155], v[96:99]
    v_mfma_f32_16x16x32_bf16 v[96:99], v[184:187], v[176:179], v[96:99]
    v_mfma_f32_16x16x32_bf16 v[80:83], v[156:159], v[152:155], v[80:83]
    v_mfma_f32_16x16x32_bf16 v[80:83], v[180:183], v[176:179], v[80:83]
    s_waitcnt lgkmcnt(0)
    v_mfma_f32_16x16x32_bf16 v[100:103], v[204:207], v[120:123], v[100:103]
    s_mov_b32 s38, 98304
    v_mfma_f32_16x16x32_bf16 v[100:103], v[228:231], v[120:123], v[100:103]
    s_mov_b32 s35, 8
    v_mfma_f32_16x16x32_bf16 v[104:107], v[208:211], v[120:123], v[104:107]
    v_mfma_f32_16x16x32_bf16 v[104:107], v[232:235], v[120:123], v[104:107]
    v_mfma_f32_16x16x32_bf16 v[68:71], v[204:207], v[188:191], v[68:71]
    s_waitcnt vmcnt(0)
    v_mfma_f32_16x16x32_bf16 v[68:71], v[228:231], v[212:215], v[68:71]
    v_mul_f32 v110, 0x3e8293ee, v108
    v_mul_f32 v111, 0x3e8293ee, v109
    v_mfma_f32_16x16x32_bf16 v[84:87], v[208:211], v[188:191], v[84:87]
    v_mul_f32 v108, 0x3e8293ee, v108
    v_mul_f32 v109, 0x3e8293ee, v109
    v_mfma_f32_16x16x32_bf16 v[84:87], v[232:235], v[212:215], v[84:87]
    s_nop 0
    v_mfma_f32_16x16x32_bf16 v[88:91], v[208:211], v[192:195], v[88:91]
    v_permlane16_swap_b32 v108, v110
    v_permlane16_swap_b32 v109, v111
    v_mfma_f32_16x16x32_bf16 v[88:91], v[232:235], v[216:219], v[88:91]
    v_mov_b32 v112, v108
    v_mov_b32 v113, v109
    v_mfma_f32_16x16x32_bf16 v[72:75], v[204:207], v[192:195], v[72:75]
    v_mov_b32 v114, v110
    v_mov_b32 v115, v111
    v_mfma_f32_16x16x32_bf16 v[72:75], v[228:231], v[216:219], v[72:75]
    v_permlane32_swap_b32 v108, v112
    v_permlane32_swap_b32 v109, v113
    v_mfma_f32_16x16x32_bf16 v[76:79], v[204:207], v[196:199], v[76:79]
    v_permlane32_swap_b32 v110, v114
    v_permlane32_swap_b32 v111, v115
    v_mfma_f32_16x16x32_bf16 v[76:79], v[228:231], v[220:223], v[76:79]
    v_mul_f32 v68, v108, v68
    v_mul_f32 v69, v108, v69
    v_mfma_f32_16x16x32_bf16 v[92:95], v[208:211], v[196:199], v[92:95]
    v_mul_f32 v70, v108, v70
    v_mul_f32 v71, v108, v71
    v_mfma_f32_16x16x32_bf16 v[92:95], v[232:235], v[220:223], v[92:95]
    v_fmac_f32 v68, v109, v100
    v_fmac_f32 v69, v109, v101
    v_mfma_f32_16x16x32_bf16 v[96:99], v[208:211], v[200:203], v[96:99]
    v_fmac_f32 v70, v109, v102
    v_fmac_f32 v71, v109, v103
    v_mfma_f32_16x16x32_bf16 v[96:99], v[232:235], v[224:227], v[96:99]
    v_cvt_pk_bf16_f32 v12, v68, v69
    v_cvt_pk_bf16_f32 v13, v70, v71
    v_mfma_f32_16x16x32_bf16 v[80:83], v[204:207], v[200:203], v[80:83]
    v_mul_f32 v84, v108, v84
    v_mul_f32 v85, v108, v85
    v_mfma_f32_16x16x32_bf16 v[80:83], v[228:231], v[224:227], v[80:83]
    v_mul_f32 v86, v108, v86
    v_mul_f32 v87, v108, v87
    v_fmac_f32 v84, v109, v104
    v_fmac_f32 v85, v109, v105
    v_fmac_f32 v86, v109, v106
    v_fmac_f32 v87, v109, v107
    v_cvt_pk_bf16_f32 v14, v84, v85
    v_cvt_pk_bf16_f32 v15, v86, v87
    v_pk_mul_f32 v[72:73], v[72:73], v[110:111] op_sel_hi:[1,0]
    v_pk_mul_f32 v[74:75], v[74:75], v[110:111] op_sel_hi:[1,0]
    v_pk_fma_f32 v[72:73], v[100:101], v[110:111], v[72:73] op_sel:[0,1,0] op_sel_hi:[1,1,1]
    v_pk_fma_f32 v[74:75], v[102:103], v[110:111], v[74:75] op_sel:[0,1,0] op_sel_hi:[1,1,1]
    v_cvt_pk_bf16_f32 v16, v72, v73
    v_cvt_pk_bf16_f32 v17, v74, v75
    v_pk_mul_f32 v[88:89], v[88:89], v[110:111] op_sel_hi:[1,0]
    v_pk_mul_f32 v[90:91], v[90:91], v[110:111] op_sel_hi:[1,0]
    v_pk_fma_f32 v[88:89], v[104:105], v[110:111], v[88:89] op_sel:[0,1,0] op_sel_hi:[1,1,1]
    v_pk_fma_f32 v[90:91], v[106:107], v[110:111], v[90:91] op_sel:[0,1,0] op_sel_hi:[1,1,1]
    v_cvt_pk_bf16_f32 v18, v88, v89
    v_cvt_pk_bf16_f32 v19, v90, v91
    v_pk_mul_f32 v[76:77], v[76:77], v[112:113] op_sel_hi:[1,0]
    v_pk_mul_f32 v[78:79], v[78:79], v[112:113] op_sel_hi:[1,0]
    v_pk_fma_f32 v[76:77], v[100:101], v[112:113], v[76:77] op_sel:[0,1,0] op_sel_hi:[1,1,1]
    v_pk_fma_f32 v[78:79], v[102:103], v[112:113], v[78:79] op_sel:[0,1,0] op_sel_hi:[1,1,1]
    v_cvt_pk_bf16_f32 v20, v76, v77
    v_cvt_pk_bf16_f32 v21, v78, v79
    v_pk_mul_f32 v[92:93], v[92:93], v[112:113] op_sel_hi:[1,0]
    v_pk_mul_f32 v[94:95], v[94:95], v[112:113] op_sel_hi:[1,0]
    v_pk_fma_f32 v[92:93], v[104:105], v[112:113], v[92:93] op_sel:[0,1,0] op_sel_hi:[1,1,1]
    v_pk_fma_f32 v[94:95], v[106:107], v[112:113], v[94:95] op_sel:[0,1,0] op_sel_hi:[1,1,1]
    v_cvt_pk_bf16_f32 v22, v92, v93
    v_cvt_pk_bf16_f32 v23, v94, v95
    v_pk_mul_f32 v[80:81], v[80:81], v[114:115] op_sel_hi:[1,0]
    v_pk_mul_f32 v[82:83], v[82:83], v[114:115] op_sel_hi:[1,0]
    v_pk_fma_f32 v[80:81], v[100:101], v[114:115], v[80:81] op_sel:[0,1,0] op_sel_hi:[1,1,1]
    v_pk_fma_f32 v[82:83], v[102:103], v[114:115], v[82:83] op_sel:[0,1,0] op_sel_hi:[1,1,1]
    v_cvt_pk_bf16_f32 v24, v80, v81
    v_cvt_pk_bf16_f32 v25, v82, v83
    v_pk_mul_f32 v[96:97], v[96:97], v[114:115] op_sel_hi:[1,0]
    v_pk_mul_f32 v[98:99], v[98:99], v[114:115] op_sel_hi:[1,0]
    v_pk_fma_f32 v[96:97], v[104:105], v[114:115], v[96:97] op_sel:[0,1,0] op_sel_hi:[1,1,1]
    v_pk_fma_f32 v[98:99], v[106:107], v[114:115], v[98:99] op_sel:[0,1,0] op_sel_hi:[1,1,1]
    v_cvt_pk_bf16_f32 v26, v96, v97
    v_cvt_pk_bf16_f32 v27, v98, v99
    v_mov_b64 v[188:189], 0
    v_mov_b64 v[190:191], 0
    v_mov_b64 v[192:193], 0
    v_mov_b64 v[194:195], 0
    v_mov_b64 v[196:197], 0
    v_mov_b64 v[198:199], 0
    v_mov_b64 v[200:201], 0
    v_mov_b64 v[202:203], 0
    v_mov_b64 v[228:229], 0
    v_mov_b64 v[230:231], 0
    v_mov_b64 v[232:233], 0
    v_mov_b64 v[234:235], 0
    v_permlane16_swap_b32 v12, v16
    v_permlane16_swap_b32 v13, v17
    v_permlane16_swap_b32 v14, v18
    v_permlane16_swap_b32 v15, v19
    v_permlane16_swap_b32 v20, v24
    v_permlane16_swap_b32 v21, v25
    v_permlane16_swap_b32 v22, v26
    v_permlane16_swap_b32 v23, v27
    s_branch L_f_att
L_f_flag:
    s_cmp_lg_u32 s80, 7
    s_cbranch_scc1 L_f_flag2
    ds_read_b128 v[236:239], v245 offset:8192
    v_lshlrev_b32 v6, 3, v1
    s_cmp_eq_u32 s34, 0
    s_cselect_b32 s36, s58, 1073741824
    buffer_store_dwordx2 v[28:29], v6, s[16:19], s36 offen sc1
    s_and_b32 s36, s34, 3
    s_lshl_b32 s36, s36, 7
    s_add_u32 s36, s36, s62
    s_mov_b64 exec, 0xffff
    buffer_store_dwordx2 v[240:241], v6, s[16:19], s36 offen sc1
    s_mov_b64 exec, -1
    s_waitcnt lgkmcnt(0)
    buffer_store_dwordx4 v[236:239], v252, s[72:75], s81 offen sc1
    s_mov_b32 s80, 5
    s_branch L_f_flagged
L_f_flag2:
    s_and_b32 s36, s2, 0xfc
    v_mov_b32 v6, s36
    v_mov_b32 v7, 1
    s_mov_b64 exec, 1
    s_waitcnt vmcnt(0)
    global_atomic_add v6, v7, s[30:31] sc1
    s_mov_b64 exec, -1
    s_branch L_f_flagged
.p2align 12
.fill 256, 4, 0xbf800000
L_isl1:
    s_branch L_f_back
L_isl1_over:
L_f_att:
    s_barrier
    ds_read_b128 v[204:207], v10 offset:0
    ds_read_b128 v[208:211], v10 offset:1024
    ds_read_b128 v[220:223], v10 offset:2048
    ds_read_b128 v[224:227], v10 offset:3072
    ds_read_b128 v[212:215], v10 offset:4096
    ds_read_b128 v[216:219], v10 offset:5120
    s_mov_b32 s36, 32768
    buffer_load_dwordx4 v[100:103], v255, s[4:7], 0 offen offset:0
    buffer_load_dwordx4 v[104:107], v255, s[4:7], 0 offen offset:64
    buffer_load_dwordx4 v[108:111], v255, s[4:7], s36 offen offset:0
    buffer_load_dwordx4 v[112:115], v255, s[4:7], s36 offen offset:64
    s_waitcnt lgkmcnt(4)
    v_mfma_f32_32x32x16_bf16 v[140:155], v[204:207], v[12:15], 0
    v_mfma_f32_32x32x16_bf16 v[140:155], v[208:211], v[16:19], v[140:155]
    v_and_b32 v6, 1, v2
    v_lshlrev_b32 v6, 10, v6
    v_lshrrev_b32 v7, 5, v1
    v_lshl_add_u32 v6, v7, 8, v6
    v_lshl_add_u32 v250, v5, 4, v6
    s_lshl_b32 s36, s32, 12
    s_add_u32 s36, s36, 131072
    v_add_u32 v251, s36, v250
    s_lshl_b32 s36, s55, 11
    s_add_u32 s36, s36, 131072
    v_add_u32 v124, s36, v9
    v_add_u32 v128, s36, v9
.p2align 6
L_k1_loop:
    v_mfma_f32_32x32x16_bf16 v[156:171], v[204:207], v[20:23], 0
    v_exp_f32 v140, v140
    v_exp_f32 v141, v141
    v_exp_f32 v142, v142
    v_mfma_f32_32x32x16_bf16 v[156:171], v[208:211], v[24:27], v[156:171]
    v_exp_f32 v143, v143
    v_exp_f32 v144, v144
    v_exp_f32 v145, v145
    v_smfmac_f32_32x32x32_bf16 v[44:59], v[228:231], v[188:195], v11
    v_exp_f32 v146, v146
    v_exp_f32 v147, v147
    v_exp_f32 v148, v148
    v_smfmac_f32_32x32x32_bf16 v[44:59], v[232:235], v[196:203], v11
    s_waitcnt lgkmcnt(0)
    v_exp_f32 v149, v149
    v_exp_f32 v150, v150
    v_exp_f32 v151, v151
    v_smfmac_f32_16x16x64_bf16 v[64:67], v[116:119], v[188:195], v11
    ds_read_b128 v[228:231], v10 offset:6144
    v_exp_f32 v152, v152
    v_exp_f32 v153, v153
    v_smfmac_f32_16x16x64_bf16 v[64:67], v[116:119], v[196:203], v11
    ds_read_b128 v[232:235], v10 offset:7168
    v_exp_f32 v154, v154
    v_exp_f32 v155, v155
    v_mfma_f32_32x32x16_bf16 v[172:187], v[212:215], v[12:15], 0
    v_exp_f32 v156, v156
    v_exp_f32 v157, v157
    v_exp_f32 v158, v158
    v_mfma_f32_32x32x16_bf16 v[172:187], v[216:219], v[16:19], v[172:187]
    v_exp_f32 v159, v159
    v_exp_f32 v160, v160
    v_exp_f32 v161, v161
    v_smfmac_f32_32x32x32_bf16 v[28:43], v[220:223], v[140:147], v11
    v_exp_f32 v162, v162
    v_exp_f32 v163, v163
    v_exp_f32 v164, v164
    v_smfmac_f32_32x32x32_bf16 v[28:43], v[224:227], v[148:155], v11
    v_exp_f32 v165, v165
    v_exp_f32 v166, v166
    v_exp_f32 v167, v167
    v_smfmac_f32_16x16x64_bf16 v[60:63], v[116:119], v[140:147], v11
    ds_read_b128 v[204:207], v10 offset:8192
    v_exp_f32 v168, v168
    v_exp_f32 v169, v169
    v_smfmac_f32_16x16x64_bf16 v[60:63], v[116:119], v[148:155], v11
    ds_read_b128 v[208:211], v10 offset:9216
    v_exp_f32 v170, v170
    v_exp_f32 v171, v171
    v_mfma_f32_32x32x16_bf16 v[188:203], v[212:215], v[20:23], 0
    v_exp_f32 v172, v172
    v_exp_f32 v173, v173
    v_exp_f32 v174, v174
    v_mfma_f32_32x32x16_bf16 v[188:203], v[216:219], v[24:27], v[188:203]
    v_exp_f32 v175, v175
    v_exp_f32 v176, v176
    v_exp_f32 v177, v177
    v_smfmac_f32_32x32x32_bf16 v[44:59], v[220:223], v[156:163], v11
    v_exp_f32 v178, v178
    v_exp_f32 v179, v179
    v_exp_f32 v180, v180
    v_smfmac_f32_32x32x32_bf16 v[44:59], v[224:227], v[164:171], v11
    s_waitcnt lgkmcnt(0)
    v_exp_f32 v181, v181
    v_exp_f32 v182, v182
    v_exp_f32 v183, v183
    v_smfmac_f32_16x16x64_bf16 v[64:67], v[116:119], v[156:163], v11
    ds_read_b128 v[220:223], v10 offset:10240
    v_exp_f32 v184, v184
    v_exp_f32 v185, v185
    v_smfmac_f32_16x16x64_bf16 v[64:67], v[116:119], v[164:171], v11
    ds_read_b128 v[224:227], v10 offset:11264
    v_exp_f32 v186, v186
    v_exp_f32 v187, v187
    v_mfma_f32_32x32x16_bf16 v[140:155], v[204:207], v[12:15], 0
    v_exp_f32 v188, v188
    v_exp_f32 v189, v189
    v_exp_f32 v190, v190
    v_mfma_f32_32x32x16_bf16 v[140:155], v[208:211], v[16:19], v[140:155]
    v_exp_f32 v191, v191
    v_exp_f32 v192, v192
    v_exp_f32 v193, v193
    v_smfmac_f32_32x32x32_bf16 v[28:43], v[228:231], v[172:179], v11
    v_exp_f32 v194, v194
    v_exp_f32 v195, v195
    v_exp_f32 v196, v196
    v_smfmac_f32_32x32x32_bf16 v[28:43], v[232:235], v[180:187], v11
    v_exp_f32 v197, v197
    v_exp_f32 v198, v198
    v_exp_f32 v199, v199
    v_smfmac_f32_16x16x64_bf16 v[60:63], v[116:119], v[172:179], v11
    ds_read_b128 v[212:215], v10 offset:12288
    v_exp_f32 v200, v200
    v_exp_f32 v201, v201
    v_smfmac_f32_16x16x64_bf16 v[60:63], v[116:119], v[180:187], v11
    ds_read_b128 v[216:219], v10 offset:13312
    v_exp_f32 v202, v202
    v_exp_f32 v203, v203
    v_mfma_f32_32x32x16_bf16 v[156:171], v[204:207], v[20:23], 0
    v_exp_f32 v140, v140
    v_exp_f32 v141, v141
    v_exp_f32 v142, v142
    v_mfma_f32_32x32x16_bf16 v[156:171], v[208:211], v[24:27], v[156:171]
    v_exp_f32 v143, v143
    v_exp_f32 v144, v144
    v_exp_f32 v145, v145
    v_smfmac_f32_32x32x32_bf16 v[44:59], v[228:231], v[188:195], v11
    v_exp_f32 v146, v146
    v_exp_f32 v147, v147
    v_exp_f32 v148, v148
    v_smfmac_f32_32x32x32_bf16 v[44:59], v[232:235], v[196:203], v11
    s_waitcnt lgkmcnt(0)
    v_exp_f32 v149, v149
    v_exp_f32 v150, v150
    v_exp_f32 v151, v151
    v_smfmac_f32_16x16x64_bf16 v[64:67], v[116:119], v[188:195], v11
    ds_read_b128 v[228:231], v10 offset:14336
    v_exp_f32 v152, v152
    v_exp_f32 v153, v153
    v_smfmac_f32_16x16x64_bf16 v[64:67], v[116:119], v[196:203], v11
    ds_read_b128 v[232:235], v10 offset:15360
    v_exp_f32 v154, v154
    v_exp_f32 v155, v155
    v_mfma_f32_32x32x16_bf16 v[172:187], v[212:215], v[12:15], 0
    v_exp_f32 v156, v156
    v_exp_f32 v157, v157
    v_exp_f32 v158, v158
    v_mfma_f32_32x32x16_bf16 v[172:187], v[216:219], v[16:19], v[172:187]
    v_exp_f32 v159, v159
    v_exp_f32 v160, v160
    v_exp_f32 v161, v161
    v_smfmac_f32_32x32x32_bf16 v[28:43], v[220:223], v[140:147], v11
    v_exp_f32 v162, v162
    v_exp_f32 v163, v163
    v_exp_f32 v164, v164
    v_smfmac_f32_32x32x32_bf16 v[28:43], v[224:227], v[148:155], v11
    v_exp_f32 v165, v165
    v_exp_f32 v166, v166
    v_exp_f32 v167, v167
    v_smfmac_f32_16x16x64_bf16 v[60:63], v[116:119], v[140:147], v11
    ds_read_b128 v[204:207], v10 offset:16384
    v_exp_f32 v168, v168
    v_exp_f32 v169, v169
    v_smfmac_f32_16x16x64_bf16 v[60:63], v[116:119], v[148:155], v11
    ds_read_b128 v[208:211], v10 offset:17408
    v_exp_f32 v170, v170
    v_exp_f32 v171, v171
    v_mfma_f32_32x32x16_bf16 v[188:203], v[212:215], v[20:23], 0
    v_exp_f32 v172, v172
    v_exp_f32 v173, v173
    v_exp_f32 v174, v174
    v_mfma_f32_32x32x16_bf16 v[188:203], v[216:219], v[24:27], v[188:203]
    v_exp_f32 v175, v175
    v_exp_f32 v176, v176
    v_exp_f32 v177, v177
    v_smfmac_f32_32x32x32_bf16 v[44:59], v[220:223], v[156:163], v11
    v_exp_f32 v178, v178
    v_exp_f32 v179, v179
    v_exp_f32 v180, v180
    v_smfmac_f32_32x32x32_bf16 v[44:59], v[224:227], v[164:171], v11
    s_waitcnt lgkmcnt(0)
    v_exp_f32 v181, v181
    v_exp_f32 v182, v182
    v_exp_f32 v183, v183
    v_smfmac_f32_16x16x64_bf16 v[64:67], v[116:119], v[156:163], v11
    ds_read_b128 v[220:223], v10 offset:18432
    v_exp_f32 v184, v184
    v_exp_f32 v185, v185
    v_smfmac_f32_16x16x64_bf16 v[64:67], v[116:119], v[164:171], v11
    ds_read_b128 v[224:227], v10 offset:19456
    v_exp_f32 v186, v186
    v_exp_f32 v187, v187
    v_mfma_f32_32x32x16_bf16 v[140:155], v[204:207], v[12:15], 0
    v_exp_f32 v188, v188
    v_exp_f32 v189, v189
    v_exp_f32 v190, v190
    v_mfma_f32_32x32x16_bf16 v[140:155], v[208:211], v[16:19], v[140:155]
    v_exp_f32 v191, v191
    v_exp_f32 v192, v192
    v_exp_f32 v193, v193
    v_smfmac_f32_32x32x32_bf16 v[28:43], v[228:231], v[172:179], v11
    v_exp_f32 v194, v194
    v_exp_f32 v195, v195
    v_exp_f32 v196, v196
    v_smfmac_f32_32x32x32_bf16 v[28:43], v[232:235], v[180:187], v11
    v_exp_f32 v197, v197
    v_exp_f32 v198, v198
    v_exp_f32 v199, v199
    v_smfmac_f32_16x16x64_bf16 v[60:63], v[116:119], v[172:179], v11
    ds_read_b128 v[212:215], v10 offset:20480
    v_exp_f32 v200, v200
    v_exp_f32 v201, v201
    v_smfmac_f32_16x16x64_bf16 v[60:63], v[116:119], v[180:187], v11
    ds_read_b128 v[216:219], v10 offset:21504
    v_exp_f32 v202, v202
    v_exp_f32 v203, v203
    v_mfma_f32_32x32x16_bf16 v[156:171], v[204:207], v[20:23], 0
    v_exp_f32 v140, v140
    v_exp_f32 v141, v141
    v_exp_f32 v142, v142
    v_mfma_f32_32x32x16_bf16 v[156:171], v[208:211], v[24:27], v[156:171]
    v_exp_f32 v143, v143
    v_exp_f32 v144, v144
    v_exp_f32 v145, v145
    v_smfmac_f32_32x32x32_bf16 v[44:59], v[228:231], v[188:195], v11
    v_exp_f32 v146, v146
    v_exp_f32 v147, v147
    v_exp_f32 v148, v148
    v_smfmac_f32_32x32x32_bf16 v[44:59], v[232:235], v[196:203], v11
    s_waitcnt lgkmcnt(0)
    v_exp_f32 v149, v149
    v_exp_f32 v150, v150
    v_exp_f32 v151, v151
    v_smfmac_f32_16x16x64_bf16 v[64:67], v[116:119], v[188:195], v11
    ds_read_b128 v[228:231], v10 offset:22528
    v_exp_f32 v152, v152
    v_exp_f32 v153, v153
    v_smfmac_f32_16x16x64_bf16 v[64:67], v[116:119], v[196:203], v11
    ds_read_b128 v[232:235], v10 offset:23552
    v_exp_f32 v154, v154
    v_exp_f32 v155, v155
    v_mfma_f32_32x32x16_bf16 v[172:187], v[212:215], v[12:15], 0
    v_exp_f32 v156, v156
    v_exp_f32 v157, v157
    v_exp_f32 v158, v158
    v_mfma_f32_32x32x16_bf16 v[172:187], v[216:219], v[16:19], v[172:187]
    v_exp_f32 v159, v159
    v_exp_f32 v160, v160
    v_exp_f32 v161, v161
    v_smfmac_f32_32x32x32_bf16 v[28:43], v[220:223], v[140:147], v11
    s_add_u32 s38, s38, 32768
    v_exp_f32 v162, v162
    v_exp_f32 v163, v163
    v_exp_f32 v164, v164
    v_smfmac_f32_32x32x32_bf16 v[28:43], v[224:227], v[148:155], v11
    s_cmp_eq_u32 s38, 163840
    v_exp_f32 v165, v165
    v_exp_f32 v166, v166
    v_exp_f32 v167, v167
    v_smfmac_f32_16x16x64_bf16 v[60:63], v[116:119], v[140:147], v11
    ds_read_b128 v[204:207], v10 offset:24576
    v_exp_f32 v168, v168
    v_exp_f32 v169, v169
    v_smfmac_f32_16x16x64_bf16 v[60:63], v[116:119], v[148:155], v11
    ds_read_b128 v[208:211], v10 offset:25600
    v_exp_f32 v170, v170
    v_exp_f32 v171, v171
    v_mfma_f32_32x32x16_bf16 v[188:203], v[212:215], v[20:23], 0
    v_exp_f32 v172, v172
    v_exp_f32 v173, v173
    v_exp_f32 v174, v174
    v_mfma_f32_32x32x16_bf16 v[188:203], v[216:219], v[24:27], v[188:203]
    v_exp_f32 v175, v175
    v_exp_f32 v176, v176
    v_exp_f32 v177, v177
    v_smfmac_f32_32x32x32_bf16 v[44:59], v[220:223], v[156:163], v11
    s_cselect_b32 s38, 65536, s38
    v_exp_f32 v178, v178
    v_exp_f32 v179, v179
    v_exp_f32 v180, v180
    v_smfmac_f32_32x32x32_bf16 v[44:59], v[224:227], v[164:171], v11
    s_waitcnt lgkmcnt(0)
    v_exp_f32 v181, v181
    v_exp_f32 v182, v182
    v_exp_f32 v183, v183
    v_smfmac_f32_16x16x64_bf16 v[64:67], v[116:119], v[156:163], v11
    ds_read_b128 v[220:223], v10 offset:26624
    v_exp_f32 v184, v184
    v_exp_f32 v185, v185
    v_smfmac_f32_16x16x64_bf16 v[64:67], v[116:119], v[164:171], v11
    ds_read_b128 v[224:227], v10 offset:27648
    v_exp_f32 v186, v186
    v_exp_f32 v187, v187
    v_mfma_f32_32x32x16_bf16 v[140:155], v[204:207], v[12:15], 0
    v_exp_f32 v188, v188
    v_exp_f32 v189, v189
    v_exp_f32 v190, v190
    v_mfma_f32_32x32x16_bf16 v[140:155], v[208:211], v[16:19], v[140:155]
    v_exp_f32 v191, v191
    v_exp_f32 v192, v192
    v_exp_f32 v193, v193
    v_smfmac_f32_32x32x32_bf16 v[28:43], v[228:231], v[172:179], v11
    v_exp_f32 v194, v194
    v_exp_f32 v195, v195
    v_exp_f32 v196, v196
    v_smfmac_f32_32x32x32_bf16 v[28:43], v[232:235], v[180:187], v11
    v_exp_f32 v197, v197
    v_exp_f32 v198, v198
    v_exp_f32 v199, v199
    v_smfmac_f32_16x16x64_bf16 v[60:63], v[116:119], v[172:179], v11
    ds_read_b128 v[212:215], v10 offset:28672
    v_exp_f32 v200, v200
    v_exp_f32 v201, v201
    v_smfmac_f32_16x16x64_bf16 v[60:63], v[116:119], v[180:187], v11
    ds_read_b128 v[216:219], v10 offset:29696
    v_exp_f32 v202, v202
    v_exp_f32 v203, v203
    v_mfma_f32_32x32x16_bf16 v[156:171], v[204:207], v[20:23], 0
    v_exp_f32 v140, v140
    v_exp_f32 v141, v141
    v_exp_f32 v142, v142
    v_mfma_f32_32x32x16_bf16 v[156:171], v[208:211], v[24:27], v[156:171]
    v_exp_f32 v143, v143
    v_exp_f32 v144, v144
    v_exp_f32 v145, v145
    v_smfmac_f32_32x32x32_bf16 v[44:59], v[228:231], v[188:195], v11
    v_exp_f32 v146, v146
    v_exp_f32 v147, v147
    v_exp_f32 v148, v148
    v_smfmac_f32_32x32x32_bf16 v[44:59], v[232:235], v[196:203], v11
    s_waitcnt lgkmcnt(0)
    v_exp_f32 v149, v149
    v_exp_f32 v150, v150
    v_exp_f32 v151, v151
    v_smfmac_f32_16x16x64_bf16 v[64:67], v[116:119], v[188:195], v11
    ds_read_b128 v[228:231], v10 offset:30720
    v_exp_f32 v152, v152
    v_exp_f32 v153, v153
    v_smfmac_f32_16x16x64_bf16 v[64:67], v[116:119], v[196:203], v11
    ds_read_b128 v[232:235], v10 offset:31744
    v_exp_f32 v154, v154
    v_exp_f32 v155, v155
    v_mfma_f32_32x32x16_bf16 v[172:187], v[212:215], v[12:15], 0
    v_exp_f32 v156, v156
    v_exp_f32 v157, v157
    v_exp_f32 v158, v158
    v_mfma_f32_32x32x16_bf16 v[172:187], v[216:219], v[16:19], v[172:187]
    v_add_u32 v10, s38, v9
    v_exp_f32 v159, v159
    v_exp_f32 v160, v160
    v_exp_f32 v161, v161
    v_smfmac_f32_32x32x32_bf16 v[28:43], v[220:223], v[140:147], v11
    s_waitcnt lgkmcnt(0)
    v_exp_f32 v162, v162
    v_exp_f32 v163, v163
    v_exp_f32 v164, v164
    v_smfmac_f32_32x32x32_bf16 v[28:43], v[224:227], v[148:155], v11
    s_barrier
    v_exp_f32 v165, v165
    v_exp_f32 v166, v166
    v_exp_f32 v167, v167
    v_smfmac_f32_16x16x64_bf16 v[60:63], v[116:119], v[140:147], v11
    ds_read_b128 v[204:207], v10 offset:0
    v_exp_f32 v168, v168
    v_exp_f32 v169, v169
    v_smfmac_f32_16x16x64_bf16 v[60:63], v[116:119], v[148:155], v11
    ds_read_b128 v[208:211], v10 offset:1024
    v_exp_f32 v170, v170
    v_exp_f32 v171, v171
    v_mfma_f32_32x32x16_bf16 v[188:203], v[212:215], v[20:23], 0
    v_exp_f32 v172, v172
    v_exp_f32 v173, v173
    v_exp_f32 v174, v174
    v_mfma_f32_32x32x16_bf16 v[188:203], v[216:219], v[24:27], v[188:203]
    v_exp_f32 v175, v175
    v_exp_f32 v176, v176
    v_exp_f32 v177, v177
    v_smfmac_f32_32x32x32_bf16 v[44:59], v[220:223], v[156:163], v11
    v_exp_f32 v178, v178
    v_exp_f32 v179, v179
    v_exp_f32 v180, v180
    v_smfmac_f32_32x32x32_bf16 v[44:59], v[224:227], v[164:171], v11
    s_waitcnt lgkmcnt(0)
    v_exp_f32 v181, v181
    v_exp_f32 v182, v182
    v_exp_f32 v183, v183
    v_smfmac_f32_16x16x64_bf16 v[64:67], v[116:119], v[156:163], v11
    ds_read_b128 v[220:223], v10 offset:2048
    v_exp_f32 v184, v184
    v_exp_f32 v185, v185
    v_smfmac_f32_16x16x64_bf16 v[64:67], v[116:119], v[164:171], v11
    ds_read_b128 v[224:227], v10 offset:3072
    v_exp_f32 v186, v186
    v_exp_f32 v187, v187
    v_mfma_f32_32x32x16_bf16 v[140:155], v[204:207], v[12:15], 0
    v_exp_f32 v188, v188
    v_exp_f32 v189, v189
    v_exp_f32 v190, v190
    v_mfma_f32_32x32x16_bf16 v[140:155], v[208:211], v[16:19], v[140:155]
    v_exp_f32 v191, v191
    v_exp_f32 v192, v192
    v_exp_f32 v193, v193
    v_exp_f32 v194, v194
    v_smfmac_f32_32x32x32_bf16 v[28:43], v[228:231], v[172:179], v11
    s_sub_u32 s35, s35, 1
    v_exp_f32 v195, v195
    v_exp_f32 v196, v196
    v_exp_f32 v197, v197
    v_smfmac_f32_32x32x32_bf16 v[28:43], v[232:235], v[180:187], v11
    s_cmp_lg_u32 s35, 0
    v_exp_f32 v198, v198
    v_exp_f32 v199, v199
    v_exp_f32 v200, v200
    v_exp_f32 v201, v201
    v_smfmac_f32_16x16x64_bf16 v[60:63], v[116:119], v[172:179], v11
    ds_read_b128 v[212:215], v10 offset:4096
    v_exp_f32 v202, v202
    v_exp_f32 v203, v203
    v_smfmac_f32_16x16x64_bf16 v[60:63], v[116:119], v[180:187], v11
    ds_read_b128 v[216:219], v10 offset:5120
    s_cbranch_scc1 L_k1_loop
    v_smfmac_f32_32x32x32_bf16 v[44:59], v[228:231], v[188:195], v11
    v_smfmac_f32_32x32x32_bf16 v[44:59], v[232:235], v[196:203], v11
    v_smfmac_f32_16x16x64_bf16 v[64:67], v[116:119], v[188:195], v11
    v_smfmac_f32_16x16x64_bf16 v[64:67], v[116:119], v[196:203], v11
    s_nop 9
    v_maximum3_f32 v6, abs(v28), abs(v29), v60
    v_maximum3_f32 v7, abs(v30), abs(v31), abs(v32)
    v_maximum3_f32 v6, abs(v33), abs(v34), v6
    v_maximum3_f32 v7, abs(v35), abs(v36), v7
    v_maximum3_f32 v6, abs(v37), abs(v38), v6
    v_maximum3_f32 v7, abs(v39), abs(v40), v7
    v_maximum3_f32 v6, abs(v41), abs(v42), v6
    v_maximum3_f32 v6, abs(v43), v7, v6
    v_cmp_nle_f32 vcc, 0x17800000, v60
    s_mov_b64 s[70:71], vcc
    v_cmp_nge_f32 vcc, 0x71800000, v6
    s_or_b64 s[70:71], s[70:71], vcc
    s_cbranch_scc1 L_k1_slow
    v_rcp_f32 v60, v60
    s_nop 0
    v_pk_mul_f32 v[28:29], v[28:29], v[60:61] op_sel_hi:[1,0]
    v_pk_mul_f32 v[30:31], v[30:31], v[60:61] op_sel_hi:[1,0]
    v_pk_mul_f32 v[32:33], v[32:33], v[60:61] op_sel_hi:[1,0]
    v_pk_mul_f32 v[34:35], v[34:35], v[60:61] op_sel_hi:[1,0]
    v_cvt_pk_bf16_f32 v204, v28, v29
    v_cvt_pk_bf16_f32 v205, v30, v31
    v_cvt_pk_bf16_f32 v206, v32, v33
    v_cvt_pk_bf16_f32 v207, v34, v35
    buffer_store_dwordx4 v[204:207], v250, s[16:19], s47 offen offset:0 sc1
    v_pk_mul_f32 v[36:37], v[36:37], v[60:61] op_sel_hi:[1,0]
    v_pk_mul_f32 v[38:39], v[38:39], v[60:61] op_sel_hi:[1,0]
    v_pk_mul_f32 v[40:41], v[40:41], v[60:61] op_sel_hi:[1,0]
    v_pk_mul_f32 v[42:43], v[42:43], v[60:61] op_sel_hi:[1,0]
    v_cvt_pk_bf16_f32 v208, v36, v37
    v_cvt_pk_bf16_f32 v209, v38, v39
    v_cvt_pk_bf16_f32 v210, v40, v41
    v_cvt_pk_bf16_f32 v211, v42, v43
    buffer_store_dwordx4 v[208:211], v250, s[16:19], s47 offen offset:512 sc1
    v_maximum3_f32 v6, abs(v44), abs(v45), v64
    v_maximum3_f32 v7, abs(v46), abs(v47), abs(v48)
    v_maximum3_f32 v6, abs(v49), abs(v50), v6
    v_maximum3_f32 v7, abs(v51), abs(v52), v7
    v_maximum3_f32 v6, abs(v53), abs(v54), v6
    v_maximum3_f32 v7, abs(v55), abs(v56), v7
    v_maximum3_f32 v6, abs(v57), abs(v58), v6
    v_maximum3_f32 v6, abs(v59), v7, v6
    v_cmp_nle_f32 vcc, 0x17800000, v64
    s_mov_b64 s[70:71], vcc
    v_cmp_nge_f32 vcc, 0x71800000, v6
    s_or_b64 s[70:71], s[70:71], vcc
    s_cbranch_scc1 L_k1_slow
L_k1_out:
    v_rcp_f32 v64, v64
    s_nop 0
    v_pk_mul_f32 v[44:45], v[44:45], v[64:65] op_sel_hi:[1,0]
    v_pk_mul_f32 v[46:47], v[46:47], v[64:65] op_sel_hi:[1,0]
    v_pk_mul_f32 v[48:49], v[48:49], v[64:65] op_sel_hi:[1,0]
    v_pk_mul_f32 v[50:51], v[50:51], v[64:65] op_sel_hi:[1,0]
    v_cvt_pk_bf16_f32 v228, v44, v45
    v_cvt_pk_bf16_f32 v229, v46, v47
    v_cvt_pk_bf16_f32 v230, v48, v49
    v_cvt_pk_bf16_f32 v231, v50, v51
    buffer_store_dwordx4 v[228:231], v250, s[16:19], s47 offen offset:2048 sc1
    v_pk_mul_f32 v[52:53], v[52:53], v[64:65] op_sel_hi:[1,0]
    v_pk_mul_f32 v[54:55], v[54:55], v[64:65] op_sel_hi:[1,0]
    v_pk_mul_f32 v[56:57], v[56:57], v[64:65] op_sel_hi:[1,0]
    v_pk_mul_f32 v[58:59], v[58:59], v[64:65] op_sel_hi:[1,0]
    v_cvt_pk_bf16_f32 v232, v52, v53
    v_cvt_pk_bf16_f32 v233, v54, v55
    v_cvt_pk_bf16_f32 v234, v56, v57
    v_cvt_pk_bf16_f32 v235, v58, v59
    buffer_store_dwordx4 v[232:235], v250, s[16:19], s47 offen offset:2560 sc1
    ds_write_b128 v251, v[204:207] offset:0
    ds_write_b128 v251, v[208:211] offset:512
    ds_write_b128 v251, v[228:231] offset:2048
    ds_write_b128 v251, v[232:235] offset:2560
    s_branch L_f_oproj
.p2align 12
.fill 256, 4, 0xbf800000
L_isl2:
    s_branch L_f_back2
L_isl2_over:
L_f_oproj:
    s_waitcnt vmcnt(4)
    v_permlane16_swap_b32 v100, v102
    v_permlane16_swap_b32 v101, v103
    v_permlane16_swap_b32 v104, v106
    v_permlane16_swap_b32 v105, v107
    v_permlane16_swap_b32 v108, v110
    v_permlane16_swap_b32 v109, v111
    v_permlane16_swap_b32 v112, v114
    v_permlane16_swap_b32 v113, v115
    v_mov_b32 v6, 1
    s_cmp_ge_u32 s34, 4
    s_cbranch_scc1 L_f_sig0
    s_mov_b64 exec, 1
    s_waitcnt vmcnt(0)
    buffer_atomic_add v6, off, s[16:19], s58 offset:0 sc1
    s_mov_b64 exec, -1
L_f_sig0:
    s_mov_b32 s38, 0
    s_waitcnt lgkmcnt(0)
    s_barrier
    ds_read_b128 v[140:143], v128 offset:0
    ds_read_b128 v[144:147], v128 offset:1024
    ds_read_b128 v[164:167], v128 offset:4096
    ds_read_b128 v[168:171], v128 offset:5120
    ds_read_b64_tr_b16 v[148:149], v136 offset:0
    ds_read_b64_tr_b16 v[150:151], v136 offset:1024
    ds_read_b64_tr_b16 v[152:153], v137 offset:0
    ds_read_b64_tr_b16 v[154:155], v137 offset:1024
    ds_read_b64_tr_b16 v[156:157], v138 offset:0
    ds_read_b64_tr_b16 v[158:159], v138 offset:1024
    ds_read_b64_tr_b16 v[160:161], v139 offset:0
    ds_read_b64_tr_b16 v[162:163], v139 offset:1024
    ds_read_b64_tr_b16 v[172:173], v136 offset:8192
    ds_read_b64_tr_b16 v[174:175], v136 offset:9216
    ds_read_b64_tr_b16 v[176:177], v137 offset:8192
    ds_read_b64_tr_b16 v[178:179], v137 offset:9216
    ds_read_b64_tr_b16 v[180:181], v138 offset:8192
    ds_read_b64_tr_b16 v[182:183], v138 offset:9216
    ds_read_b64_tr_b16 v[184:185], v139 offset:8192
    ds_read_b64_tr_b16 v[186:187], v139 offset:9216
    s_add_u32 s38, s38, 16384
    s_and_b32 s38, s38, 0x1ffff
    s_bfe_u32 s59, s38, 0xf0001
    v_add_u32 v136, s38, v132
    v_add_u32 v137, s38, v133
    v_add_u32 v138, s38, v134
    v_add_u32 v139, s38, v135
    v_add_u32 v128, s59, v124
    v_lshlrev_b32 v68, 16, v100
    v_and_b32 v69, 0xffff0000, v100
    v_lshlrev_b32 v70, 16, v101
    v_and_b32 v71, 0xffff0000, v101
    v_lshlrev_b32 v76, 16, v102
    v_and_b32 v77, 0xffff0000, v102
    v_lshlrev_b32 v78, 16, v103
    v_and_b32 v79, 0xffff0000, v103
    v_lshlrev_b32 v84, 16, v104
    v_and_b32 v85, 0xffff0000, v104
    v_lshlrev_b32 v86, 16, v105
    v_and_b32 v87, 0xffff0000, v105
    v_lshlrev_b32 v92, 16, v106
    v_and_b32 v93, 0xffff0000, v106
    v_lshlrev_b32 v94, 16, v107
    v_and_b32 v95, 0xffff0000, v107
    v_lshlrev_b32 v72, 16, v108
    v_and_b32 v73, 0xffff0000, v108
    v_lshlrev_b32 v74, 16, v109
    v_and_b32 v75, 0xffff0000, v109
    v_lshlrev_b32 v80, 16, v110
    v_and_b32 v81, 0xffff0000, v110
    v_lshlrev_b32 v82, 16, v111
    v_and_b32 v83, 0xffff0000, v111
    v_lshlrev_b32 v88, 16, v112
    v_and_b32 v89, 0xffff0000, v112
    v_lshlrev_b32 v90, 16, v113
    v_and_b32 v91, 0xffff0000, v113
    v_lshlrev_b32 v96, 16, v114
    v_and_b32 v97, 0xffff0000, v114
    v_lshlrev_b32 v98, 16, v115
    v_and_b32 v99, 0xffff0000, v115
    s_cmp_lt_u32 s34, 4
    s_cbranch_scc1 L_f_sig1
    s_mov_b64 exec, 1
    s_waitcnt vmcnt(0)
    buffer_atomic_add v6, off, s[16:19], s58 offset:256 sc1
    s_mov_b64 exec, -1
L_f_sig1:
    s_lshl_b32 s36, s33, 1
    s_add_u32 s36, s36, s55
    s_lshl_b32 s36, s36, 12
    s_lshl_b32 s37, s34, 1
    s_add_u32 s37, s37, s56
    s_lshl_b32 s37, s37, 8
    s_add_u32 s36, s36, s37
    s_add_u32 s58, s36, 55574528
    s_mov_b32 s48, 7
    s_waitcnt lgkmcnt(0)
L_f_oloop:
    s_barrier
    v_mfma_f32_16x16x32_bf16 v[68:71], v[148:151], v[140:143], v[68:71]
    ds_read_b128 v[188:191], v128 offset:0
    ds_read_b128 v[192:195], v128 offset:1024
    v_mfma_f32_16x16x32_bf16 v[72:75], v[148:151], v[144:147], v[72:75]
    ds_read_b128 v[212:215], v128 offset:4096
    s_add_u32 s38, s38, 16384
    v_mfma_f32_16x16x32_bf16 v[80:83], v[152:155], v[144:147], v[80:83]
    ds_read_b128 v[216:219], v128 offset:5120
    ds_read_b64_tr_b16 v[196:197], v136 offset:0
    v_mfma_f32_16x16x32_bf16 v[76:79], v[152:155], v[140:143], v[76:79]
    ds_read_b64_tr_b16 v[198:199], v136 offset:1024
    s_and_b32 s38, s38, 0x1ffff
    v_mfma_f32_16x16x32_bf16 v[84:87], v[156:159], v[140:143], v[84:87]
    ds_read_b64_tr_b16 v[200:201], v137 offset:0
    ds_read_b64_tr_b16 v[202:203], v137 offset:1024
    v_mfma_f32_16x16x32_bf16 v[88:91], v[156:159], v[144:147], v[88:91]
    ds_read_b64_tr_b16 v[204:205], v138 offset:0
    s_bfe_u32 s59, s38, 0xf0001
    v_mfma_f32_16x16x32_bf16 v[96:99], v[160:163], v[144:147], v[96:99]
    ds_read_b64_tr_b16 v[206:207], v138 offset:1024
    ds_read_b64_tr_b16 v[208:209], v139 offset:0
    v_mfma_f32_16x16x32_bf16 v[92:95], v[160:163], v[140:143], v[92:95]
    ds_read_b64_tr_b16 v[210:211], v139 offset:1024
    s_waitcnt lgkmcnt(12)
    v_mfma_f32_16x16x32_bf16 v[68:71], v[172:175], v[164:167], v[68:71]
    ds_read_b64_tr_b16 v[220:221], v136 offset:8192
    v_add_u32 v128, s59, v124
    v_mfma_f32_16x16x32_bf16 v[72:75], v[172:175], v[168:171], v[72:75]
    ds_read_b64_tr_b16 v[222:223], v136 offset:9216
    v_add_u32 v136, s38, v132
    v_mfma_f32_16x16x32_bf16 v[80:83], v[176:179], v[168:171], v[80:83]
    ds_read_b64_tr_b16 v[224:225], v137 offset:8192
    v_mfma_f32_16x16x32_bf16 v[76:79], v[176:179], v[164:167], v[76:79]
    ds_read_b64_tr_b16 v[226:227], v137 offset:9216
    v_add_u32 v137, s38, v133
    v_mfma_f32_16x16x32_bf16 v[84:87], v[180:183], v[164:167], v[84:87]
    ds_read_b64_tr_b16 v[228:229], v138 offset:8192
    v_mfma_f32_16x16x32_bf16 v[88:91], v[180:183], v[168:171], v[88:91]
    ds_read_b64_tr_b16 v[230:231], v138 offset:9216
    v_add_u32 v138, s38, v134
    v_mfma_f32_16x16x32_bf16 v[96:99], v[184:187], v[168:171], v[96:99]
    ds_read_b64_tr_b16 v[232:233], v139 offset:8192
    v_mfma_f32_16x16x32_bf16 v[92:95], v[184:187], v[164:167], v[92:95]
    ds_read_b64_tr_b16 v[234:235], v139 offset:9216
    v_add_u32 v139, s38, v135
    s_waitcnt lgkmcnt(8)
    s_barrier
    v_mfma_f32_16x16x32_bf16 v[68:71], v[196:199], v[188:191], v[68:71]
    ds_read_b128 v[140:143], v128 offset:0
    ds_read_b128 v[144:147], v128 offset:1024
    v_mfma_f32_16x16x32_bf16 v[72:75], v[196:199], v[192:195], v[72:75]
    ds_read_b128 v[164:167], v128 offset:4096
    s_add_u32 s38, s38, 16384
    v_mfma_f32_16x16x32_bf16 v[80:83], v[200:203], v[192:195], v[80:83]
    ds_read_b128 v[168:171], v128 offset:5120
    ds_read_b64_tr_b16 v[148:149], v136 offset:0
    v_mfma_f32_16x16x32_bf16 v[76:79], v[200:203], v[188:191], v[76:79]
    ds_read_b64_tr_b16 v[150:151], v136 offset:1024
    s_and_b32 s38, s38, 0x1ffff
    v_mfma_f32_16x16x32_bf16 v[84:87], v[204:207], v[188:191], v[84:87]
    ds_read_b64_tr_b16 v[152:153], v137 offset:0
    ds_read_b64_tr_b16 v[154:155], v137 offset:1024
    v_mfma_f32_16x16x32_bf16 v[88:91], v[204:207], v[192:195], v[88:91]
    ds_read_b64_tr_b16 v[156:157], v138 offset:0
    s_bfe_u32 s59, s38, 0xf0001
    v_mfma_f32_16x16x32_bf16 v[96:99], v[208:211], v[192:195], v[96:99]
    ds_read_b64_tr_b16 v[158:159], v138 offset:1024
    ds_read_b64_tr_b16 v[160:161], v139 offset:0
    v_mfma_f32_16x16x32_bf16 v[92:95], v[208:211], v[188:191], v[92:95]
    ds_read_b64_tr_b16 v[162:163], v139 offset:1024
    s_waitcnt lgkmcnt(12)
    v_mfma_f32_16x16x32_bf16 v[68:71], v[220:223], v[212:215], v[68:71]
    ds_read_b64_tr_b16 v[172:173], v136 offset:8192
    v_add_u32 v128, s59, v124
    v_mfma_f32_16x16x32_bf16 v[72:75], v[220:223], v[216:219], v[72:75]
    ds_read_b64_tr_b16 v[174:175], v136 offset:9216
    v_add_u32 v136, s38, v132
    v_mfma_f32_16x16x32_bf16 v[80:83], v[224:227], v[216:219], v[80:83]
    ds_read_b64_tr_b16 v[176:177], v137 offset:8192
    s_sub_u32 s48, s48, 1
    v_mfma_f32_16x16x32_bf16 v[76:79], v[224:227], v[212:215], v[76:79]
    ds_read_b64_tr_b16 v[178:179], v137 offset:9216
    v_add_u32 v137, s38, v133
    v_mfma_f32_16x16x32_bf16 v[84:87], v[228:231], v[212:215], v[84:87]
    ds_read_b64_tr_b16 v[180:181], v138 offset:8192
    s_cmp_lg_u32 s48, 0
    v_mfma_f32_16x16x32_bf16 v[88:91], v[228:231], v[216:219], v[88:91]
    ds_read_b64_tr_b16 v[182:183], v138 offset:9216
    v_add_u32 v138, s38, v134
    v_mfma_f32_16x16x32_bf16 v[96:99], v[232:235], v[216:219], v[96:99]
    ds_read_b64_tr_b16 v[184:185], v139 offset:8192
    v_mfma_f32_16x16x32_bf16 v[92:95], v[232:235], v[212:215], v[92:95]
    ds_read_b64_tr_b16 v[186:187], v139 offset:9216
    v_add_u32 v139, s38, v135
    s_waitcnt lgkmcnt(8)
    s_cbranch_scc1 L_f_oloop
    s_barrier
    v_mfma_f32_16x16x32_bf16 v[68:71], v[148:151], v[140:143], v[68:71]
    ds_read_b128 v[188:191], v128 offset:0
    ds_read_b128 v[192:195], v128 offset:1024
    v_mfma_f32_16x16x32_bf16 v[72:75], v[148:151], v[144:147], v[72:75]
    ds_read_b128 v[212:215], v128 offset:4096
    v_mfma_f32_16x16x32_bf16 v[80:83], v[152:155], v[144:147], v[80:83]
    ds_read_b128 v[216:219], v128 offset:5120
    ds_read_b64_tr_b16 v[196:197], v136 offset:0
    v_mfma_f32_16x16x32_bf16 v[76:79], v[152:155], v[140:143], v[76:79]
    ds_read_b64_tr_b16 v[198:199], v136 offset:1024
    v_mfma_f32_16x16x32_bf16 v[84:87], v[156:159], v[140:143], v[84:87]
    ds_read_b64_tr_b16 v[200:201], v137 offset:0
    ds_read_b64_tr_b16 v[202:203], v137 offset:1024
    v_mfma_f32_16x16x32_bf16 v[88:91], v[156:159], v[144:147], v[88:91]
    ds_read_b64_tr_b16 v[204:205], v138 offset:0
    v_mfma_f32_16x16x32_bf16 v[96:99], v[160:163], v[144:147], v[96:99]
    ds_read_b64_tr_b16 v[206:207], v138 offset:1024
    ds_read_b64_tr_b16 v[208:209], v139 offset:0
    v_mfma_f32_16x16x32_bf16 v[92:95], v[160:163], v[140:143], v[92:95]
    ds_read_b64_tr_b16 v[210:211], v139 offset:1024
    s_waitcnt lgkmcnt(12)
    v_mfma_f32_16x16x32_bf16 v[68:71], v[172:175], v[164:167], v[68:71]
    ds_read_b64_tr_b16 v[220:221], v136 offset:8192
    v_mfma_f32_16x16x32_bf16 v[72:75], v[172:175], v[168:171], v[72:75]
    ds_read_b64_tr_b16 v[222:223], v136 offset:9216
    v_mfma_f32_16x16x32_bf16 v[80:83], v[176:179], v[168:171], v[80:83]
    ds_read_b64_tr_b16 v[224:225], v137 offset:8192
    v_mfma_f32_16x16x32_bf16 v[76:79], v[176:179], v[164:167], v[76:79]
    ds_read_b64_tr_b16 v[226:227], v137 offset:9216
    v_mfma_f32_16x16x32_bf16 v[84:87], v[180:183], v[164:167], v[84:87]
    ds_read_b64_tr_b16 v[228:229], v138 offset:8192
    v_mfma_f32_16x16x32_bf16 v[88:91], v[180:183], v[168:171], v[88:91]
    ds_read_b64_tr_b16 v[230:231], v138 offset:9216
    v_mfma_f32_16x16x32_bf16 v[96:99], v[184:187], v[168:171], v[96:99]
    ds_read_b64_tr_b16 v[232:233], v139 offset:8192
    v_mfma_f32_16x16x32_bf16 v[92:95], v[184:187], v[164:167], v[92:95]
    ds_read_b64_tr_b16 v[234:235], v139 offset:9216
    s_waitcnt lgkmcnt(8)
    v_mfma_f32_16x16x32_bf16 v[68:71], v[196:199], v[188:191], v[68:71]
    v_mfma_f32_16x16x32_bf16 v[72:75], v[196:199], v[192:195], v[72:75]
    v_mfma_f32_16x16x32_bf16 v[80:83], v[200:203], v[192:195], v[80:83]
    v_mfma_f32_16x16x32_bf16 v[76:79], v[200:203], v[188:191], v[76:79]
    v_mfma_f32_16x16x32_bf16 v[84:87], v[204:207], v[188:191], v[84:87]
    v_mfma_f32_16x16x32_bf16 v[88:91], v[204:207], v[192:195], v[88:91]
    v_mfma_f32_16x16x32_bf16 v[96:99], v[208:211], v[192:195], v[96:99]
    v_mfma_f32_16x16x32_bf16 v[92:95], v[208:211], v[188:191], v[92:95]
    s_waitcnt lgkmcnt(0)
    v_mfma_f32_16x16x32_bf16 v[68:71], v[220:223], v[212:215], v[68:71]
    v_mfma_f32_16x16x32_bf16 v[72:75], v[220:223], v[216:219], v[72:75]
    v_mfma_f32_16x16x32_bf16 v[80:83], v[224:227], v[216:219], v[80:83]
    v_mfma_f32_16x16x32_bf16 v[76:79], v[224:227], v[212:215], v[76:79]
    v_mfma_f32_16x16x32_bf16 v[84:87], v[228:231], v[212:215], v[84:87]
    v_mfma_f32_16x16x32_bf16 v[88:91], v[228:231], v[216:219], v[88:91]
    v_mfma_f32_16x16x32_bf16 v[96:99], v[232:235], v[216:219], v[96:99]
    v_mfma_f32_16x16x32_bf16 v[92:95], v[232:235], v[212:215], v[92:95]
    s_nop 3
    v_cvt_pk_bf16_f32 v12, v68, v69
    v_cvt_pk_bf16_f32 v13, v70, v71
    v_cvt_pk_bf16_f32 v14, v76, v77
    v_cvt_pk_bf16_f32 v15, v78, v79
    v_cvt_pk_bf16_f32 v16, v72, v73
    v_cvt_pk_bf16_f32 v17, v74, v75
    v_cvt_pk_bf16_f32 v18, v80, v81
    v_cvt_pk_bf16_f32 v19, v82, v83
    s_nop 0
    v_permlane16_swap_b32 v12, v14
    v_permlane16_swap_b32 v13, v15
    buffer_store_dwordx4 v[12:15], v254, s[16:19], s60 offen offset:0 sc1
    v_permlane16_swap_b32 v16, v18
    v_permlane16_swap_b32 v17, v19
    buffer_store_dwordx4 v[16:19], v254, s[16:19], s60 offen offset:1024 sc1
    v_cvt_pk_bf16_f32 v20, v84, v85
    v_cvt_pk_bf16_f32 v21, v86, v87
    v_cvt_pk_bf16_f32 v22, v92, v93
    v_cvt_pk_bf16_f32 v23, v94, v95
    v_cvt_pk_bf16_f32 v24, v88, v89
    v_cvt_pk_bf16_f32 v25, v90, v91
    v_cvt_pk_bf16_f32 v26, v96, v97
    v_cvt_pk_bf16_f32 v27, v98, v99
    s_nop 0
    v_permlane16_swap_b32 v20, v22
    v_permlane16_swap_b32 v21, v23
    buffer_store_dwordx4 v[20:23], v254, s[16:19], s61 offen offset:0 sc1
    v_permlane16_swap_b32 v24, v26
    v_permlane16_swap_b32 v25, v27
    buffer_store_dwordx4 v[24:27], v254, s[16:19], s61 offen offset:1024 sc1
    v_pk_mul_f32 v[30:31], v[68:69], v[68:69]
    v_pk_mul_f32 v[34:35], v[72:73], v[72:73]
    v_pk_add_f32 v[28:29], v[68:69], v[70:71]
    v_pk_fma_f32 v[30:31], v[70:71], v[70:71], v[30:31]
    v_pk_add_f32 v[32:33], v[72:73], v[74:75]
    v_pk_fma_f32 v[34:35], v[74:75], v[74:75], v[34:35]
    v_pk_add_f32 v[28:29], v[28:29], v[76:77]
    v_pk_fma_f32 v[30:31], v[76:77], v[76:77], v[30:31]
    v_pk_add_f32 v[32:33], v[32:33], v[80:81]
    v_pk_fma_f32 v[34:35], v[80:81], v[80:81], v[34:35]
    v_pk_add_f32 v[28:29], v[28:29], v[78:79]
    v_pk_fma_f32 v[30:31], v[78:79], v[78:79], v[30:31]
    v_pk_add_f32 v[32:33], v[32:33], v[82:83]
    v_pk_fma_f32 v[34:35], v[82:83], v[82:83], v[34:35]
    v_pk_add_f32 v[28:29], v[28:29], v[84:85]
    v_pk_fma_f32 v[30:31], v[84:85], v[84:85], v[30:31]
    v_pk_add_f32 v[32:33], v[32:33], v[88:89]
    v_pk_fma_f32 v[34:35], v[88:89], v[88:89], v[34:35]
    v_pk_add_f32 v[28:29], v[28:29], v[86:87]
    v_pk_fma_f32 v[30:31], v[86:87], v[86:87], v[30:31]
    v_pk_add_f32 v[32:33], v[32:33], v[90:91]
    v_pk_fma_f32 v[34:35], v[90:91], v[90:91], v[34:35]
    v_pk_add_f32 v[28:29], v[28:29], v[92:93]
    v_pk_fma_f32 v[30:31], v[92:93], v[92:93], v[30:31]
    v_pk_add_f32 v[32:33], v[32:33], v[96:97]
    v_pk_fma_f32 v[34:35], v[96:97], v[96:97], v[34:35]
    v_pk_add_f32 v[28:29], v[28:29], v[94:95]
    v_pk_fma_f32 v[30:31], v[94:95], v[94:95], v[30:31]
    v_pk_add_f32 v[32:33], v[32:33], v[98:99]
    v_pk_fma_f32 v[34:35], v[98:99], v[98:99], v[34:35]
    v_add_f32 v28, v28, v29
    v_add_f32 v29, v30, v31
    v_add_f32 v32, v32, v33
    v_add_f32 v33, v34, v35
    v_lshrrev_b32 v6, 6, v254
    v_permlane32_swap_b32 v28, v29
    v_permlane32_swap_b32 v32, v33
    s_nop 0
    v_add_f32 v28, v28, v29
    v_add_f32 v32, v32, v33
    v_and_b32 v6, 12, v6
    v_lshl_add_u32 v6, v5, 4, v6
    v_permlane16_swap_b32 v28, v32
    s_nop 0
    v_add_f32 v28, v28, v32
    buffer_store_dword v28, v6, s[16:19], s58 offen sc1
L_end_attn_kernel:
    s_endpgm
.p2align 12
.fill 256, 4, 0xbf800000
L_isl3:
    s_branch L_f_back
L_isl3_over:
L_f_setup:
    s_cmp_eq_u32 s32, 0
    s_cbranch_scc1 L_isl0
    s_cmp_eq_u32 s32, 1
    s_cbranch_scc1 L_isl1
L_f_back:
    s_waitcnt lgkmcnt(0)
    s_mov_b32 s18, 75497472
    s_mov_b32 s19, 0x00020000
    s_add_u32 s72, s16, 4194304
    s_addc_u32 s73, s17, 0
    s_mov_b32 s74, 262144
    s_mov_b32 s75, 0x00020000
    s_lshl_b32 s44, s2, 2
    s_add_u32 s44, s44, s32
    s_lshl_b32 s64, s32, 12
    s_add_u32 s64, s64, 16384
    v_lshrrev_b32 v6, 4, v1
    v_lshlrev_b32 v6, 10, v6
    v_bfe_u32 v7, v1, 2, 2
    v_lshl_add_u32 v6, v7, 7, v6
    v_bfe_u32 v7, v1, 3, 1
    v_lshl_add_u32 v6, v7, 6, v6
    v_add_u32 v6, s64, v6
    v_and_b32 v7, 3, v1
    v_lshl_add_u32 v26, v7, 4, v6
    v_xor_b32 v27, 64, v26
    s_lshr_b32 s66, s44, 3
    s_and_b32 s67, s44, 7
    s_lshl_b32 s67, s67, 2
    s_cmp_ge_u32 s66, 112
    s_cbranch_scc1 L_k1_wo
    s_cmp_ge_u32 s66, 56
    s_cselect_b32 s68, 1, 0
    s_cselect_b32 s76, s26, s24
    s_cselect_b32 s77, s27, s25
    s_mul_i32 s36, s68, 56
    s_sub_u32 s66, s66, s36
    s_mov_b32 s78, 7340032
    s_mov_b32 s45, 7168
    s_mov_b32 s46, 14336
    s_mov_b32 s63, 7340032
    v_lshl_add_u32 v22, v7, 3, v6
    v_xor_b32 v23, 32, v22
    v_xor_b32 v24, 64, v22
    v_xor_b32 v25, 96, v22
    s_lshl_b32 s69, s66, 2
    s_add_u32 s69, s69, 0
    s_mul_i32 s70, s69, 9363
    s_lshr_b32 s70, s70, 16
    s_sub_u32 s71, s68, s70
    s_mul_i32 s71, s71, 7
    s_add_u32 s71, s69, s71
    s_lshl_b32 s36, s70, 5
    s_add_u32 s36, s36, s67
    s_mul_i32 s36, s36, 14
    s_add_u32 s36, s36, s71
    s_lshl_b32 s36, s36, 10
    s_add_u32 s50, s36, 31457280
    s_lshl_b32 s36, s67, 3
    s_add_u32 s36, s36, s70
    s_mul_i32 s36, s36, 14
    s_add_u32 s36, s36, s71
    s_lshl_b32 s36, s36, 6
    s_add_u32 s58, s36, 54525952
    s_lshl_b32 s69, s66, 2
    s_add_u32 s69, s69, 1
    s_mul_i32 s70, s69, 9363
    s_lshr_b32 s70, s70, 16
    s_sub_u32 s71, s68, s70
    s_mul_i32 s71, s71, 7
    s_add_u32 s71, s69, s71
    s_lshl_b32 s36, s70, 5
    s_add_u32 s36, s36, s67
    s_mul_i32 s36, s36, 14
    s_add_u32 s36, s36, s71
    s_lshl_b32 s36, s36, 10
    s_add_u32 s51, s36, 31457280
    s_lshl_b32 s36, s67, 3
    s_add_u32 s36, s36, s70
    s_mul_i32 s36, s36, 14
    s_add_u32 s36, s36, s71
    s_lshl_b32 s36, s36, 6
    s_add_u32 s59, s36, 54525952
    s_lshl_b32 s69, s66, 2
    s_add_u32 s69, s69, 2
    s_mul_i32 s70, s69, 9363
    s_lshr_b32 s70, s70, 16
    s_sub_u32 s71, s68, s70
    s_mul_i32 s71, s71, 7
    s_add_u32 s71, s69, s71
    s_lshl_b32 s36, s70, 5
    s_add_u32 s36, s36, s67
    s_mul_i32 s36, s36, 14
    s_add_u32 s36, s36, s71
    s_lshl_b32 s36, s36, 10
    s_add_u32 s52, s36, 31457280
    s_lshl_b32 s36, s67, 3
    s_add_u32 s36, s36, s70
    s_mul_i32 s36, s36, 14
    s_add_u32 s36, s36, s71
    s_lshl_b32 s36, s36, 6
    s_add_u32 s60, s36, 54525952
    s_lshl_b32 s69, s66, 2
    s_add_u32 s69, s69, 3
    s_mul_i32 s70, s69, 9363
    s_lshr_b32 s70, s70, 16
    s_sub_u32 s71, s68, s70
    s_mul_i32 s71, s71, 7
    s_add_u32 s71, s69, s71
    s_lshl_b32 s36, s70, 5
    s_add_u32 s36, s36, s67
    s_mul_i32 s36, s36, 14
    s_add_u32 s36, s36, s71
    s_lshl_b32 s36, s36, 10
    s_add_u32 s53, s36, 31457280
    s_lshl_b32 s36, s67, 3
    s_add_u32 s36, s36, s70
    s_mul_i32 s36, s36, 14
    s_add_u32 s36, s36, s71
    s_lshl_b32 s36, s36, 6
    s_add_u32 s61, s36, 54525952
    s_branch L_k1_jp
L_k1_wo:
    s_mov_b32 s76, s24
    s_mov_b32 s77, s25
    s_mov_b32 s78, 0
    s_mov_b32 s45, 2048
    s_mov_b32 s46, 0
    s_mov_b32 s63, 0
    s_mov_b32 s50, 1073741824
    s_mov_b32 s58, 1073741824
    v_mov_b32 v22, v26
    s_mov_b32 s51, 1073741824
    s_mov_b32 s59, 1073741824
    v_mov_b32 v23, v26
    s_mov_b32 s52, 1073741824
    s_mov_b32 s60, 1073741824
    v_mov_b32 v24, v26
    s_mov_b32 s53, 1073741824
    s_mov_b32 s61, 1073741824
    v_mov_b32 v25, v26
L_k1_jp:
    s_mov_b32 s79, 0x00020000
    v_lshrrev_b32 v6, 3, v1
    v_bfe_u32 v7, v1, 4, 1
    v_lshlrev_b32 v7, 2, v7
    v_and_b32 v8, 7, v1
    v_xor_b32 v7, v7, v8
    v_lshlrev_b32 v7, 4, v7
    v_mul_lo_u32 v18, v6, s45
    v_lshl_add_u32 v19, v6, 11, v7
    v_add_u32 v18, v18, v7
    s_lshl_b32 s36, s67, 5
    s_mul_i32 s36, s36, s45
    s_lshl_b32 s37, s66, 7
    s_add_u32 s36, s36, s37
    v_add_u32 v18, s36, v18
    s_lshl_b32 s36, s45, 3
    s_sub_u32 s42, s36, 1024
    s_add_u32 s43, s36, 3072
    s_mov_b32 s41, 0
    s_mul_i32 s66, s44, 1171
    s_lshr_b32 s66, s66, 16
    s_mul_i32 s36, s66, 56
    s_sub_u32 s67, s44, s36
    s_lshl_b32 s67, s67, 1
    s_cmp_ge_u32 s67, 48
    s_cselect_b32 s69, 48, 0
    s_cselect_b32 s70, 8, 0
    s_sub_u32 s69, s67, s69
    s_and_b32 s71, s69, 7
    s_add_u32 s70, s70, s71
    s_lshr_b32 s69, s69, 3
    s_sub_u32 s71, s67, 96
    s_cmp_ge_u32 s67, 96
    s_cselect_b32 s69, 6, s69
    s_cselect_b32 s70, s71, s70
    s_mul_i32 s70, s70, 14
    s_add_u32 s36, s70, s69
    s_lshl_b32 s36, s36, 15
    s_lshl_b32 s37, s66, 7
    s_add_u32 s36, s36, s37
    v_add_u32 v19, s36, v19
    s_lshr_b32 s36, s66, 1
    s_mul_i32 s36, s36, 112
    s_add_u32 s36, s36, s67
    s_lshl_b32 s36, s36, 1
    s_and_b32 s37, s66, 1
    s_add_u32 s36, s36, s37
    s_lshl_b32 s36, s36, 12
    s_add_u32 s62, s36, 46137344
    s_cmp_eq_u32 s63, 0
    s_cselect_b32 s62, 1073741824, s62
    v_and_b32 v6, 15, v1
    v_cmp_eq_u32 vcc, 0, v6
    v_mov_b32 v7, 1073741824
    s_nop 0
    v_cndmask_b32 v20, v7, v1, vcc
    v_mov_b32 v120, 0x3f803f80
    v_mov_b32 v121, 0x3f803f80
    v_mov_b32 v122, 0x3f803f80
    v_mov_b32 v123, 0x3f803f80
    v_lshlrev_b32 v21, 2, v1
    s_barrier
    s_add_u32 m0, s39, 0
    s_nop 0
    buffer_load_dwordx4 v12, s[4:7], s49 offen lds
    s_add_u32 m0, s39, 4096
    s_nop 0
    buffer_load_dwordx4 v13, s[4:7], s49 offen lds
    s_add_u32 s49, s49, 128
    s_and_b32 s49, s49, 2047
    s_add_u32 s36, s39, s57
    s_add_u32 m0, s36, 0
    s_nop 0
    buffer_load_dwordx4 v14, s[8:11], s54 offen lds
    s_add_u32 m0, s36, 4096
    s_nop 0
    buffer_load_dwordx4 v15, s[8:11], s54 offen lds
    s_add_u32 m0, s36, 8192
    s_nop 0
    buffer_load_dwordx4 v16, s[8:11], s54 offen lds
    s_add_u32 m0, s36, 12288
    s_nop 0
    buffer_load_dwordx4 v17, s[8:11], s54 offen lds
    s_add_u32 s54, s54, 0x20000
    s_and_b32 s54, s54, 0x1fffff
    s_add_u32 m0, s39, 24576
    s_nop 0
    buffer_load_dwordx4 v12, s[4:7], s49 offen lds
    s_add_u32 m0, s39, 28672
    s_nop 0
    buffer_load_dwordx4 v13, s[4:7], s49 offen lds
    s_add_u32 s49, s49, 128
    s_and_b32 s49, s49, 2047
    s_add_u32 s36, s39, s57
    s_add_u32 m0, s36, 24576
    s_nop 0
    buffer_load_dwordx4 v14, s[8:11], s54 offen lds
    s_add_u32 m0, s36, 28672
    s_nop 0
    buffer_load_dwordx4 v15, s[8:11], s54 offen lds
    s_add_u32 m0, s36, 32768
    s_nop 0
    buffer_load_dwordx4 v16, s[8:11], s54 offen lds
    s_add_u32 m0, s36, 36864
    s_nop 0
    buffer_load_dwordx4 v17, s[8:11], s54 offen lds
    s_add_u32 s54, s54, 0x20000
    s_and_b32 s54, s54, 0x1fffff
    s_waitcnt vmcnt(6)
    s_barrier
    s_add_u32 m0, s39, 49152
    s_nop 0
    buffer_load_dwordx4 v12, s[4:7], s49 offen lds
    s_add_u32 m0, s39, 53248
    s_nop 0
    buffer_load_dwordx4 v13, s[4:7], s49 offen lds
    s_add_u32 s49, s49, 128
    s_and_b32 s49, s49, 2047
    s_add_u32 s36, s39, s57
    s_add_u32 m0, s36, 49152
    s_nop 0
    buffer_load_dwordx4 v14, s[8:11], s54 offen lds
    s_add_u32 m0, s36, 53248
    s_nop 0
    buffer_load_dwordx4 v15, s[8:11], s54 offen lds
    s_add_u32 m0, s36, 57344
    s_nop 0
    buffer_load_dwordx4 v16, s[8:11], s54 offen lds
    s_add_u32 m0, s36, 61440
    s_nop 0
    buffer_load_dwordx4 v17, s[8:11], s54 offen lds
    s_add_u32 s54, s54, 0x20000
    s_and_b32 s54, s54, 0x1fffff
    s_add_u32 m0, s39, 73728
    s_nop 0
    buffer_load_dwordx4 v12, s[4:7], s49 offen lds
    s_add_u32 m0, s39, 77824
    s_nop 0
    buffer_load_dwordx4 v13, s[4:7], s49 offen lds
    s_add_u32 s49, s49, 128
    s_and_b32 s49, s49, 2047
    s_add_u32 s36, s39, s57
    s_add_u32 m0, s36, 73728
    s_nop 0
    buffer_load_dwordx4 v14, s[8:11], s54 offen lds
    s_add_u32 m0, s36, 77824
    s_nop 0
    buffer_load_dwordx4 v15, s[8:11], s54 offen lds
    s_add_u32 m0, s36, 81920
    s_nop 0
    buffer_load_dwordx4 v16, s[8:11], s54 offen lds
    s_add_u32 m0, s36, 86016
    s_nop 0
    buffer_load_dwordx4 v17, s[8:11], s54 offen lds
    s_add_u32 s54, s54, 0x20000
    s_and_b32 s54, s54, 0x1fffff
    s_waitcnt vmcnt(12)
    s_barrier
L_f_ld2:
    s_add_u32 m0, s39, 0
    s_nop 0
    buffer_load_dwordx4 v12, s[4:7], s49 offen lds
    s_add_u32 m0, s39, 4096
    s_nop 0
    buffer_load_dwordx4 v13, s[4:7], s49 offen lds
    s_add_u32 s49, s49, 128
    s_and_b32 s49, s49, 2047
    s_add_u32 s36, s39, s57
    s_add_u32 m0, s36, 0
    s_nop 0
    buffer_load_dwordx4 v14, s[8:11], s54 offen lds
    s_add_u32 m0, s36, 4096
    s_nop 0
    buffer_load_dwordx4 v15, s[8:11], s54 offen lds
    s_add_u32 m0, s36, 8192
    s_nop 0
    buffer_load_dwordx4 v16, s[8:11], s54 offen lds
    s_add_u32 m0, s36, 12288
    s_nop 0
    buffer_load_dwordx4 v17, s[8:11], s54 offen lds
    s_add_u32 s54, s54, 0x20000
    s_and_b32 s54, s54, 0x1fffff
    s_add_u32 s39, s39, 24576
    s_cmp_ge_u32 s39, 98304
    s_cselect_b32 s36, 98304, 0
    s_sub_u32 s39, s39, s36
    s_sub_u32 s48, s48, 1
    s_cmp_lg_u32 s48, 0
    s_waitcnt vmcnt(12)
    s_barrier
    s_cbranch_scc1 L_f_ld2
    s_lshl_b32 s40, s32, 13
    s_add_u32 s39, s40, 65536
    s_mov_b32 s48, 1048576
    s_cmp_eq_u32 s32, 0
    s_cbranch_scc1 L_f_poll0
    s_waitcnt vmcnt(6)
    s_barrier
    s_waitcnt vmcnt(0)
    s_branch L_f_polled
L_f_poll0:
    global_load_dword v60, v21, s[30:31] sc1
    s_waitcnt vmcnt(7)
    s_barrier
L_f_poll:
    s_waitcnt vmcnt(0)
    v_cmp_ne_u32 vcc, 4, v60
    s_sub_u32 s48, s48, 1
    s_cbranch_scc1 L_f_polled
    s_cbranch_vccz L_f_polled
    s_sleep 2
    global_load_dword v60, v21, s[30:31] sc1
    s_branch L_f_poll
L_f_polled:
    s_barrier
    s_add_u32 m0, s39, 32768
    s_nop 0
    buffer_load_dwordx4 v9, s[72:75], s40 offen offset:0 sc1 lds
    buffer_load_dwordx4 v9, s[72:75], s40 offen offset:1024 sc1 lds
    buffer_load_dwordx4 v9, s[72:75], s40 offen offset:2048 sc1 lds
    buffer_load_dwordx4 v9, s[72:75], s40 offen offset:3072 sc1 lds
    s_add_u32 s40, s40, 4096
    s_add_u32 m0, s39, 36864
    s_nop 0
    buffer_load_dwordx4 v9, s[72:75], s40 offen offset:0 sc1 lds
    buffer_load_dwordx4 v9, s[72:75], s40 offen offset:1024 sc1 lds
    buffer_load_dwordx4 v9, s[72:75], s40 offen offset:2048 sc1 lds
    buffer_load_dwordx4 v9, s[72:75], s40 offen offset:3072 sc1 lds
    s_add_u32 s40, s40, 28672
    s_and_b32 s40, s40, 0x3ffff
    s_waitcnt vmcnt(0)
    s_barrier
    s_mov_b32 s8, s20
    s_mov_b32 s9, s21
    s_lshl_b32 s57, s55, 1
    s_add_u32 s57, s57, s56
    s_lshl_b32 s57, s57, 10
    s_lshl_b32 s38, s32, 11
    s_lshl_b32 s47, s33, 17
    s_add_u32 s47, s47, s38
    s_add_u32 s47, s47, 5242880
    s_add_u32 m0, s39, 65536
    s_nop 0
    buffer_load_dwordx4 v9, s[72:75], s40 offen offset:0 sc1 lds
    buffer_load_dwordx4 v9, s[72:75], s40 offen offset:1024 sc1 lds
    buffer_load_dwordx4 v9, s[72:75], s40 offen offset:2048 sc1 lds
    buffer_load_dwordx4 v9, s[72:75], s40 offen offset:3072 sc1 lds
    s_add_u32 s40, s40, 4096
    s_add_u32 m0, s39, 69632
    s_nop 0
    buffer_load_dwordx4 v9, s[72:75], s40 offen offset:0 sc1 lds
    buffer_load_dwordx4 v9, s[72:75], s40 offen offset:1024 sc1 lds
    buffer_load_dwordx4 v9, s[72:75], s40 offen offset:2048 sc1 lds
    buffer_load_dwordx4 v9, s[72:75], s40 offen offset:3072 sc1 lds
    s_add_u32 s40, s40, 28672
    s_and_b32 s40, s40, 0x3ffff
    s_add_u32 m0, s39, 0
    s_nop 0
    buffer_load_dwordx4 v9, s[72:75], s40 offen offset:0 sc1 lds
    buffer_load_dwordx4 v9, s[72:75], s40 offen offset:1024 sc1 lds
    buffer_load_dwordx4 v9, s[72:75], s40 offen offset:2048 sc1 lds
    buffer_load_dwordx4 v9, s[72:75], s40 offen offset:3072 sc1 lds
    s_add_u32 s40, s40, 4096
    s_add_u32 m0, s39, 4096
    s_nop 0
    buffer_load_dwordx4 v9, s[72:75], s40 offen offset:0 sc1 lds
    buffer_load_dwordx4 v9, s[72:75], s40 offen offset:1024 sc1 lds
    buffer_load_dwordx4 v9, s[72:75], s40 offen offset:2048 sc1 lds
    buffer_load_dwordx4 v9, s[72:75], s40 offen offset:3072 sc1 lds
    s_add_u32 s40, s40, 28672
    s_and_b32 s40, s40, 0x3ffff
    s_lshl_b32 s36, s44, 12
    s_add_u32 s36, s36, 0
    v_mov_b64 v[60:61], -1
    v_mov_b64 v[62:63], -1
    buffer_store_dwordx4 v[60:63], v9, s[16:19], s36 offen offset:0 sc1
    buffer_store_dwordx4 v[60:63], v9, s[16:19], s36 offen offset:1024 sc1
    buffer_store_dwordx4 v[60:63], v9, s[16:19], s36 offen offset:2048 sc1
    buffer_store_dwordx4 v[60:63], v9, s[16:19], s36 offen offset:3072 sc1
    s_mov_b32 m0, s64
    s_nop 0
    buffer_load_dwordx4 v18, s[76:79], s41 offen offset:0 lds
    s_add_u32 s41, s41, s42
    buffer_load_dwordx4 v18, s[76:79], s41 offen offset:1024 lds
    s_add_u32 s41, s41, s42
    buffer_load_dwordx4 v18, s[76:79], s41 offen offset:2048 lds
    s_add_u32 s41, s41, s42
    buffer_load_dwordx4 v18, s[76:79], s41 offen offset:3072 lds
    s_add_u32 s41, s41, s43
    s_waitcnt vmcnt(16)
    s_barrier
    s_add_u32 m0, s39, 32768
    s_nop 0
    buffer_load_dwordx4 v9, s[72:75], s40 offen offset:0 sc1 lds
    buffer_load_dwordx4 v9, s[72:75], s40 offen offset:1024 sc1 lds
    buffer_load_dwordx4 v9, s[72:75], s40 offen offset:2048 sc1 lds
    buffer_load_dwordx4 v9, s[72:75], s40 offen offset:3072 sc1 lds
    s_add_u32 s40, s40, 4096
    s_add_u32 m0, s39, 36864
    s_nop 0
    buffer_load_dwordx4 v9, s[72:75], s40 offen offset:0 sc1 lds
    buffer_load_dwordx4 v9, s[72:75], s40 offen offset:1024 sc1 lds
    buffer_load_dwordx4 v9, s[72:75], s40 offen offset:2048 sc1 lds
    buffer_load_dwordx4 v9, s[72:75], s40 offen offset:3072 sc1 lds
    s_add_u32 s40, s40, 28672
    s_and_b32 s40, s40, 0x3ffff
    s_waitcnt vmcnt(8)
    ds_read_b64_tr_b16 v[28:29], v22 offset:0
    ds_read_b64_tr_b16 v[30:31], v22 offset:512
    ds_read_b64_tr_b16 v[32:33], v23 offset:0
    ds_read_b64_tr_b16 v[34:35], v23 offset:512
    ds_read_b64_tr_b16 v[36:37], v24 offset:0
    ds_read_b64_tr_b16 v[38:39], v24 offset:512
    ds_read_b64_tr_b16 v[40:41], v25 offset:0
    ds_read_b64_tr_b16 v[42:43], v25 offset:512
    s_waitcnt lgkmcnt(0)
    s_mov_b32 m0, s64
    s_nop 0
    buffer_load_dwordx4 v18, s[76:79], s41 offen offset:0 lds
    s_add_u32 s41, s41, s42
    buffer_load_dwordx4 v18, s[76:79], s41 offen offset:1024 lds
    s_add_u32 s41, s41, s42
    buffer_load_dwordx4 v18, s[76:79], s41 offen offset:2048 lds
    s_add_u32 s41, s41, s42
    buffer_load_dwordx4 v18, s[76:79], s41 offen offset:3072 lds
    s_add_u32 s41, s41, s43
    buffer_store_dwordx4 v[28:31], v9, s[16:19], s50 offen sc1
    s_add_u32 s50, s50, s46
    v_mfma_f32_16x16x32_bf16 v[44:47], v[28:31], v[120:123], 0
    buffer_store_dwordx4 v[32:35], v9, s[16:19], s51 offen sc1
    s_add_u32 s51, s51, s46
    v_mfma_f32_16x16x32_bf16 v[48:51], v[32:35], v[120:123], 0
    buffer_store_dwordx4 v[36:39], v9, s[16:19], s52 offen sc1
    s_add_u32 s52, s52, s46
    v_mfma_f32_16x16x32_bf16 v[52:55], v[36:39], v[120:123], 0
    buffer_store_dwordx4 v[40:43], v9, s[16:19], s53 offen sc1
    s_add_u32 s53, s53, s46
    v_mfma_f32_16x16x32_bf16 v[56:59], v[40:43], v[120:123], 0
    s_branch L_isl2
L_f_back2:
    s_branch L_f_pg1
.p2align 12
.fill 256, 4, 0xbf800000
L_f_pg1:
    s_waitcnt vmcnt(24)
    s_barrier
    s_add_u32 m0, s39, 65536
    s_nop 0
    buffer_load_dwordx4 v9, s[72:75], s40 offen offset:0 sc1 lds
    buffer_load_dwordx4 v9, s[72:75], s40 offen offset:1024 sc1 lds
    buffer_load_dwordx4 v9, s[72:75], s40 offen offset:2048 sc1 lds
    buffer_load_dwordx4 v9, s[72:75], s40 offen offset:3072 sc1 lds
    s_add_u32 s40, s40, 4096
    s_add_u32 m0, s39, 69632
    s_nop 0
    buffer_load_dwordx4 v9, s[72:75], s40 offen offset:0 sc1 lds
    buffer_load_dwordx4 v9, s[72:75], s40 offen offset:1024 sc1 lds
    buffer_load_dwordx4 v9, s[72:75], s40 offen offset:2048 sc1 lds
    buffer_load_dwordx4 v9, s[72:75], s40 offen offset:3072 sc1 lds
    s_add_u32 s40, s40, 28672
    s_and_b32 s40, s40, 0x3ffff
    s_waitcnt vmcnt(12)
    ds_read_b64_tr_b16 v[28:29], v22 offset:0
    ds_read_b64_tr_b16 v[30:31], v22 offset:512
    ds_read_b64_tr_b16 v[32:33], v23 offset:0
    ds_read_b64_tr_b16 v[34:35], v23 offset:512
    ds_read_b64_tr_b16 v[36:37], v24 offset:0
    ds_read_b64_tr_b16 v[38:39], v24 offset:512
    ds_read_b64_tr_b16 v[40:41], v25 offset:0
    ds_read_b64_tr_b16 v[42:43], v25 offset:512
    s_waitcnt lgkmcnt(0)
    s_mov_b32 m0, s64
    s_nop 0
    buffer_load_dwordx4 v18, s[76:79], s41 offen offset:0 lds
    s_add_u32 s41, s41, s42
    buffer_load_dwordx4 v18, s[76:79], s41 offen offset:1024 lds
    s_add_u32 s41, s41, s42
    buffer_load_dwordx4 v18, s[76:79], s41 offen offset:2048 lds
    s_add_u32 s41, s41, s42
    buffer_load_dwordx4 v18, s[76:79], s41 offen offset:3072 lds
    s_add_u32 s41, s41, s43
    buffer_store_dwordx4 v[28:31], v9, s[16:19], s50 offen sc1
    s_add_u32 s50, s50, s46
    v_mfma_f32_16x16x32_bf16 v[44:47], v[28:31], v[120:123], v[44:47]
    buffer_store_dwordx4 v[32:35], v9, s[16:19], s51 offen sc1
    s_add_u32 s51, s51, s46
    v_mfma_f32_16x16x32_bf16 v[48:51], v[32:35], v[120:123], v[48:51]
    buffer_store_dwordx4 v[36:39], v9, s[16:19], s52 offen sc1
    s_add_u32 s52, s52, s46
    v_mfma_f32_16x16x32_bf16 v[52:55], v[36:39], v[120:123], v[52:55]
    buffer_store_dwordx4 v[40:43], v9, s[16:19], s53 offen sc1
    s_add_u32 s53, s53, s46
    v_mfma_f32_16x16x32_bf16 v[56:59], v[40:43], v[120:123], v[56:59]
    s_waitcnt vmcnt(24)
    s_barrier
    s_add_u32 m0, s39, 0
    s_nop 0
    buffer_load_dwordx4 v9, s[72:75], s40 offen offset:0 sc1 lds
    buffer_load_dwordx4 v9, s[72:75], s40 offen offset:1024 sc1 lds
    buffer_load_dwordx4 v9, s[72:75], s40 offen offset:2048 sc1 lds
    buffer_load_dwordx4 v9, s[72:75], s40 offen offset:3072 sc1 lds
    s_add_u32 s40, s40, 4096
    s_add_u32 m0, s39, 4096
    s_nop 0
    buffer_load_dwordx4 v9, s[72:75], s40 offen offset:0 sc1 lds
    buffer_load_dwordx4 v9, s[72:75], s40 offen offset:1024 sc1 lds
    buffer_load_dwordx4 v9, s[72:75], s40 offen offset:2048 sc1 lds
    buffer_load_dwordx4 v9, s[72:75], s40 offen offset:3072 sc1 lds
    s_add_u32 s40, s40, 28672
    s_and_b32 s40, s40, 0x3ffff
    s_lshl_b32 s36, s44, 10
    s_add_u32 s36, s36, 56688640
    s_cmp_lt_u32 s44, 8
    s_cselect_b32 s36, s36, 1073741824
    v_mov_b64 v[60:61], 0
    v_mov_b64 v[62:63], 0
    buffer_store_dwordx4 v[60:63], v9, s[16:19], s36 offen sc1
    s_waitcnt vmcnt(13)
    ds_read_b64_tr_b16 v[28:29], v22 offset:0
    ds_read_b64_tr_b16 v[30:31], v22 offset:512
    ds_read_b64_tr_b16 v[32:33], v23 offset:0
    ds_read_b64_tr_b16 v[34:35], v23 offset:512
    ds_read_b64_tr_b16 v[36:37], v24 offset:0
    ds_read_b64_tr_b16 v[38:39], v24 offset:512
    ds_read_b64_tr_b16 v[40:41], v25 offset:0
    ds_read_b64_tr_b16 v[42:43], v25 offset:512
    s_waitcnt lgkmcnt(0)
    s_mov_b32 m0, s64
    s_nop 0
    buffer_load_dwordx4 v18, s[76:79], s41 offen offset:0 lds
    s_add_u32 s41, s41, s42
    buffer_load_dwordx4 v18, s[76:79], s41 offen offset:1024 lds
    s_add_u32 s41, s41, s42
    buffer_load_dwordx4 v18, s[76:79], s41 offen offset:2048 lds
    s_add_u32 s41, s41, s42
    buffer_load_dwordx4 v18, s[76:79], s41 offen offset:3072 lds
    s_add_u32 s41, s41, s43
    buffer_store_dwordx4 v[28:31], v9, s[16:19], s50 offen sc1
    s_add_u32 s50, s50, s46
    v_mfma_f32_16x16x32_bf16 v[44:47], v[28:31], v[120:123], v[44:47]
    buffer_store_dwordx4 v[32:35], v9, s[16:19], s51 offen sc1
    s_add_u32 s51, s51, s46
    v_mfma_f32_16x16x32_bf16 v[48:51], v[32:35], v[120:123], v[48:51]
    buffer_store_dwordx4 v[36:39], v9, s[16:19], s52 offen sc1
    s_add_u32 s52, s52, s46
    v_mfma_f32_16x16x32_bf16 v[52:55], v[36:39], v[120:123], v[52:55]
    buffer_store_dwordx4 v[40:43], v9, s[16:19], s53 offen sc1
    s_add_u32 s53, s53, s46
    v_mfma_f32_16x16x32_bf16 v[56:59], v[40:43], v[120:123], v[56:59]
    s_waitcnt vmcnt(25)
    s_barrier
    s_add_u32 m0, s39, 32768
    s_nop 0
    buffer_load_dwordx4 v9, s[72:75], s40 offen offset:0 sc1 lds
    buffer_load_dwordx4 v9, s[72:75], s40 offen offset:1024 sc1 lds
    buffer_load_dwordx4 v9, s[72:75], s40 offen offset:2048 sc1 lds
    buffer_load_dwordx4 v9, s[72:75], s40 offen offset:3072 sc1 lds
    s_add_u32 s40, s40, 4096
    s_add_u32 m0, s39, 36864
    s_nop 0
    buffer_load_dwordx4 v9, s[72:75], s40 offen offset:0 sc1 lds
    buffer_load_dwordx4 v9, s[72:75], s40 offen offset:1024 sc1 lds
    buffer_load_dwordx4 v9, s[72:75], s40 offen offset:2048 sc1 lds
    buffer_load_dwordx4 v9, s[72:75], s40 offen offset:3072 sc1 lds
    s_add_u32 s40, s40, 28672
    s_and_b32 s40, s40, 0x3ffff
    s_waitcnt vmcnt(12)
    ds_read_b64_tr_b16 v[28:29], v22 offset:0
    ds_read_b64_tr_b16 v[30:31], v22 offset:512
    ds_read_b64_tr_b16 v[32:33], v23 offset:0
    ds_read_b64_tr_b16 v[34:35], v23 offset:512
    ds_read_b64_tr_b16 v[36:37], v24 offset:0
    ds_read_b64_tr_b16 v[38:39], v24 offset:512
    ds_read_b64_tr_b16 v[40:41], v25 offset:0
    ds_read_b64_tr_b16 v[42:43], v25 offset:512
    s_waitcnt lgkmcnt(0)
    s_mov_b32 s76, s28
    s_mov_b32 s77, s29
    s_mov_b32 s78, s63
    s_mov_b32 s41, 0
    s_mov_b32 m0, s64
    s_nop 0
    buffer_load_dwordx4 v19, s[76:79], s41 offen offset:0 lds
    s_add_u32 s41, s41, 15360
    buffer_load_dwordx4 v19, s[76:79], s41 offen offset:1024 lds
    s_add_u32 s41, s41, 211968
    buffer_load_dwordx4 v19, s[76:79], s41 offen offset:2048 lds
    s_add_u32 s41, s41, 15360
    buffer_load_dwordx4 v19, s[76:79], s41 offen offset:3072 lds
    s_add_u32 s41, s41, 216064
    buffer_store_dwordx4 v[28:31], v9, s[16:19], s50 offen sc1
    s_add_u32 s50, s50, s46
    v_mfma_f32_16x16x32_bf16 v[44:47], v[28:31], v[120:123], v[44:47]
    buffer_store_dwordx4 v[32:35], v9, s[16:19], s51 offen sc1
    s_add_u32 s51, s51, s46
    v_mfma_f32_16x16x32_bf16 v[48:51], v[32:35], v[120:123], v[48:51]
    buffer_store_dwordx4 v[36:39], v9, s[16:19], s52 offen sc1
    s_add_u32 s52, s52, s46
    v_mfma_f32_16x16x32_bf16 v[52:55], v[36:39], v[120:123], v[52:55]
    buffer_store_dwordx4 v[40:43], v9, s[16:19], s53 offen sc1
    s_add_u32 s53, s53, s46
    v_mfma_f32_16x16x32_bf16 v[56:59], v[40:43], v[120:123], v[56:59]
    s_waitcnt vmcnt(25)
    s_barrier
    s_add_u32 m0, s39, 65536
    s_nop 0
    buffer_load_dwordx4 v9, s[72:75], s40 offen offset:0 sc1 lds
    buffer_load_dwordx4 v9, s[72:75], s40 offen offset:1024 sc1 lds
    buffer_load_dwordx4 v9, s[72:75], s40 offen offset:2048 sc1 lds
    buffer_load_dwordx4 v9, s[72:75], s40 offen offset:3072 sc1 lds
    s_add_u32 s40, s40, 4096
    s_add_u32 m0, s39, 69632
    s_nop 0
    buffer_load_dwordx4 v9, s[72:75], s40 offen offset:0 sc1 lds
    buffer_load_dwordx4 v9, s[72:75], s40 offen offset:1024 sc1 lds
    buffer_load_dwordx4 v9, s[72:75], s40 offen offset:2048 sc1 lds
    buffer_load_dwordx4 v9, s[72:75], s40 offen offset:3072 sc1 lds
    s_add_u32 s40, s40, 28672
    s_and_b32 s40, s40, 0x3ffff
    s_waitcnt vmcnt(12)
    ds_read_b64_tr_b16 v[28:29], v26 offset:0
    ds_read_b64_tr_b16 v[30:31], v26 offset:512
    ds_read_b64_tr_b16 v[32:33], v26 offset:8
    ds_read_b64_tr_b16 v[34:35], v26 offset:520
    ds_read_b64_tr_b16 v[36:37], v27 offset:0
    ds_read_b64_tr_b16 v[38:39], v27 offset:512
    ds_read_b64_tr_b16 v[40:41], v27 offset:8
    ds_read_b64_tr_b16 v[42:43], v27 offset:520
    s_waitcnt lgkmcnt(0)
    s_mov_b32 m0, s64
    s_nop 0
    buffer_load_dwordx4 v19, s[76:79], s41 offen offset:0 lds
    s_add_u32 s41, s41, 15360
    buffer_load_dwordx4 v19, s[76:79], s41 offen offset:1024 lds
    s_add_u32 s41, s41, 211968
    buffer_load_dwordx4 v19, s[76:79], s41 offen offset:2048 lds
    s_add_u32 s41, s41, 15360
    buffer_load_dwordx4 v19, s[76:79], s41 offen offset:3072 lds
    s_add_u32 s41, s41, 216064
    buffer_store_dwordx4 v[28:31], v9, s[16:19], s62 offen offset:0 sc1
    buffer_store_dwordx4 v[32:35], v9, s[16:19], s62 offen offset:1024 sc1
    buffer_store_dwordx4 v[36:39], v9, s[16:19], s62 offen offset:2048 sc1
    buffer_store_dwordx4 v[40:43], v9, s[16:19], s62 offen offset:3072 sc1
    s_add_u32 s62, s62, 8192
    buffer_store_dwordx4 v[44:47], v20, s[16:19], s58 offen sc1
    buffer_store_dwordx4 v[48:51], v20, s[16:19], s59 offen sc1
    buffer_store_dwordx4 v[52:55], v20, s[16:19], s60 offen sc1
    buffer_store_dwordx4 v[56:59], v20, s[16:19], s61 offen sc1
    s_lshl_b32 s36, s34, 18
    s_add_u32 s36, s36, 0
    s_add_u32 m0, s57, 0
    s_nop 0
    buffer_load_dwordx4 v14, s[8:11], s36 offen lds
    s_add_u32 m0, s57, 4096
    s_nop 0
    buffer_load_dwordx4 v15, s[8:11], s36 offen lds
    s_add_u32 m0, s57, 8192
    s_nop 0
    buffer_load_dwordx4 v16, s[8:11], s36 offen lds
    s_add_u32 m0, s57, 12288
    s_nop 0
    buffer_load_dwordx4 v17, s[8:11], s36 offen lds
    s_add_u32 s36, s34, 1
    s_and_b32 s36, s36, 3
    s_lshl_b32 s36, s36, 18
    s_add_u32 s36, s36, 0
    s_add_u32 m0, s57, 32768
    s_nop 0
    buffer_load_dwordx4 v14, s[8:11], s36 offen lds
    s_add_u32 m0, s57, 36864
    s_nop 0
    buffer_load_dwordx4 v15, s[8:11], s36 offen lds
    s_add_u32 m0, s57, 40960
    s_nop 0
    buffer_load_dwordx4 v16, s[8:11], s36 offen lds
    s_add_u32 m0, s57, 45056
    s_nop 0
    buffer_load_dwordx4 v17, s[8:11], s36 offen lds
    s_add_u32 s36, s34, 1
    s_and_b32 s36, s36, 3
    s_lshl_b32 s36, s36, 18
    s_add_u32 s36, s36, 131072
    s_add_u32 m0, s57, 49152
    s_nop 0
    buffer_load_dwordx4 v14, s[8:11], s36 offen lds
    s_add_u32 m0, s57, 53248
    s_nop 0
    buffer_load_dwordx4 v15, s[8:11], s36 offen lds
    s_add_u32 m0, s57, 57344
    s_nop 0
    buffer_load_dwordx4 v16, s[8:11], s36 offen lds
    s_add_u32 m0, s57, 61440
    s_nop 0
    buffer_load_dwordx4 v17, s[8:11], s36 offen lds
    s_lshr_b32 s36, s2, 3
    s_lshl_b32 s36, s36, 11
    v_and_b32 v6, 255, v0
    v_lshlrev_b32 v6, 3, v6
    v_add_u32 v6, s36, v6
    s_getpc_b64 s[22:23]
L_f_pc2:
    s_add_u32 s22, s22, L_code_rest-L_f_pc2
    s_addc_u32 s23, s23, 0
    v_min_u32 v6, L_code_end-L_code_rest-4, v6
    global_load_dword v7, v6, s[22:23]
    s_waitcnt vmcnt(41)
    s_barrier
    s_waitcnt vmcnt(21)
    ds_read_b64_tr_b16 v[28:29], v26 offset:0
    ds_read_b64_tr_b16 v[30:31], v26 offset:512
    ds_read_b64_tr_b16 v[32:33], v26 offset:8
    ds_read_b64_tr_b16 v[34:35], v26 offset:520
    ds_read_b64_tr_b16 v[36:37], v27 offset:0
    ds_read_b64_tr_b16 v[38:39], v27 offset:512
    ds_read_b64_tr_b16 v[40:41], v27 offset:8
    ds_read_b64_tr_b16 v[42:43], v27 offset:520
    s_waitcnt lgkmcnt(0)
    buffer_store_dwordx4 v[28:31], v9, s[16:19], s62 offen offset:0 sc1
    buffer_store_dwordx4 v[32:35], v9, s[16:19], s62 offen offset:1024 sc1
    buffer_store_dwordx4 v[36:39], v9, s[16:19], s62 offen offset:2048 sc1
    buffer_store_dwordx4 v[40:43], v9, s[16:19], s62 offen offset:3072 sc1
    s_add_u32 s36, s34, 2
    s_and_b32 s36, s36, 3
    s_lshl_b32 s36, s36, 18
    s_add_u32 s36, s36, 0
    s_add_u32 m0, s57, 65536
    s_nop 0
    buffer_load_dwordx4 v14, s[8:11], s36 offen lds
    s_add_u32 m0, s57, 69632
    s_nop 0
    buffer_load_dwordx4 v15, s[8:11], s36 offen lds
    s_add_u32 m0, s57, 73728
    s_nop 0
    buffer_load_dwordx4 v16, s[8:11], s36 offen lds
    s_add_u32 m0, s57, 77824
    s_nop 0
    buffer_load_dwordx4 v17, s[8:11], s36 offen lds
    s_add_u32 s36, s34, 2
    s_and_b32 s36, s36, 3
    s_lshl_b32 s36, s36, 18
    s_add_u32 s36, s36, 131072
    s_add_u32 m0, s57, 81920
    s_nop 0
    buffer_load_dwordx4 v14, s[8:11], s36 offen lds
    s_add_u32 m0, s57, 86016
    s_nop 0
    buffer_load_dwordx4 v15, s[8:11], s36 offen lds
    s_add_u32 m0, s57, 90112
    s_nop 0
    buffer_load_dwordx4 v16, s[8:11], s36 offen lds
    s_add_u32 m0, s57, 94208
    s_nop 0
    buffer_load_dwordx4 v17, s[8:11], s36 offen lds
    s_and_b32 s36, s33, 7
    s_add_u32 s36, s36, 8
    s_lshr_b32 s37, s36, 1
    s_cmp_eq_u32 s34, s37
    s_cselect_b32 s37, 8, 0
    s_sub_u32 s36, s36, s37
    s_lshl_b32 s36, s36, 17
    buffer_load_dwordx4 v[60:63], v14, s[8:11], s36 offen
    buffer_load_dwordx4 v[60:63], v15, s[8:11], s36 offen
    buffer_load_dwordx4 v[60:63], v16, s[8:11], s36 offen
    buffer_load_dwordx4 v[60:63], v17, s[8:11], s36 offen
    s_waitcnt vmcnt(41)
    s_barrier
    s_lshl_b32 s36, s34, 18
    s_add_u32 s36, s36, 131072
    s_add_u32 m0, s57, 16384
    s_nop 0
    buffer_load_dwordx4 v14, s[8:11], s36 offen lds
    s_add_u32 m0, s57, 20480
    s_nop 0
    buffer_load_dwordx4 v15, s[8:11], s36 offen lds
    s_add_u32 m0, s57, 24576
    s_nop 0
    buffer_load_dwordx4 v16, s[8:11], s36 offen lds
    s_add_u32 m0, s57, 28672
    s_nop 0
    buffer_load_dwordx4 v17, s[8:11], s36 offen lds
    s_add_u32 s36, s34, 3
    s_and_b32 s36, s36, 3
    s_lshl_b32 s36, s36, 18
    s_add_u32 s36, s36, 0
    s_add_u32 m0, s57, 98304
    s_nop 0
    buffer_load_dwordx4 v14, s[8:11], s36 offen lds
    s_add_u32 m0, s57, 102400
    s_nop 0
    buffer_load_dwordx4 v15, s[8:11], s36 offen lds
    s_add_u32 m0, s57, 106496
    s_nop 0
    buffer_load_dwordx4 v16, s[8:11], s36 offen lds
    s_add_u32 m0, s57, 110592
    s_nop 0
    buffer_load_dwordx4 v17, s[8:11], s36 offen lds
    s_add_u32 s36, s34, 3
    s_and_b32 s36, s36, 3
    s_lshl_b32 s36, s36, 18
    s_add_u32 s36, s36, 131072
    s_add_u32 m0, s57, 114688
    s_nop 0
    buffer_load_dwordx4 v14, s[8:11], s36 offen lds
    s_add_u32 m0, s57, 118784
    s_nop 0
    buffer_load_dwordx4 v15, s[8:11], s36 offen lds
    s_add_u32 m0, s57, 122880
    s_nop 0
    buffer_load_dwordx4 v16, s[8:11], s36 offen lds
    s_add_u32 m0, s57, 126976
    s_nop 0
    buffer_load_dwordx4 v17, s[8:11], s36 offen lds
    s_branch L_f_pg7
.p2align 12
.fill 256, 4, 0xbf800000
L_f_pg7:
    s_barrier
    s_lshl_b32 s40, s33, 9
    s_add_u32 s40, s40, 56623104
    s_mov_b32 s48, 1048576
    s_waitcnt vmcnt(0)
    v_mov_b32 v60, 0
    s_cmp_lt_u32 s34, 4
    s_cbranch_scc1 L_f_late
    s_mov_b64 exec, 1
    v_mov_b32 v60, 0
    buffer_atomic_add v60, off, s[16:19], s40 offset:0 sc0 sc1
    s_mov_b64 exec, -1
    s_waitcnt vmcnt(0)
    v_readfirstlane_b32 s36, v60
    s_nop 0
    s_cmp_lt_u32 s36, 16
    s_cbranch_scc1 L_f_late
    s_add_u32 s36, s34, 1
    s_and_b32 s36, s36, 3
    s_lshl_b32 s36, s36, 14
    s_add_u32 s36, s36, 0
    s_add_u32 m0, s38, 147456
    s_add_u32 s36, s36, s47
    buffer_load_dwordx4 v9, s[16:19], s36 offen offset:0 sc1 lds
    buffer_load_dwordx4 v9, s[16:19], s36 offen offset:1024 sc1 lds
    s_add_u32 s36, s34, 1
    s_and_b32 s36, s36, 3
    s_lshl_b32 s36, s36, 14
    s_add_u32 s36, s36, 8192
    s_add_u32 m0, s38, 155648
    s_add_u32 s36, s36, s47
    buffer_load_dwordx4 v9, s[16:19], s36 offen offset:0 sc1 lds
    buffer_load_dwordx4 v9, s[16:19], s36 offen offset:1024 sc1 lds
    s_barrier
    s_branch L_f_both
L_f_late:
    s_cmp_eq_u32 s32, 0
    s_cselect_b32 s45, 16, 0
    v_readfirstlane_b32 s36, v60
    s_nop 0
    s_cmp_ge_u32 s36, s45
    s_cbranch_scc1 L_f_open0
    s_mov_b64 exec, 1
    v_mov_b32 v60, 0
    buffer_atomic_add v60, off, s[16:19], s40 offset:0 sc0 sc1
    s_mov_b64 exec, -1
    s_sleep 3
    s_mov_b64 exec, 1
    v_mov_b32 v61, 0
    buffer_atomic_add v61, off, s[16:19], s40 offset:0 sc0 sc1
    s_mov_b64 exec, -1
    s_sleep 3
L_f_gate0:
    s_mov_b64 exec, 1
    v_mov_b32 v62, 0
    buffer_atomic_add v62, off, s[16:19], s40 offset:0 sc0 sc1
    s_mov_b64 exec, -1
    s_waitcnt vmcnt(2)
    v_readfirstlane_b32 s36, v60
    s_nop 0
    s_cmp_ge_u32 s36, s45
    s_cbranch_scc1 L_f_open0
    s_mov_b64 exec, 1
    v_mov_b32 v60, 0
    buffer_atomic_add v60, off, s[16:19], s40 offset:0 sc0 sc1
    s_mov_b64 exec, -1
    s_waitcnt vmcnt(2)
    v_readfirstlane_b32 s36, v61
    s_nop 0
    s_cmp_ge_u32 s36, s45
    s_cbranch_scc1 L_f_open0
    s_mov_b64 exec, 1
    v_mov_b32 v61, 0
    buffer_atomic_add v61, off, s[16:19], s40 offset:0 sc0 sc1
    s_mov_b64 exec, -1
    s_waitcnt vmcnt(2)
    v_readfirstlane_b32 s36, v62
    s_nop 0
    s_cmp_ge_u32 s36, s45
    s_cbranch_scc1 L_f_open0
    s_sub_u32 s48, s48, 1
    s_cbranch_scc0 L_f_gate0
L_f_open0:
    s_barrier
    s_add_u32 s36, s34, 1
    s_and_b32 s36, s36, 3
    s_lshl_b32 s36, s36, 14
    s_add_u32 s36, s36, 0
    s_add_u32 m0, s38, 147456
    s_add_u32 s36, s36, s47
    buffer_load_dwordx4 v9, s[16:19], s36 offen offset:0 sc1 lds
    buffer_load_dwordx4 v9, s[16:19], s36 offen offset:1024 sc1 lds
    s_add_u32 s36, s34, 1
    s_and_b32 s36, s36, 3
    s_lshl_b32 s36, s36, 14
    s_add_u32 s36, s36, 8192
    s_add_u32 m0, s38, 155648
    s_add_u32 s36, s36, s47
    buffer_load_dwordx4 v9, s[16:19], s36 offen offset:0 sc1 lds
    buffer_load_dwordx4 v9, s[16:19], s36 offen offset:1024 sc1 lds
L_f_both:
    s_cmp_eq_u32 s32, 0
    s_cselect_b32 s40, s40, 1073741824
    s_cselect_b32 s45, 16, 0
    s_cmp_lt_u32 s34, 4
    s_cselect_b32 s42, 1073741824, s40
    s_cselect_b32 s43, 0, s45
    s_cselect_b32 s40, s40, 1073741824
    s_cselect_b32 s45, s45, 0
    s_barrier
    s_add_u32 s36, s34, 2
    s_and_b32 s36, s36, 3
    s_lshl_b32 s36, s36, 14
    s_add_u32 s36, s36, 0
    s_add_u32 m0, s38, 131072
    s_add_u32 s36, s36, s47
    buffer_load_dwordx4 v9, s[16:19], s36 offen offset:0 sc1 lds
    buffer_load_dwordx4 v9, s[16:19], s36 offen offset:1024 sc1 lds
    s_waitcnt vmcnt(4)
    s_barrier
    s_add_u32 s36, s34, 2
    s_and_b32 s36, s36, 3
    s_lshl_b32 s36, s36, 14
    s_add_u32 s36, s36, 8192
    s_add_u32 m0, s38, 139264
    s_add_u32 s36, s36, s47
    buffer_load_dwordx4 v9, s[16:19], s36 offen offset:0 sc1 lds
    buffer_load_dwordx4 v9, s[16:19], s36 offen offset:1024 sc1 lds
    s_xor_b32 s36, s34, 4
    s_lshl_b32 s36, s36, 18
    s_add_u32 s36, s36, 0
    s_add_u32 m0, s57, 0
    s_nop 0
    buffer_load_dwordx4 v14, s[8:11], s36 offen lds
    s_add_u32 m0, s57, 4096
    s_nop 0
    buffer_load_dwordx4 v15, s[8:11], s36 offen lds
    s_add_u32 m0, s57, 8192
    s_nop 0
    buffer_load_dwordx4 v16, s[8:11], s36 offen lds
    s_waitcnt vmcnt(7)
    s_barrier
    s_add_u32 s36, s34, 3
    s_and_b32 s36, s36, 3
    s_lshl_b32 s36, s36, 14
    s_add_u32 s36, s36, 0
    s_add_u32 m0, s38, 147456
    s_add_u32 s36, s36, s47
    buffer_load_dwordx4 v9, s[16:19], s36 offen offset:0 sc1 lds
    buffer_load_dwordx4 v9, s[16:19], s36 offen offset:1024 sc1 lds
    buffer_load_dword v60, off, s[16:19], s40 offset:256 sc1
    s_xor_b32 s36, s34, 4
    s_lshl_b32 s36, s36, 18
    s_add_u32 s36, s36, 0
    s_add_u32 m0, s57, 12288
    s_nop 0
    buffer_load_dwordx4 v17, s[8:11], s36 offen lds
    s_xor_b32 s36, s34, 4
    s_lshl_b32 s36, s36, 18
    s_add_u32 s36, s36, 131072
    s_add_u32 m0, s57, 16384
    s_nop 0
    buffer_load_dwordx4 v14, s[8:11], s36 offen lds
    s_add_u32 m0, s57, 20480
    s_nop 0
    buffer_load_dwordx4 v15, s[8:11], s36 offen lds
    s_waitcnt vmcnt(11)
    s_barrier
    s_add_u32 s36, s34, 3
    s_and_b32 s36, s36, 3
    s_lshl_b32 s36, s36, 14
    s_add_u32 s36, s36, 8192
    s_add_u32 m0, s38, 155648
    s_add_u32 s36, s36, s47
    buffer_load_dwordx4 v9, s[16:19], s36 offen offset:0 sc1 lds
    buffer_load_dwordx4 v9, s[16:19], s36 offen offset:1024 sc1 lds
    s_xor_b32 s36, s34, 4
    s_lshl_b32 s36, s36, 18
    s_add_u32 s36, s36, 131072
    s_add_u32 m0, s57, 24576
    s_nop 0
    buffer_load_dwordx4 v16, s[8:11], s36 offen lds
    s_add_u32 m0, s57, 28672
    s_nop 0
    buffer_load_dwordx4 v17, s[8:11], s36 offen lds
    s_add_u32 s36, s34, 5
    s_and_b32 s36, s36, 3
    s_lshl_b32 s36, s36, 18
    s_add_u32 s36, s36, 1048576
    s_add_u32 m0, s57, 32768
    s_nop 0
    buffer_load_dwordx4 v14, s[8:11], s36 offen lds
    s_waitcnt vmcnt(8)
    v_readfirstlane_b32 s36, v60
    s_nop 0
    s_cmp_ge_u32 s36, s45
    s_cbranch_scc1 L_f_open1
    s_mov_b64 exec, 1
    v_mov_b32 v60, 0
    buffer_atomic_add v60, off, s[16:19], s40 offset:256 sc0 sc1
    s_mov_b64 exec, -1
    s_sleep 3
    s_mov_b64 exec, 1
    v_mov_b32 v61, 0
    buffer_atomic_add v61, off, s[16:19], s40 offset:256 sc0 sc1
    s_mov_b64 exec, -1
    s_sleep 3
L_f_gate1:
    s_mov_b64 exec, 1
    v_mov_b32 v62, 0
    buffer_atomic_add v62, off, s[16:19], s40 offset:256 sc0 sc1
    s_mov_b64 exec, -1
    s_waitcnt vmcnt(2)
    v_readfirstlane_b32 s36, v60
    s_nop 0
    s_cmp_ge_u32 s36, s45
    s_cbranch_scc1 L_f_open1
    s_mov_b64 exec, 1
    v_mov_b32 v60, 0
    buffer_atomic_add v60, off, s[16:19], s40 offset:256 sc0 sc1
    s_mov_b64 exec, -1
    s_waitcnt vmcnt(2)
    v_readfirstlane_b32 s36, v61
    s_nop 0
    s_cmp_ge_u32 s36, s45
    s_cbranch_scc1 L_f_open1
    s_mov_b64 exec, 1
    v_mov_b32 v61, 0
    buffer_atomic_add v61, off, s[16:19], s40 offset:256 sc0 sc1
    s_mov_b64 exec, -1
    s_waitcnt vmcnt(2)
    v_readfirstlane_b32 s36, v62
    s_nop 0
    s_cmp_ge_u32 s36, s45
    s_cbranch_scc1 L_f_open1
    s_sub_u32 s48, s48, 1
    s_cbranch_scc0 L_f_gate1
L_f_open1:
    s_mov_b32 s40, s42
    s_mov_b32 s45, s43
    s_waitcnt vmcnt(14)
    s_barrier
    s_xor_b32 s36, s34, 4
    s_lshl_b32 s36, s36, 14
    s_add_u32 s36, s36, 0
    s_add_u32 m0, s38, 131072
    s_add_u32 s36, s36, s47
    buffer_load_dwordx4 v9, s[16:19], s36 offen offset:0 sc1 lds
    buffer_load_dwordx4 v9, s[16:19], s36 offen offset:1024 sc1 lds
    buffer_load_dword v60, off, s[16:19], s40 offset:256 sc1
    s_add_u32 s36, s34, 5
    s_and_b32 s36, s36, 3
    s_lshl_b32 s36, s36, 18
    s_add_u32 s36, s36, 1048576
    s_add_u32 m0, s57, 36864
    s_nop 0
    buffer_load_dwordx4 v15, s[8:11], s36 offen lds
    s_add_u32 m0, s57, 40960
    s_nop 0
    buffer_load_dwordx4 v16, s[8:11], s36 offen lds
    s_add_u32 m0, s57, 45056
    s_nop 0
    buffer_load_dwordx4 v17, s[8:11], s36 offen lds
    s_waitcnt vmcnt(15)
    s_barrier
    s_xor_b32 s36, s34, 4
    s_lshl_b32 s36, s36, 14
    s_add_u32 s36, s36, 8192
    s_add_u32 m0, s38, 139264
    s_add_u32 s36, s36, s47
    buffer_load_dwordx4 v9, s[16:19], s36 offen offset:0 sc1 lds
    buffer_load_dwordx4 v9, s[16:19], s36 offen offset:1024 sc1 lds
    s_add_u32 s36, s34, 5
    s_and_b32 s36, s36, 3
    s_lshl_b32 s36, s36, 18
    s_add_u32 s36, s36, 1179648
    s_add_u32 m0, s57, 49152
    s_nop 0
    buffer_load_dwordx4 v14, s[8:11], s36 offen lds
    s_add_u32 m0, s57, 53248
    s_nop 0
    buffer_load_dwordx4 v15, s[8:11], s36 offen lds
    s_add_u32 m0, s57, 57344
    s_nop 0
    buffer_load_dwordx4 v16, s[8:11], s36 offen lds
    s_waitcnt vmcnt(8)
    v_readfirstlane_b32 s36, v60
    s_nop 0
    s_cmp_ge_u32 s36, s45
    s_cbranch_scc1 L_f_open1b
    s_mov_b64 exec, 1
    v_mov_b32 v60, 0
    buffer_atomic_add v60, off, s[16:19], s40 offset:256 sc0 sc1
    s_mov_b64 exec, -1
    s_sleep 3
    s_mov_b64 exec, 1
    v_mov_b32 v61, 0
    buffer_atomic_add v61, off, s[16:19], s40 offset:256 sc0 sc1
    s_mov_b64 exec, -1
    s_sleep 3
L_f_gate1b:
    s_mov_b64 exec, 1
    v_mov_b32 v62, 0
    buffer_atomic_add v62, off, s[16:19], s40 offset:256 sc0 sc1
    s_mov_b64 exec, -1
    s_waitcnt vmcnt(2)
    v_readfirstlane_b32 s36, v60
    s_nop 0
    s_cmp_ge_u32 s36, s45
    s_cbranch_scc1 L_f_open1b
    s_mov_b64 exec, 1
    v_mov_b32 v60, 0
    buffer_atomic_add v60, off, s[16:19], s40 offset:256 sc0 sc1
    s_mov_b64 exec, -1
    s_waitcnt vmcnt(2)
    v_readfirstlane_b32 s36, v61
    s_nop 0
    s_cmp_ge_u32 s36, s45
    s_cbranch_scc1 L_f_open1b
    s_mov_b64 exec, 1
    v_mov_b32 v61, 0
    buffer_atomic_add v61, off, s[16:19], s40 offset:256 sc0 sc1
    s_mov_b64 exec, -1
    s_waitcnt vmcnt(2)
    v_readfirstlane_b32 s36, v62
    s_nop 0
    s_cmp_ge_u32 s36, s45
    s_cbranch_scc1 L_f_open1b
    s_sub_u32 s48, s48, 1
    s_cbranch_scc0 L_f_gate1b
L_f_open1b:
    s_waitcnt vmcnt(14)
    s_barrier
    s_add_u32 s36, s34, 5
    s_and_b32 s36, s36, 3
    s_lshl_b32 s36, s36, 14
    s_add_u32 s36, s36, 65536
    s_add_u32 m0, s38, 147456
    s_add_u32 s36, s36, s47
    buffer_load_dwordx4 v9, s[16:19], s36 offen offset:0 sc1 lds
    buffer_load_dwordx4 v9, s[16:19], s36 offen offset:1024 sc1 lds
    s_add_u32 s36, s34, 5
    s_and_b32 s36, s36, 3
    s_lshl_b32 s36, s36, 18
    s_add_u32 s36, s36, 1179648
    s_add_u32 m0, s57, 61440
    s_nop 0
    buffer_load_dwordx4 v17, s[8:11], s36 offen lds
    s_add_u32 s36, s34, 6
    s_and_b32 s36, s36, 3
    s_lshl_b32 s36, s36, 18
    s_add_u32 s36, s36, 1048576
    s_add_u32 m0, s57, 65536
    s_nop 0
    buffer_load_dwordx4 v14, s[8:11], s36 offen lds
    s_add_u32 m0, s57, 69632
    s_nop 0
    buffer_load_dwordx4 v15, s[8:11], s36 offen lds
    s_waitcnt vmcnt(14)
    s_barrier
    s_add_u32 s36, s34, 5
    s_and_b32 s36, s36, 3
    s_lshl_b32 s36, s36, 14
    s_add_u32 s36, s36, 73728
    s_add_u32 m0, s38, 155648
    s_add_u32 s36, s36, s47
    buffer_load_dwordx4 v9, s[16:19], s36 offen offset:0 sc1 lds
    buffer_load_dwordx4 v9, s[16:19], s36 offen offset:1024 sc1 lds
    s_add_u32 s36, s34, 6
    s_and_b32 s36, s36, 3
    s_lshl_b32 s36, s36, 18
    s_add_u32 s36, s36, 1048576
    s_add_u32 m0, s57, 73728
    s_nop 0
    buffer_load_dwordx4 v16, s[8:11], s36 offen lds
    s_add_u32 m0, s57, 77824
    s_nop 0
    buffer_load_dwordx4 v17, s[8:11], s36 offen lds
    s_add_u32 s36, s34, 6
    s_and_b32 s36, s36, 3
    s_lshl_b32 s36, s36, 18
    s_add_u32 s36, s36, 1179648
    s_add_u32 m0, s57, 81920
    s_nop 0
    buffer_load_dwordx4 v14, s[8:11], s36 offen lds
    s_waitcnt vmcnt(13)
    s_barrier
    s_add_u32 s36, s34, 6
    s_and_b32 s36, s36, 3
    s_lshl_b32 s36, s36, 14
    s_add_u32 s36, s36, 65536
    s_add_u32 m0, s38, 131072
    s_add_u32 s36, s36, s47
    buffer_load_dwordx4 v9, s[16:19], s36 offen offset:0 sc1 lds
    buffer_load_dwordx4 v9, s[16:19], s36 offen offset:1024 sc1 lds
    s_add_u32 s36, s34, 6
    s_and_b32 s36, s36, 3
    s_lshl_b32 s36, s36, 18
    s_add_u32 s36, s36, 1179648
    s_add_u32 m0, s57, 86016
    s_nop 0
    buffer_load_dwordx4 v15, s[8:11], s36 offen lds
    s_add_u32 m0, s57, 90112
    s_nop 0
    buffer_load_dwordx4 v16, s[8:11], s36 offen lds
    s_add_u32 m0, s57, 94208
    s_nop 0
    buffer_load_dwordx4 v17, s[8:11], s36 offen lds
    s_waitcnt vmcnt(13)
    s_barrier
    s_add_u32 s36, s34, 6
    s_and_b32 s36, s36, 3
    s_lshl_b32 s36, s36, 14
    s_add_u32 s36, s36, 73728
    s_add_u32 m0, s38, 139264
    s_add_u32 s36, s36, s47
    buffer_load_dwordx4 v9, s[16:19], s36 offen offset:0 sc1 lds
    buffer_load_dwordx4 v9, s[16:19], s36 offen offset:1024 sc1 lds
    s_add_u32 s36, s34, 7
    s_and_b32 s36, s36, 3
    s_lshl_b32 s36, s36, 18
    s_add_u32 s36, s36, 1048576
    s_add_u32 m0, s57, 98304
    s_nop 0
    buffer_load_dwordx4 v14, s[8:11], s36 offen lds
    s_add_u32 m0, s57, 102400
    s_nop 0
    buffer_load_dwordx4 v15, s[8:11], s36 offen lds
    s_add_u32 m0, s57, 106496
    s_nop 0
    buffer_load_dwordx4 v16, s[8:11], s36 offen lds
    s_waitcnt vmcnt(13)
    s_barrier
    s_add_u32 s36, s34, 7
    s_and_b32 s36, s36, 3
    s_lshl_b32 s36, s36, 14
    s_add_u32 s36, s36, 65536
    s_add_u32 m0, s38, 147456
    s_add_u32 s36, s36, s47
    buffer_load_dwordx4 v9, s[16:19], s36 offen offset:0 sc1 lds
    buffer_load_dwordx4 v9, s[16:19], s36 offen offset:1024 sc1 lds
    s_add_u32 s36, s34, 7
    s_and_b32 s36, s36, 3
    s_lshl_b32 s36, s36, 18
    s_add_u32 s36, s36, 1048576
    s_add_u32 m0, s57, 110592
    s_nop 0
    buffer_load_dwordx4 v17, s[8:11], s36 offen lds
    s_add_u32 s36, s34, 7
    s_and_b32 s36, s36, 3
    s_lshl_b32 s36, s36, 18
    s_add_u32 s36, s36, 1179648
    s_add_u32 m0, s57, 114688
    s_nop 0
    buffer_load_dwordx4 v14, s[8:11], s36 offen lds
    s_add_u32 m0, s57, 118784
    s_nop 0
    buffer_load_dwordx4 v15, s[8:11], s36 offen lds
    s_waitcnt vmcnt(13)
    s_barrier
    s_add_u32 s36, s34, 7
    s_and_b32 s36, s36, 3
    s_lshl_b32 s36, s36, 14
    s_add_u32 s36, s36, 73728
    s_add_u32 m0, s38, 155648
    s_add_u32 s36, s36, s47
    buffer_load_dwordx4 v9, s[16:19], s36 offen offset:0 sc1 lds
    buffer_load_dwordx4 v9, s[16:19], s36 offen offset:1024 sc1 lds
    s_add_u32 s36, s34, 7
    s_and_b32 s36, s36, 3
    s_lshl_b32 s36, s36, 18
    s_add_u32 s36, s36, 1179648
    s_add_u32 m0, s57, 122880
    s_nop 0
    buffer_load_dwordx4 v16, s[8:11], s36 offen lds
    s_add_u32 m0, s57, 126976
    s_nop 0
    buffer_load_dwordx4 v17, s[8:11], s36 offen lds
    s_waitcnt vmcnt(12)
    s_barrier
    s_waitcnt vmcnt(6)
    s_barrier
    s_waitcnt vmcnt(0)
    s_barrier
    s_cmp_lg_u32 s32, 0
    s_cbranch_scc1 L_hop0
    s_call_b64 s[14:15], L_isl4
    s_call_b64 s[14:15], L_isl8
    s_call_b64 s[14:15], L_isl12
    s_call_b64 s[14:15], L_isl16
    s_endpgm
L_hop0:
    s_cmp_lg_u32 s32, 1
    s_cbranch_scc1 L_hop1
    s_call_b64 s[14:15], L_isl5
    s_call_b64 s[14:15], L_isl9
    s_call_b64 s[14:15], L_isl13
    s_endpgm
L_hop1:
    s_cmp_lg_u32 s32, 2
    s_cbranch_scc1 L_hop2
    s_call_b64 s[14:15], L_isl6
    s_call_b64 s[14:15], L_isl10
    s_call_b64 s[14:15], L_isl14
    s_endpgm
L_hop2:
    s_call_b64 s[14:15], L_isl7
    s_call_b64 s[14:15], L_isl11
    s_call_b64 s[14:15], L_isl15
    s_endpgm
L_k1_slow:
    s_waitcnt vmcnt(0) lgkmcnt(0)
    s_nop 15
    v_mov_b32 v6, 0xff800000
    v_mov_b32 v7, 0xff800000
    s_mov_b32 s40, 0
L_k1_s1:
    buffer_load_dwordx4 v[204:207], v9, s[72:75], s40 offen offset:0 sc1
    buffer_load_dwordx4 v[208:211], v9, s[72:75], s40 offen offset:1024 sc1
    s_waitcnt vmcnt(0)
    v_mfma_f32_32x32x16_bf16 v[140:155], v[204:207], v[12:15], 0
    v_mfma_f32_32x32x16_bf16 v[140:155], v[208:211], v[16:19], v[140:155]
    v_mfma_f32_32x32x16_bf16 v[156:171], v[204:207], v[20:23], 0
    v_mfma_f32_32x32x16_bf16 v[156:171], v[208:211], v[24:27], v[156:171]
    s_nop 15
    v_max3_f32 v6, v140, v141, v6
    v_max3_f32 v6, v142, v143, v6
    v_max3_f32 v6, v144, v145, v6
    v_max3_f32 v6, v146, v147, v6
    v_max3_f32 v6, v148, v149, v6
    v_max3_f32 v6, v150, v151, v6
    v_max3_f32 v6, v152, v153, v6
    v_max3_f32 v6, v154, v155, v6
    v_max3_f32 v7, v156, v157, v7
    v_max3_f32 v7, v158, v159, v7
    v_max3_f32 v7, v160, v161, v7
    v_max3_f32 v7, v162, v163, v7
    v_max3_f32 v7, v164, v165, v7
    v_max3_f32 v7, v166, v167, v7
    v_max3_f32 v7, v168, v169, v7
    v_max3_f32 v7, v170, v171, v7
    s_add_u32 s40, s40, 4096
    s_cmp_lt_u32 s40, 262144
    s_cbranch_scc1 L_k1_s1
    v_mov_b32 v8, v6
    s_nop 1
    v_permlane32_swap_b32 v6, v8
    s_nop 1
    v_max_f32 v6, v6, v8
    v_sub_f32 v172, 0, v6
    v_mov_b32 v28, 0
    v_sub_f32 v173, 0, v6
    v_mov_b32 v29, 0
    v_sub_f32 v174, 0, v6
    v_mov_b32 v30, 0
    v_sub_f32 v175, 0, v6
    v_mov_b32 v31, 0
    v_sub_f32 v176, 0, v6
    v_mov_b32 v32, 0
    v_sub_f32 v177, 0, v6
    v_mov_b32 v33, 0
    v_sub_f32 v178, 0, v6
    v_mov_b32 v34, 0
    v_sub_f32 v179, 0, v6
    v_mov_b32 v35, 0
    v_sub_f32 v180, 0, v6
    v_mov_b32 v36, 0
    v_sub_f32 v181, 0, v6
    v_mov_b32 v37, 0
    v_sub_f32 v182, 0, v6
    v_mov_b32 v38, 0
    v_sub_f32 v183, 0, v6
    v_mov_b32 v39, 0
    v_sub_f32 v184, 0, v6
    v_mov_b32 v40, 0
    v_sub_f32 v185, 0, v6
    v_mov_b32 v41, 0
    v_sub_f32 v186, 0, v6
    v_mov_b32 v42, 0
    v_sub_f32 v187, 0, v6
    v_mov_b32 v43, 0
    v_mov_b32 v60, 0
    v_mov_b32 v61, 0
    v_mov_b32 v62, 0
    v_mov_b32 v63, 0
    v_mov_b32 v8, v7
    s_nop 1
    v_permlane32_swap_b32 v7, v8
    s_nop 1
    v_max_f32 v7, v7, v8
    v_sub_f32 v188, 0, v7
    v_mov_b32 v44, 0
    v_sub_f32 v189, 0, v7
    v_mov_b32 v45, 0
    v_sub_f32 v190, 0, v7
    v_mov_b32 v46, 0
    v_sub_f32 v191, 0, v7
    v_mov_b32 v47, 0
    v_sub_f32 v192, 0, v7
    v_mov_b32 v48, 0
    v_sub_f32 v193, 0, v7
    v_mov_b32 v49, 0
    v_sub_f32 v194, 0, v7
    v_mov_b32 v50, 0
    v_sub_f32 v195, 0, v7
    v_mov_b32 v51, 0
    v_sub_f32 v196, 0, v7
    v_mov_b32 v52, 0
    v_sub_f32 v197, 0, v7
    v_mov_b32 v53, 0
    v_sub_f32 v198, 0, v7
    v_mov_b32 v54, 0
    v_sub_f32 v199, 0, v7
    v_mov_b32 v55, 0
    v_sub_f32 v200, 0, v7
    v_mov_b32 v56, 0
    v_sub_f32 v201, 0, v7
    v_mov_b32 v57, 0
    v_sub_f32 v202, 0, v7
    v_mov_b32 v58, 0
    v_sub_f32 v203, 0, v7
    v_mov_b32 v59, 0
    v_mov_b32 v64, 0
    v_mov_b32 v65, 0
    v_mov_b32 v66, 0
    v_mov_b32 v67, 0
    s_mov_b32 s40, 0
L_k1_s2:
    buffer_load_dwordx4 v[204:207], v9, s[72:75], s40 offen offset:0 sc1
    buffer_load_dwordx4 v[208:211], v9, s[72:75], s40 offen offset:1024 sc1
    buffer_load_dwordx4 v[220:223], v9, s[72:75], s40 offen offset:2048 sc1
    buffer_load_dwordx4 v[224:227], v9, s[72:75], s40 offen offset:3072 sc1
    s_waitcnt vmcnt(0)
    v_mfma_f32_32x32x16_bf16 v[140:155], v[204:207], v[12:15], v[172:187]
    v_mfma_f32_32x32x16_bf16 v[140:155], v[208:211], v[16:19], v[140:155]
    v_mfma_f32_32x32x16_bf16 v[156:171], v[204:207], v[20:23], v[188:203]
    v_mfma_f32_32x32x16_bf16 v[156:171], v[208:211], v[24:27], v[156:171]
    s_nop 15
    v_exp_f32 v140, v140
    v_exp_f32 v141, v141
    v_exp_f32 v142, v142
    v_exp_f32 v143, v143
    v_exp_f32 v144, v144
    v_exp_f32 v145, v145
    v_exp_f32 v146, v146
    v_exp_f32 v147, v147
    v_exp_f32 v148, v148
    v_exp_f32 v149, v149
    v_exp_f32 v150, v150
    v_exp_f32 v151, v151
    v_exp_f32 v152, v152
    v_exp_f32 v153, v153
    v_exp_f32 v154, v154
    v_exp_f32 v155, v155
    v_exp_f32 v156, v156
    v_exp_f32 v157, v157
    v_exp_f32 v158, v158
    v_exp_f32 v159, v159
    v_exp_f32 v160, v160
    v_exp_f32 v161, v161
    v_exp_f32 v162, v162
    v_exp_f32 v163, v163
    v_exp_f32 v164, v164
    v_exp_f32 v165, v165
    v_exp_f32 v166, v166
    v_exp_f32 v167, v167
    v_exp_f32 v168, v168
    v_exp_f32 v169, v169
    v_exp_f32 v170, v170
    v_exp_f32 v171, v171
    s_nop 1
    v_smfmac_f32_32x32x32_bf16 v[28:43], v[220:223], v[140:147], v11
    v_smfmac_f32_32x32x32_bf16 v[28:43], v[224:227], v[148:155], v11
    v_smfmac_f32_16x16x64_bf16 v[60:63], v[116:119], v[140:147], v11
    v_smfmac_f32_16x16x64_bf16 v[60:63], v[116:119], v[148:155], v11
    v_smfmac_f32_32x32x32_bf16 v[44:59], v[220:223], v[156:163], v11
    v_smfmac_f32_32x32x32_bf16 v[44:59], v[224:227], v[164:171], v11
    v_smfmac_f32_16x16x64_bf16 v[64:67], v[116:119], v[156:163], v11
    v_smfmac_f32_16x16x64_bf16 v[64:67], v[116:119], v[164:171], v11
    s_add_u32 s40, s40, 4096
    s_cmp_lt_u32 s40, 262144
    s_cbranch_scc1 L_k1_s2
    s_nop 15
    s_nop 7
    v_rcp_f32 v60, v60
    s_nop 0
    v_pk_mul_f32 v[28:29], v[28:29], v[60:61] op_sel_hi:[1,0]
    v_pk_mul_f32 v[30:31], v[30:31], v[60:61] op_sel_hi:[1,0]
    v_pk_mul_f32 v[32:33], v[32:33], v[60:61] op_sel_hi:[1,0]
    v_pk_mul_f32 v[34:35], v[34:35], v[60:61] op_sel_hi:[1,0]
    v_cvt_pk_bf16_f32 v204, v28, v29
    v_cvt_pk_bf16_f32 v205, v30, v31
    v_cvt_pk_bf16_f32 v206, v32, v33
    v_cvt_pk_bf16_f32 v207, v34, v35
    buffer_store_dwordx4 v[204:207], v250, s[16:19], s47 offen offset:0 sc1
    v_pk_mul_f32 v[36:37], v[36:37], v[60:61] op_sel_hi:[1,0]
    v_pk_mul_f32 v[38:39], v[38:39], v[60:61] op_sel_hi:[1,0]
    v_pk_mul_f32 v[40:41], v[40:41], v[60:61] op_sel_hi:[1,0]
    v_pk_mul_f32 v[42:43], v[42:43], v[60:61] op_sel_hi:[1,0]
    v_cvt_pk_bf16_f32 v208, v36, v37
    v_cvt_pk_bf16_f32 v209, v38, v39
    v_cvt_pk_bf16_f32 v210, v40, v41
    v_cvt_pk_bf16_f32 v211, v42, v43
    buffer_store_dwordx4 v[208:211], v250, s[16:19], s47 offen offset:512 sc1
    s_branch L_k1_out
L_code_rest:
.globl ffn_kernel
.p2align 8
.type ffn_kernel,@function
ffn_kernel:
    s_cmp_lt_u32 s2, 256
    s_cbranch_scc1 L_isl4_over
    s_endpgm
L_isl4:
    s_setpc_b64 s[14:15]
L_isl4_over:
    s_load_dwordx2 s[4:5], s[0:1], 88
    s_load_dwordx2 s[20:21], s[0:1], 72
    v_lshrrev_b32 v20, 6, v0
    v_and_b32 v21, 63, v0
    v_readfirstlane_b32 s28, v20
    v_lshlrev_b32 v1, 4, v21
    s_lshr_b32 s32, s2, 3
    s_lshr_b32 s29, s32, 2
    s_and_b32 s32, s32, 3
    s_and_b32 s30, s2, 7
    s_lshl_b32 s30, s30, 2
    s_add_u32 s30, s30, s32
    s_lshl_b32 s37, s29, 2
    s_add_u32 s37, s37, s28
    s_lshl_b32 s32, s37, 17
    s_add_u32 s32, s32, 9437184
    s_mul_i32 s33, s30, 458752
    s_add_u32 s33, s33, 31457280
    s_mul_i32 s35, s28, 7168
    s_mov_b32 s36, s35
    s_mov_b32 s34, 0
    s_waitcnt lgkmcnt(0)
    s_add_u32 s8, s4, s32
    s_addc_u32 s9, s5, 0
    s_mov_b32 s10, 131072
    s_mov_b32 s11, 0x00020000
    s_add_u32 s12, s4, s33
    s_addc_u32 s13, s5, 0
    s_mov_b32 s14, 458752
    s_mov_b32 s15, 0x00020000
    s_lshl_b32 s31, s28, 10
    s_add_u32 s35, s35, 57344
    buffer_load_dwordx4 a[96:99], v1, s[8:11], s34 offen offset:0
    buffer_load_dwordx4 a[100:103], v1, s[8:11], s34 offen offset:1024
    buffer_load_dwordx4 a[104:107], v1, s[8:11], s34 offen offset:2048
    buffer_load_dwordx4 a[108:111], v1, s[8:11], s34 offen offset:3072
    s_add_u32 s34, s34, 4096
    s_add_u32 m0, s31, 86016
    s_nop 0
    buffer_load_dwordx4 v1, s[12:15], s31 offen lds
    s_add_u32 s31, s31, 4096
    s_add_u32 m0, s31, 86016
    s_nop 0
    buffer_load_dwordx4 v1, s[12:15], s31 offen lds
    s_add_u32 s31, s31, 4096
    s_add_u32 m0, s31, 86016
    s_nop 0
    buffer_load_dwordx4 v1, s[12:15], s31 offen lds
    s_add_u32 s31, s31, 4096
    s_add_u32 m0, s31, 86016
    s_nop 0
    buffer_load_dwordx4 v1, s[12:15], s31 offen lds
    s_add_u32 s31, s31, 4096
    s_mov_b32 s6, 75497472
    s_mov_b32 s7, 0x00020000
    s_lshl_b32 s40, s37, 13
    s_add_u32 s40, s40, 55574528
    s_mul_i32 s41, s30, 896
    s_add_u32 s41, s41, 54525952
    v_add_u32 v2, 57344, v1
    v_add_u32 v3, 114688, v1
    v_lshlrev_b32 v6, 2, v0
    v_lshrrev_b32 v20, 4, v21
    v_lshlrev_b32 v4, 4, v20
    v_add_u32 v4, 143360, v4
    v_and_b32 v22, 1, v20
    v_lshlrev_b32 v22, 10, v22
    v_lshrrev_b32 v20, 1, v20
    v_lshl_add_u32 v22, v20, 8, v22
    v_and_b32 v21, 15, v21
    v_lshl_add_u32 v7, v21, 4, v22
    s_mul_i32 s32, s37, 458752
    s_add_u32 s32, s32, 13631488
    s_and_b32 s33, s30, 1
    s_lshl_b32 s33, s33, 9
    s_add_u32 s32, s32, s33
    s_lshr_b32 s33, s30, 1
    s_lshl_b32 s33, s33, 12
    s_add_u32 s32, s32, s33
    s_add_u32 s39, s32, 393216
    s_lshr_b32 s33, s30, 4
    s_mul_i32 s33, s33, 163840
    s_add_u32 s38, s32, s33
    s_getpc_b64 s[16:17]
    s_lshr_b32 s32, s2, 3
    s_lshl_b32 s32, s32, 10
    v_add_u32 v20, s32, v6
    v_min_u32 v20, L_code_end-L_k3_pf-4, v20
L_k3_pf:
    global_load_dword v28, v20, s[16:17]
    s_branch L_isl5_over
.p2align 12
L_isl5:
    s_setpc_b64 s[14:15]
L_isl5_over:
    s_barrier
    buffer_load_dwordx4 a[112:115], v1, s[8:11], s34 offen offset:0
    buffer_load_dwordx4 a[116:119], v1, s[8:11], s34 offen offset:1024
    buffer_load_dwordx4 a[120:123], v1, s[8:11], s34 offen offset:2048
    buffer_load_dwordx4 a[124:127], v1, s[8:11], s34 offen offset:3072
    s_add_u32 s34, s34, 4096
    s_add_u32 m0, s31, 86016
    s_nop 0
    buffer_load_dwordx4 v1, s[12:15], s31 offen lds
    s_add_u32 s31, s31, 4096
    s_add_u32 m0, s31, 86016
    s_nop 0
    buffer_load_dwordx4 v1, s[12:15], s31 offen lds
    s_add_u32 s31, s31, 4096
    s_add_u32 m0, s31, 86016
    s_nop 0
    buffer_load_dwordx4 v1, s[12:15], s31 offen lds
    s_add_u32 s31, s31, 4096
    s_waitcnt vmcnt(8)
    s_barrier
    ds_read_b128 a[160:163], v2 offset:28672
    ds_read_b128 a[164:167], v2 offset:35840
    ds_read_b128 a[168:171], v2 offset:29696
    ds_read_b128 a[172:175], v2 offset:36864
    s_waitcnt lgkmcnt(2)
    v_mfma_f32_16x16x32_bf16 v[32:35], a[160:163], a[96:99], 0
    ds_read_b128 a[176:179], v2 offset:30720
    v_mfma_f32_16x16x32_bf16 v[144:147], a[164:167], a[96:99], 0
    ds_read_b128 a[180:183], v2 offset:37888
    v_mfma_f32_16x16x32_bf16 v[36:39], a[160:163], a[100:103], 0
    v_mfma_f32_16x16x32_bf16 v[148:151], a[164:167], a[100:103], 0
    buffer_load_dwordx4 a[128:131], v1, s[8:11], s34 offen offset:0
    v_mfma_f32_16x16x32_bf16 v[40:43], a[160:163], a[104:107], 0
    v_mfma_f32_16x16x32_bf16 v[152:155], a[164:167], a[104:107], 0
    v_mfma_f32_16x16x32_bf16 v[44:47], a[160:163], a[108:111], 0
    buffer_load_dwordx4 a[132:135], v1, s[8:11], s34 offen offset:1024
    v_mfma_f32_16x16x32_bf16 v[156:159], a[164:167], a[108:111], 0
    s_waitcnt lgkmcnt(2)
    v_mfma_f32_16x16x32_bf16 v[60:63], a[168:171], a[108:111], 0
    ds_read_b128 a[184:187], v2 offset:31744
    v_mfma_f32_16x16x32_bf16 v[172:175], a[172:175], a[108:111], 0
    ds_read_b128 a[188:191], v2 offset:38912
    v_mfma_f32_16x16x32_bf16 v[56:59], a[168:171], a[104:107], 0
    v_mfma_f32_16x16x32_bf16 v[168:171], a[172:175], a[104:107], 0
    buffer_load_dwordx4 a[136:139], v1, s[8:11], s34 offen offset:2048
    v_mfma_f32_16x16x32_bf16 v[52:55], a[168:171], a[100:103], 0
    v_mfma_f32_16x16x32_bf16 v[164:167], a[172:175], a[100:103], 0
    v_mfma_f32_16x16x32_bf16 v[48:51], a[168:171], a[96:99], 0
    buffer_load_dwordx4 a[140:143], v1, s[8:11], s34 offen offset:3072
    s_add_u32 s34, s34, 4096
    v_mfma_f32_16x16x32_bf16 v[160:163], a[172:175], a[96:99], 0
    s_waitcnt lgkmcnt(2)
    v_mfma_f32_16x16x32_bf16 v[64:67], a[176:179], a[96:99], 0
    ds_read_b128 a[160:163], v2 offset:32768
    v_mfma_f32_16x16x32_bf16 v[176:179], a[180:183], a[96:99], 0
    ds_read_b128 a[164:167], v2 offset:39936
    v_mfma_f32_16x16x32_bf16 v[68:71], a[176:179], a[100:103], 0
    v_mfma_f32_16x16x32_bf16 v[180:183], a[180:183], a[100:103], 0
    v_mfma_f32_16x16x32_bf16 v[72:75], a[176:179], a[104:107], 0
    v_mfma_f32_16x16x32_bf16 v[184:187], a[180:183], a[104:107], 0
    s_add_u32 m0, s31, 86016
    v_mfma_f32_16x16x32_bf16 v[76:79], a[176:179], a[108:111], 0
    buffer_load_dwordx4 v1, s[12:15], s31 offen lds
    s_add_u32 s31, s31, 4096
    v_mfma_f32_16x16x32_bf16 v[188:191], a[180:183], a[108:111], 0
    s_waitcnt lgkmcnt(2)
    v_mfma_f32_16x16x32_bf16 v[92:95], a[184:187], a[108:111], 0
    ds_read_b128 a[168:171], v2 offset:33792
    v_mfma_f32_16x16x32_bf16 v[204:207], a[188:191], a[108:111], 0
    ds_read_b128 a[172:175], v2 offset:40960
    v_mfma_f32_16x16x32_bf16 v[88:91], a[184:187], a[104:107], 0
    s_add_u32 m0, s31, 86016
    v_mfma_f32_16x16x32_bf16 v[200:203], a[188:191], a[104:107], 0
    buffer_load_dwordx4 v1, s[12:15], s31 offen lds
    s_add_u32 s31, s31, 4096
    v_mfma_f32_16x16x32_bf16 v[84:87], a[184:187], a[100:103], 0
    v_mfma_f32_16x16x32_bf16 v[196:199], a[188:191], a[100:103], 0
    s_add_u32 m0, s31, 86016
    v_mfma_f32_16x16x32_bf16 v[80:83], a[184:187], a[96:99], 0
    buffer_load_dwordx4 v1, s[12:15], s31 offen lds
    s_add_u32 s31, s31, 4096
    v_mfma_f32_16x16x32_bf16 v[192:195], a[188:191], a[96:99], 0
    s_waitcnt lgkmcnt(2)
    v_mfma_f32_16x16x32_bf16 v[96:99], a[160:163], a[96:99], 0
    ds_read_b128 a[176:179], v2 offset:34816
    v_mfma_f32_16x16x32_bf16 v[208:211], a[164:167], a[96:99], 0
    ds_read_b128 a[180:183], v2 offset:41984
    v_mfma_f32_16x16x32_bf16 v[100:103], a[160:163], a[100:103], 0
    v_mfma_f32_16x16x32_bf16 v[212:215], a[164:167], a[100:103], 0
    v_mfma_f32_16x16x32_bf16 v[104:107], a[160:163], a[104:107], 0
    v_mfma_f32_16x16x32_bf16 v[216:219], a[164:167], a[104:107], 0
    s_add_u32 m0, s31, 86016
    v_mfma_f32_16x16x32_bf16 v[108:111], a[160:163], a[108:111], 0
    buffer_load_dwordx4 v1, s[12:15], s31 offen lds
    s_add_u32 s31, s31, 4096
    v_mfma_f32_16x16x32_bf16 v[220:223], a[164:167], a[108:111], 0
    s_waitcnt vmcnt(8) lgkmcnt(0)
    s_barrier
    v_mfma_f32_16x16x32_bf16 v[124:127], a[168:171], a[108:111], 0
    ds_read_b128 a[184:187], v2 offset:43008
    v_mfma_f32_16x16x32_bf16 v[236:239], a[172:175], a[108:111], 0
    ds_read_b128 a[188:191], v2 offset:50176
    v_mfma_f32_16x16x32_bf16 v[120:123], a[168:171], a[104:107], 0
    v_mfma_f32_16x16x32_bf16 v[232:235], a[172:175], a[104:107], 0
    buffer_load_dwordx4 a[144:147], v1, s[8:11], s34 offen offset:0
    v_mfma_f32_16x16x32_bf16 v[116:119], a[168:171], a[100:103], 0
    v_mfma_f32_16x16x32_bf16 v[228:231], a[172:175], a[100:103], 0
    v_mfma_f32_16x16x32_bf16 v[112:115], a[168:171], a[96:99], 0
    buffer_load_dwordx4 a[148:151], v1, s[8:11], s34 offen offset:1024
    v_mfma_f32_16x16x32_bf16 v[224:227], a[172:175], a[96:99], 0
    v_mfma_f32_16x16x32_bf16 v[128:131], a[176:179], a[96:99], 0
    ds_read_b128 a[160:163], v2 offset:44032
    v_mfma_f32_16x16x32_bf16 v[240:243], a[180:183], a[96:99], 0
    ds_read_b128 a[164:167], v2 offset:51200
    v_mfma_f32_16x16x32_bf16 v[132:135], a[176:179], a[100:103], 0
    v_mfma_f32_16x16x32_bf16 v[244:247], a[180:183], a[100:103], 0
    v_mfma_f32_16x16x32_bf16 v[136:139], a[176:179], a[104:107], 0
    v_mfma_f32_16x16x32_bf16 v[248:251], a[180:183], a[104:107], 0
    v_mfma_f32_16x16x32_bf16 v[140:143], a[176:179], a[108:111], 0
    buffer_load_dwordx4 a[152:155], v1, s[8:11], s34 offen offset:2048
    v_mfma_f32_16x16x32_bf16 v[252:255], a[180:183], a[108:111], 0
    s_waitcnt lgkmcnt(2)
    v_mfma_f32_16x16x32_bf16 v[44:47], a[184:187], a[124:127], v[44:47]
    ds_read_b128 a[168:171], v2 offset:45056
    v_mfma_f32_16x16x32_bf16 v[156:159], a[188:191], a[124:127], v[156:159]
    ds_read_b128 a[172:175], v2 offset:52224
    v_mfma_f32_16x16x32_bf16 v[40:43], a[184:187], a[120:123], v[40:43]
    v_mfma_f32_16x16x32_bf16 v[152:155], a[188:191], a[120:123], v[152:155]
    buffer_load_dwordx4 a[156:159], v1, s[8:11], s34 offen offset:3072
    s_add_u32 s34, s34, 4096
    v_mfma_f32_16x16x32_bf16 v[36:39], a[184:187], a[116:119], v[36:39]
    v_mfma_f32_16x16x32_bf16 v[148:151], a[188:191], a[116:119], v[148:151]
    s_add_u32 m0, s31, 86016
    v_mfma_f32_16x16x32_bf16 v[32:35], a[184:187], a[112:115], v[32:35]
    buffer_load_dwordx4 v1, s[12:15], s31 offen lds
    s_add_u32 s31, s31, 4096
    v_mfma_f32_16x16x32_bf16 v[144:147], a[188:191], a[112:115], v[144:147]
    s_waitcnt lgkmcnt(2)
    v_mfma_f32_16x16x32_bf16 v[48:51], a[160:163], a[112:115], v[48:51]
    ds_read_b128 a[176:179], v2 offset:46080
    v_mfma_f32_16x16x32_bf16 v[160:163], a[164:167], a[112:115], v[160:163]
    ds_read_b128 a[180:183], v2 offset:53248
    v_mfma_f32_16x16x32_bf16 v[52:55], a[160:163], a[116:119], v[52:55]
    v_mfma_f32_16x16x32_bf16 v[164:167], a[164:167], a[116:119], v[164:167]
    v_mfma_f32_16x16x32_bf16 v[56:59], a[160:163], a[120:123], v[56:59]
    v_mfma_f32_16x16x32_bf16 v[168:171], a[164:167], a[120:123], v[168:171]
    s_add_u32 m0, s31, 86016
    v_mfma_f32_16x16x32_bf16 v[60:63], a[160:163], a[124:127], v[60:63]
    buffer_load_dwordx4 v1, s[12:15], s31 offen lds
    s_add_u32 s31, s31, 4096
    v_mfma_f32_16x16x32_bf16 v[172:175], a[164:167], a[124:127], v[172:175]
    s_waitcnt lgkmcnt(2)
    v_mfma_f32_16x16x32_bf16 v[76:79], a[168:171], a[124:127], v[76:79]
    ds_read_b128 a[184:187], v2 offset:47104
    v_mfma_f32_16x16x32_bf16 v[188:191], a[172:175], a[124:127], v[188:191]
    ds_read_b128 a[188:191], v2 offset:54272
    v_mfma_f32_16x16x32_bf16 v[72:75], a[168:171], a[120:123], v[72:75]
    s_add_u32 m0, s31, 86016
    v_mfma_f32_16x16x32_bf16 v[184:187], a[172:175], a[120:123], v[184:187]
    buffer_load_dwordx4 v1, s[12:15], s31 offen lds
    s_add_u32 s31, s31, 4096
    v_mfma_f32_16x16x32_bf16 v[68:71], a[168:171], a[116:119], v[68:71]
    v_mfma_f32_16x16x32_bf16 v[180:183], a[172:175], a[116:119], v[180:183]
    s_add_u32 m0, s36, 0
    v_mfma_f32_16x16x32_bf16 v[64:67], a[168:171], a[112:115], v[64:67]
    buffer_load_dwordx4 v1, s[12:15], s35 offen offset:0 lds
    v_mfma_f32_16x16x32_bf16 v[176:179], a[172:175], a[112:115], v[176:179]
    s_waitcnt lgkmcnt(2)
    v_mfma_f32_16x16x32_bf16 v[80:83], a[176:179], a[112:115], v[80:83]
    ds_read_b128 a[160:163], v2 offset:48128
    v_mfma_f32_16x16x32_bf16 v[192:195], a[180:183], a[112:115], v[192:195]
    ds_read_b128 a[164:167], v2 offset:55296
    v_mfma_f32_16x16x32_bf16 v[84:87], a[176:179], a[116:119], v[84:87]
    v_mfma_f32_16x16x32_bf16 v[196:199], a[180:183], a[116:119], v[196:199]
    v_mfma_f32_16x16x32_bf16 v[88:91], a[176:179], a[120:123], v[88:91]
    v_mfma_f32_16x16x32_bf16 v[200:203], a[180:183], a[120:123], v[200:203]
    v_mfma_f32_16x16x32_bf16 v[92:95], a[176:179], a[124:127], v[92:95]
    buffer_load_dwordx4 v1, s[12:15], s35 offen offset:1024 lds
    v_mfma_f32_16x16x32_bf16 v[204:207], a[180:183], a[124:127], v[204:207]
    s_waitcnt lgkmcnt(2)
    v_mfma_f32_16x16x32_bf16 v[108:111], a[184:187], a[124:127], v[108:111]
    ds_read_b128 a[168:171], v2 offset:49152
    v_mfma_f32_16x16x32_bf16 v[220:223], a[188:191], a[124:127], v[220:223]
    ds_read_b128 a[172:175], v2 offset:56320
    v_mfma_f32_16x16x32_bf16 v[104:107], a[184:187], a[120:123], v[104:107]
    v_mfma_f32_16x16x32_bf16 v[216:219], a[188:191], a[120:123], v[216:219]
    buffer_load_dwordx4 v1, s[12:15], s35 offen offset:2048 lds
    v_mfma_f32_16x16x32_bf16 v[100:103], a[184:187], a[116:119], v[100:103]
    v_mfma_f32_16x16x32_bf16 v[212:215], a[188:191], a[116:119], v[212:215]
    v_mfma_f32_16x16x32_bf16 v[96:99], a[184:187], a[112:115], v[96:99]
    buffer_load_dwordx4 v1, s[12:15], s35 offen offset:3072 lds
    s_add_u32 s35, s35, 4096
    v_mfma_f32_16x16x32_bf16 v[208:211], a[188:191], a[112:115], v[208:211]
    s_waitcnt vmcnt(11) lgkmcnt(0)
    s_barrier
    v_mfma_f32_16x16x32_bf16 v[112:115], a[160:163], a[112:115], v[112:115]
    ds_read_b128 a[176:179], v3 offset:0
    v_mfma_f32_16x16x32_bf16 v[224:227], a[164:167], a[112:115], v[224:227]
    ds_read_b128 a[180:183], v3 offset:7168
    v_mfma_f32_16x16x32_bf16 v[116:119], a[160:163], a[116:119], v[116:119]
    v_mfma_f32_16x16x32_bf16 v[228:231], a[164:167], a[116:119], v[228:231]
    v_mfma_f32_16x16x32_bf16 v[120:123], a[160:163], a[120:123], v[120:123]
    v_mfma_f32_16x16x32_bf16 v[232:235], a[164:167], a[120:123], v[232:235]
    s_add_u32 m0, s36, 4096
    v_mfma_f32_16x16x32_bf16 v[124:127], a[160:163], a[124:127], v[124:127]
    buffer_load_dwordx4 v1, s[12:15], s35 offen offset:0 lds
    v_mfma_f32_16x16x32_bf16 v[236:239], a[164:167], a[124:127], v[236:239]
    v_mfma_f32_16x16x32_bf16 v[140:143], a[168:171], a[124:127], v[140:143]
    ds_read_b128 a[184:187], v3 offset:1024
    v_mfma_f32_16x16x32_bf16 v[252:255], a[172:175], a[124:127], v[252:255]
    ds_read_b128 a[188:191], v3 offset:8192
    v_mfma_f32_16x16x32_bf16 v[136:139], a[168:171], a[120:123], v[136:139]
    v_mfma_f32_16x16x32_bf16 v[248:251], a[172:175], a[120:123], v[248:251]
    buffer_load_dwordx4 v1, s[12:15], s35 offen offset:1024 lds
    v_mfma_f32_16x16x32_bf16 v[132:135], a[168:171], a[116:119], v[132:135]
    v_mfma_f32_16x16x32_bf16 v[244:247], a[172:175], a[116:119], v[244:247]
    v_mfma_f32_16x16x32_bf16 v[128:131], a[168:171], a[112:115], v[128:131]
    buffer_load_dwordx4 v1, s[12:15], s35 offen offset:2048 lds
    s_add_u32 s35, s35, 24576
    v_mfma_f32_16x16x32_bf16 v[240:243], a[172:175], a[112:115], v[240:243]
    s_waitcnt lgkmcnt(2)
    v_mfma_f32_16x16x32_bf16 v[32:35], a[176:179], a[128:131], v[32:35]
    ds_read_b128 a[160:163], v3 offset:2048
    v_mfma_f32_16x16x32_bf16 v[144:147], a[180:183], a[128:131], v[144:147]
    ds_read_b128 a[164:167], v3 offset:9216
    v_mfma_f32_16x16x32_bf16 v[36:39], a[176:179], a[132:135], v[36:39]
    v_mfma_f32_16x16x32_bf16 v[148:151], a[180:183], a[132:135], v[148:151]
    v_mfma_f32_16x16x32_bf16 v[40:43], a[176:179], a[136:139], v[40:43]
    v_mfma_f32_16x16x32_bf16 v[152:155], a[180:183], a[136:139], v[152:155]
    v_mfma_f32_16x16x32_bf16 v[44:47], a[176:179], a[140:143], v[44:47]
    buffer_load_dwordx4 a[0:3], v1, s[8:11], s34 offen offset:0
    v_mfma_f32_16x16x32_bf16 v[156:159], a[180:183], a[140:143], v[156:159]
    s_waitcnt lgkmcnt(2)
    v_mfma_f32_16x16x32_bf16 v[60:63], a[184:187], a[140:143], v[60:63]
    ds_read_b128 a[168:171], v3 offset:3072
    v_mfma_f32_16x16x32_bf16 v[172:175], a[188:191], a[140:143], v[172:175]
    ds_read_b128 a[172:175], v3 offset:10240
    v_mfma_f32_16x16x32_bf16 v[56:59], a[184:187], a[136:139], v[56:59]
    v_mfma_f32_16x16x32_bf16 v[168:171], a[188:191], a[136:139], v[168:171]
    buffer_load_dwordx4 a[4:7], v1, s[8:11], s34 offen offset:1024
    v_mfma_f32_16x16x32_bf16 v[52:55], a[184:187], a[132:135], v[52:55]
    v_mfma_f32_16x16x32_bf16 v[164:167], a[188:191], a[132:135], v[164:167]
    v_mfma_f32_16x16x32_bf16 v[48:51], a[184:187], a[128:131], v[48:51]
    buffer_load_dwordx4 a[8:11], v1, s[8:11], s34 offen offset:2048
    v_mfma_f32_16x16x32_bf16 v[160:163], a[188:191], a[128:131], v[160:163]
    s_waitcnt lgkmcnt(2)
    v_mfma_f32_16x16x32_bf16 v[64:67], a[160:163], a[128:131], v[64:67]
    ds_read_b128 a[176:179], v3 offset:4096
    v_mfma_f32_16x16x32_bf16 v[176:179], a[164:167], a[128:131], v[176:179]
    ds_read_b128 a[180:183], v3 offset:11264
    v_mfma_f32_16x16x32_bf16 v[68:71], a[160:163], a[132:135], v[68:71]
    v_mfma_f32_16x16x32_bf16 v[180:183], a[164:167], a[132:135], v[180:183]
    v_mfma_f32_16x16x32_bf16 v[72:75], a[160:163], a[136:139], v[72:75]
    v_mfma_f32_16x16x32_bf16 v[184:187], a[164:167], a[136:139], v[184:187]
    v_mfma_f32_16x16x32_bf16 v[76:79], a[160:163], a[140:143], v[76:79]
    buffer_load_dwordx4 a[12:15], v1, s[8:11], s34 offen offset:3072
    s_add_u32 s34, s34, 4096
    v_mfma_f32_16x16x32_bf16 v[188:191], a[164:167], a[140:143], v[188:191]
    s_waitcnt lgkmcnt(2)
    v_mfma_f32_16x16x32_bf16 v[92:95], a[168:171], a[140:143], v[92:95]
    ds_read_b128 a[184:187], v3 offset:5120
    v_mfma_f32_16x16x32_bf16 v[204:207], a[172:175], a[140:143], v[204:207]
    ds_read_b128 a[188:191], v3 offset:12288
    v_mfma_f32_16x16x32_bf16 v[88:91], a[168:171], a[136:139], v[88:91]
    v_mfma_f32_16x16x32_bf16 v[200:203], a[172:175], a[136:139], v[200:203]
    buffer_load_dwordx4 a[16:19], v1, s[8:11], s34 offen offset:0
    v_mfma_f32_16x16x32_bf16 v[84:87], a[168:171], a[132:135], v[84:87]
    v_mfma_f32_16x16x32_bf16 v[196:199], a[172:175], a[132:135], v[196:199]
    v_mfma_f32_16x16x32_bf16 v[80:83], a[168:171], a[128:131], v[80:83]
    buffer_load_dwordx4 a[20:23], v1, s[8:11], s34 offen offset:1024
    v_mfma_f32_16x16x32_bf16 v[192:195], a[172:175], a[128:131], v[192:195]
    s_waitcnt lgkmcnt(2)
    v_mfma_f32_16x16x32_bf16 v[96:99], a[176:179], a[128:131], v[96:99]
    ds_read_b128 a[160:163], v3 offset:6144
    v_mfma_f32_16x16x32_bf16 v[208:211], a[180:183], a[128:131], v[208:211]
    ds_read_b128 a[164:167], v3 offset:13312
    v_mfma_f32_16x16x32_bf16 v[100:103], a[176:179], a[132:135], v[100:103]
    v_mfma_f32_16x16x32_bf16 v[212:215], a[180:183], a[132:135], v[212:215]
    v_mfma_f32_16x16x32_bf16 v[104:107], a[176:179], a[136:139], v[104:107]
    v_mfma_f32_16x16x32_bf16 v[216:219], a[180:183], a[136:139], v[216:219]
    v_mfma_f32_16x16x32_bf16 v[108:111], a[176:179], a[140:143], v[108:111]
    buffer_load_dwordx4 a[24:27], v1, s[8:11], s34 offen offset:2048
    v_mfma_f32_16x16x32_bf16 v[220:223], a[180:183], a[140:143], v[220:223]
    s_waitcnt vmcnt(14) lgkmcnt(0)
    s_barrier
    v_mfma_f32_16x16x32_bf16 v[124:127], a[184:187], a[140:143], v[124:127]
    ds_read_b128 a[168:171], v3 offset:14336
    v_mfma_f32_16x16x32_bf16 v[236:239], a[188:191], a[140:143], v[236:239]
    ds_read_b128 a[172:175], v3 offset:21504
    v_mfma_f32_16x16x32_bf16 v[120:123], a[184:187], a[136:139], v[120:123]
    v_mfma_f32_16x16x32_bf16 v[232:235], a[188:191], a[136:139], v[232:235]
    buffer_load_dwordx4 a[28:31], v1, s[8:11], s34 offen offset:3072
    s_add_u32 s34, s34, 4096
    v_mfma_f32_16x16x32_bf16 v[116:119], a[184:187], a[132:135], v[116:119]
    v_mfma_f32_16x16x32_bf16 v[228:231], a[188:191], a[132:135], v[228:231]
    s_add_u32 m0, s36, 28672
    v_mfma_f32_16x16x32_bf16 v[112:115], a[184:187], a[128:131], v[112:115]
    buffer_load_dwordx4 v1, s[12:15], s35 offen offset:0 lds
    v_mfma_f32_16x16x32_bf16 v[224:227], a[188:191], a[128:131], v[224:227]
    v_mfma_f32_16x16x32_bf16 v[128:131], a[160:163], a[128:131], v[128:131]
    ds_read_b128 a[176:179], v3 offset:15360
    v_mfma_f32_16x16x32_bf16 v[240:243], a[164:167], a[128:131], v[240:243]
    ds_read_b128 a[180:183], v3 offset:22528
    v_mfma_f32_16x16x32_bf16 v[132:135], a[160:163], a[132:135], v[132:135]
    v_mfma_f32_16x16x32_bf16 v[244:247], a[164:167], a[132:135], v[244:247]
    v_mfma_f32_16x16x32_bf16 v[136:139], a[160:163], a[136:139], v[136:139]
    v_mfma_f32_16x16x32_bf16 v[248:251], a[164:167], a[136:139], v[248:251]
    v_mfma_f32_16x16x32_bf16 v[140:143], a[160:163], a[140:143], v[140:143]
    buffer_load_dwordx4 v1, s[12:15], s35 offen offset:1024 lds
    v_mfma_f32_16x16x32_bf16 v[252:255], a[164:167], a[140:143], v[252:255]
    s_waitcnt lgkmcnt(2)
    v_mfma_f32_16x16x32_bf16 v[44:47], a[168:171], a[156:159], v[44:47]
    ds_read_b128 a[184:187], v3 offset:16384
    v_mfma_f32_16x16x32_bf16 v[156:159], a[172:175], a[156:159], v[156:159]
    ds_read_b128 a[188:191], v3 offset:23552
    v_mfma_f32_16x16x32_bf16 v[40:43], a[168:171], a[152:155], v[40:43]
    v_mfma_f32_16x16x32_bf16 v[152:155], a[172:175], a[152:155], v[152:155]
    buffer_load_dwordx4 v1, s[12:15], s35 offen offset:2048 lds
    v_mfma_f32_16x16x32_bf16 v[36:39], a[168:171], a[148:151], v[36:39]
    v_mfma_f32_16x16x32_bf16 v[148:151], a[172:175], a[148:151], v[148:151]
    v_mfma_f32_16x16x32_bf16 v[32:35], a[168:171], a[144:147], v[32:35]
    buffer_load_dwordx4 v1, s[12:15], s35 offen offset:3072 lds
    s_add_u32 s35, s35, 4096
    v_mfma_f32_16x16x32_bf16 v[144:147], a[172:175], a[144:147], v[144:147]
    s_waitcnt lgkmcnt(2)
    v_mfma_f32_16x16x32_bf16 v[48:51], a[176:179], a[144:147], v[48:51]
    ds_read_b128 a[160:163], v3 offset:17408
    v_mfma_f32_16x16x32_bf16 v[160:163], a[180:183], a[144:147], v[160:163]
    ds_read_b128 a[164:167], v3 offset:24576
    v_mfma_f32_16x16x32_bf16 v[52:55], a[176:179], a[148:151], v[52:55]
    v_mfma_f32_16x16x32_bf16 v[164:167], a[180:183], a[148:151], v[164:167]
    v_mfma_f32_16x16x32_bf16 v[56:59], a[176:179], a[152:155], v[56:59]
    v_mfma_f32_16x16x32_bf16 v[168:171], a[180:183], a[152:155], v[168:171]
    s_add_u32 m0, s36, 32768
    v_mfma_f32_16x16x32_bf16 v[60:63], a[176:179], a[156:159], v[60:63]
    buffer_load_dwordx4 v1, s[12:15], s35 offen offset:0 lds
    v_mfma_f32_16x16x32_bf16 v[172:175], a[180:183], a[156:159], v[172:175]
    s_waitcnt lgkmcnt(2)
    v_mfma_f32_16x16x32_bf16 v[76:79], a[184:187], a[156:159], v[76:79]
    ds_read_b128 a[168:171], v3 offset:18432
    v_mfma_f32_16x16x32_bf16 v[188:191], a[188:191], a[156:159], v[188:191]
    ds_read_b128 a[172:175], v3 offset:25600
    v_mfma_f32_16x16x32_bf16 v[72:75], a[184:187], a[152:155], v[72:75]
    v_mfma_f32_16x16x32_bf16 v[184:187], a[188:191], a[152:155], v[184:187]
    buffer_load_dwordx4 v1, s[12:15], s35 offen offset:1024 lds
    v_mfma_f32_16x16x32_bf16 v[68:71], a[184:187], a[148:151], v[68:71]
    v_mfma_f32_16x16x32_bf16 v[180:183], a[188:191], a[148:151], v[180:183]
    v_mfma_f32_16x16x32_bf16 v[64:67], a[184:187], a[144:147], v[64:67]
    buffer_load_dwordx4 v1, s[12:15], s35 offen offset:2048 lds
    s_add_u32 s35, s35, 24576
    v_mfma_f32_16x16x32_bf16 v[176:179], a[188:191], a[144:147], v[176:179]
    s_waitcnt lgkmcnt(2)
    v_mfma_f32_16x16x32_bf16 v[80:83], a[160:163], a[144:147], v[80:83]
    ds_read_b128 a[176:179], v3 offset:19456
    v_mfma_f32_16x16x32_bf16 v[192:195], a[164:167], a[144:147], v[192:195]
    ds_read_b128 a[180:183], v3 offset:26624
    v_mfma_f32_16x16x32_bf16 v[84:87], a[160:163], a[148:151], v[84:87]
    v_mfma_f32_16x16x32_bf16 v[196:199], a[164:167], a[148:151], v[196:199]
    v_mfma_f32_16x16x32_bf16 v[88:91], a[160:163], a[152:155], v[88:91]
    v_mfma_f32_16x16x32_bf16 v[200:203], a[164:167], a[152:155], v[200:203]
    v_mfma_f32_16x16x32_bf16 v[92:95], a[160:163], a[156:159], v[92:95]
    buffer_load_dwordx4 a[32:35], v1, s[8:11], s34 offen offset:0
    v_mfma_f32_16x16x32_bf16 v[204:207], a[164:167], a[156:159], v[204:207]
    s_waitcnt lgkmcnt(2)
    v_mfma_f32_16x16x32_bf16 v[108:111], a[168:171], a[156:159], v[108:111]
    ds_read_b128 a[184:187], v3 offset:20480
    v_mfma_f32_16x16x32_bf16 v[220:223], a[172:175], a[156:159], v[220:223]
    ds_read_b128 a[188:191], v3 offset:27648
    v_mfma_f32_16x16x32_bf16 v[104:107], a[168:171], a[152:155], v[104:107]
    v_mfma_f32_16x16x32_bf16 v[216:219], a[172:175], a[152:155], v[216:219]
    buffer_load_dwordx4 a[36:39], v1, s[8:11], s34 offen offset:1024
    v_mfma_f32_16x16x32_bf16 v[100:103], a[168:171], a[148:151], v[100:103]
    v_mfma_f32_16x16x32_bf16 v[212:215], a[172:175], a[148:151], v[212:215]
    v_mfma_f32_16x16x32_bf16 v[96:99], a[168:171], a[144:147], v[96:99]
    buffer_load_dwordx4 a[40:43], v1, s[8:11], s34 offen offset:2048
    v_mfma_f32_16x16x32_bf16 v[208:211], a[172:175], a[144:147], v[208:211]
    s_waitcnt vmcnt(10) lgkmcnt(0)
    s_barrier
    v_mfma_f32_16x16x32_bf16 v[112:115], a[176:179], a[144:147], v[112:115]
    ds_read_b128 a[160:163], v1 offset:0
    v_mfma_f32_16x16x32_bf16 v[224:227], a[180:183], a[144:147], v[224:227]
    ds_read_b128 a[164:167], v1 offset:14336
    v_mfma_f32_16x16x32_bf16 v[116:119], a[176:179], a[148:151], v[116:119]
    v_mfma_f32_16x16x32_bf16 v[228:231], a[180:183], a[148:151], v[228:231]
    v_mfma_f32_16x16x32_bf16 v[120:123], a[176:179], a[152:155], v[120:123]
    v_mfma_f32_16x16x32_bf16 v[232:235], a[180:183], a[152:155], v[232:235]
    v_mfma_f32_16x16x32_bf16 v[124:127], a[176:179], a[156:159], v[124:127]
    buffer_load_dwordx4 a[44:47], v1, s[8:11], s34 offen offset:3072
    s_add_u32 s34, s34, 4096
    v_mfma_f32_16x16x32_bf16 v[236:239], a[180:183], a[156:159], v[236:239]
    v_mfma_f32_16x16x32_bf16 v[140:143], a[184:187], a[156:159], v[140:143]
    ds_read_b128 a[168:171], v1 offset:7168
    v_mfma_f32_16x16x32_bf16 v[252:255], a[188:191], a[156:159], v[252:255]
    ds_read_b128 a[172:175], v1 offset:21504
    v_mfma_f32_16x16x32_bf16 v[136:139], a[184:187], a[152:155], v[136:139]
    v_mfma_f32_16x16x32_bf16 v[248:251], a[188:191], a[152:155], v[248:251]
    buffer_load_dwordx4 a[48:51], v1, s[8:11], s34 offen offset:0
    v_mfma_f32_16x16x32_bf16 v[132:135], a[184:187], a[148:151], v[132:135]
    v_mfma_f32_16x16x32_bf16 v[244:247], a[188:191], a[148:151], v[244:247]
    v_mfma_f32_16x16x32_bf16 v[128:131], a[184:187], a[144:147], v[128:131]
    buffer_load_dwordx4 a[52:55], v1, s[8:11], s34 offen offset:1024
    v_mfma_f32_16x16x32_bf16 v[240:243], a[188:191], a[144:147], v[240:243]
    s_waitcnt lgkmcnt(2)
    v_mfma_f32_16x16x32_bf16 v[32:35], a[160:163], a[0:3], v[32:35]
    ds_read_b128 a[176:179], v1 offset:1024
    v_mfma_f32_16x16x32_bf16 v[32:35], a[164:167], a[16:19], v[32:35]
    ds_read_b128 a[180:183], v1 offset:15360
    v_mfma_f32_16x16x32_bf16 v[36:39], a[160:163], a[4:7], v[36:39]
    v_mfma_f32_16x16x32_bf16 v[36:39], a[164:167], a[20:23], v[36:39]
    v_mfma_f32_16x16x32_bf16 v[40:43], a[160:163], a[8:11], v[40:43]
    v_mfma_f32_16x16x32_bf16 v[40:43], a[164:167], a[24:27], v[40:43]
    v_mfma_f32_16x16x32_bf16 v[44:47], a[160:163], a[12:15], v[44:47]
    buffer_load_dwordx4 a[56:59], v1, s[8:11], s34 offen offset:2048
    v_mfma_f32_16x16x32_bf16 v[44:47], a[164:167], a[28:31], v[44:47]
    s_waitcnt lgkmcnt(2)
    v_mfma_f32_16x16x32_bf16 v[156:159], a[168:171], a[12:15], v[156:159]
    ds_read_b128 a[184:187], v1 offset:8192
    v_mfma_f32_16x16x32_bf16 v[156:159], a[172:175], a[28:31], v[156:159]
    ds_read_b128 a[188:191], v1 offset:22528
    v_mfma_f32_16x16x32_bf16 v[152:155], a[168:171], a[8:11], v[152:155]
    v_mfma_f32_16x16x32_bf16 v[152:155], a[172:175], a[24:27], v[152:155]
    buffer_load_dwordx4 a[60:63], v1, s[8:11], s34 offen offset:3072
    s_add_u32 s34, s34, 4096
    v_mfma_f32_16x16x32_bf16 v[148:151], a[168:171], a[4:7], v[148:151]
    v_mfma_f32_16x16x32_bf16 v[148:151], a[172:175], a[20:23], v[148:151]
    s_add_u32 m0, s36, 57344
    v_mfma_f32_16x16x32_bf16 v[144:147], a[168:171], a[0:3], v[144:147]
    buffer_load_dwordx4 v1, s[12:15], s35 offen offset:0 lds
    v_mfma_f32_16x16x32_bf16 v[144:147], a[172:175], a[16:19], v[144:147]
    s_waitcnt lgkmcnt(2)
    v_mfma_f32_16x16x32_bf16 v[48:51], a[176:179], a[0:3], v[48:51]
    ds_read_b128 a[160:163], v1 offset:2048
    v_mfma_f32_16x16x32_bf16 v[48:51], a[180:183], a[16:19], v[48:51]
    ds_read_b128 a[164:167], v1 offset:16384
    v_mfma_f32_16x16x32_bf16 v[52:55], a[176:179], a[4:7], v[52:55]
    v_mfma_f32_16x16x32_bf16 v[52:55], a[180:183], a[20:23], v[52:55]
    v_mfma_f32_16x16x32_bf16 v[56:59], a[176:179], a[8:11], v[56:59]
    v_mfma_f32_16x16x32_bf16 v[56:59], a[180:183], a[24:27], v[56:59]
    v_mfma_f32_16x16x32_bf16 v[60:63], a[176:179], a[12:15], v[60:63]
    buffer_load_dwordx4 v1, s[12:15], s35 offen offset:1024 lds
    v_mfma_f32_16x16x32_bf16 v[60:63], a[180:183], a[28:31], v[60:63]
    s_waitcnt lgkmcnt(2)
    v_mfma_f32_16x16x32_bf16 v[172:175], a[184:187], a[12:15], v[172:175]
    ds_read_b128 a[168:171], v1 offset:9216
    v_mfma_f32_16x16x32_bf16 v[172:175], a[188:191], a[28:31], v[172:175]
    ds_read_b128 a[172:175], v1 offset:23552
    v_mfma_f32_16x16x32_bf16 v[168:171], a[184:187], a[8:11], v[168:171]
    v_mfma_f32_16x16x32_bf16 v[168:171], a[188:191], a[24:27], v[168:171]
    buffer_load_dwordx4 v1, s[12:15], s35 offen offset:2048 lds
    v_mfma_f32_16x16x32_bf16 v[164:167], a[184:187], a[4:7], v[164:167]
    v_mfma_f32_16x16x32_bf16 v[164:167], a[188:191], a[20:23], v[164:167]
    v_mfma_f32_16x16x32_bf16 v[160:163], a[184:187], a[0:3], v[160:163]
    buffer_load_dwordx4 v1, s[12:15], s35 offen offset:3072 lds
    s_add_u32 s35, s35, 4096
    v_mfma_f32_16x16x32_bf16 v[160:163], a[188:191], a[16:19], v[160:163]
    s_waitcnt lgkmcnt(2)
    v_mfma_f32_16x16x32_bf16 v[64:67], a[160:163], a[0:3], v[64:67]
    ds_read_b128 a[176:179], v1 offset:3072
    v_mfma_f32_16x16x32_bf16 v[64:67], a[164:167], a[16:19], v[64:67]
    ds_read_b128 a[180:183], v1 offset:17408
    v_mfma_f32_16x16x32_bf16 v[68:71], a[160:163], a[4:7], v[68:71]
    v_mfma_f32_16x16x32_bf16 v[68:71], a[164:167], a[20:23], v[68:71]
    v_mfma_f32_16x16x32_bf16 v[72:75], a[160:163], a[8:11], v[72:75]
    v_mfma_f32_16x16x32_bf16 v[72:75], a[164:167], a[24:27], v[72:75]
    s_add_u32 m0, s36, 61440
    v_mfma_f32_16x16x32_bf16 v[76:79], a[160:163], a[12:15], v[76:79]
    buffer_load_dwordx4 v1, s[12:15], s35 offen offset:0 lds
    v_mfma_f32_16x16x32_bf16 v[76:79], a[164:167], a[28:31], v[76:79]
    s_waitcnt lgkmcnt(2)
    v_mfma_f32_16x16x32_bf16 v[188:191], a[168:171], a[12:15], v[188:191]
    ds_read_b128 a[184:187], v1 offset:10240
    v_mfma_f32_16x16x32_bf16 v[188:191], a[172:175], a[28:31], v[188:191]
    ds_read_b128 a[188:191], v1 offset:24576
    v_mfma_f32_16x16x32_bf16 v[184:187], a[168:171], a[8:11], v[184:187]
    v_mfma_f32_16x16x32_bf16 v[184:187], a[172:175], a[24:27], v[184:187]
    buffer_load_dwordx4 v1, s[12:15], s35 offen offset:1024 lds
    v_mfma_f32_16x16x32_bf16 v[180:183], a[168:171], a[4:7], v[180:183]
    v_mfma_f32_16x16x32_bf16 v[180:183], a[172:175], a[20:23], v[180:183]
    v_mfma_f32_16x16x32_bf16 v[176:179], a[168:171], a[0:3], v[176:179]
    buffer_load_dwordx4 v1, s[12:15], s35 offen offset:2048 lds
    s_add_u32 s35, s35, 24576
    v_mfma_f32_16x16x32_bf16 v[176:179], a[172:175], a[16:19], v[176:179]
    s_waitcnt lgkmcnt(2)
    v_mfma_f32_16x16x32_bf16 v[80:83], a[176:179], a[0:3], v[80:83]
    ds_read_b128 a[160:163], v1 offset:4096
    v_mfma_f32_16x16x32_bf16 v[80:83], a[180:183], a[16:19], v[80:83]
    ds_read_b128 a[164:167], v1 offset:18432
    v_mfma_f32_16x16x32_bf16 v[84:87], a[176:179], a[4:7], v[84:87]
    v_mfma_f32_16x16x32_bf16 v[84:87], a[180:183], a[20:23], v[84:87]
    v_mfma_f32_16x16x32_bf16 v[88:91], a[176:179], a[8:11], v[88:91]
    v_mfma_f32_16x16x32_bf16 v[88:91], a[180:183], a[24:27], v[88:91]
    v_mfma_f32_16x16x32_bf16 v[92:95], a[176:179], a[12:15], v[92:95]
    buffer_load_dwordx4 a[64:67], v1, s[8:11], s34 offen offset:0
    v_mfma_f32_16x16x32_bf16 v[92:95], a[180:183], a[28:31], v[92:95]
    s_waitcnt lgkmcnt(2)
    v_mfma_f32_16x16x32_bf16 v[204:207], a[184:187], a[12:15], v[204:207]
    ds_read_b128 a[168:171], v1 offset:11264
    v_mfma_f32_16x16x32_bf16 v[204:207], a[188:191], a[28:31], v[204:207]
    ds_read_b128 a[172:175], v1 offset:25600
    v_mfma_f32_16x16x32_bf16 v[200:203], a[184:187], a[8:11], v[200:203]
    s_branch L_isl6_over
.p2align 12
L_isl6:
    s_setpc_b64 s[14:15]
L_isl6_over:
    v_mfma_f32_16x16x32_bf16 v[200:203], a[188:191], a[24:27], v[200:203]
    buffer_load_dwordx4 a[68:71], v1, s[8:11], s34 offen offset:1024
    v_mfma_f32_16x16x32_bf16 v[196:199], a[184:187], a[4:7], v[196:199]
    v_mfma_f32_16x16x32_bf16 v[196:199], a[188:191], a[20:23], v[196:199]
    v_mfma_f32_16x16x32_bf16 v[192:195], a[184:187], a[0:3], v[192:195]
    buffer_load_dwordx4 a[72:75], v1, s[8:11], s34 offen offset:2048
    v_mfma_f32_16x16x32_bf16 v[192:195], a[188:191], a[16:19], v[192:195]
    s_waitcnt lgkmcnt(2)
    v_mfma_f32_16x16x32_bf16 v[96:99], a[160:163], a[0:3], v[96:99]
    ds_read_b128 a[176:179], v1 offset:5120
    v_mfma_f32_16x16x32_bf16 v[96:99], a[164:167], a[16:19], v[96:99]
    ds_read_b128 a[180:183], v1 offset:19456
    v_mfma_f32_16x16x32_bf16 v[100:103], a[160:163], a[4:7], v[100:103]
    v_mfma_f32_16x16x32_bf16 v[100:103], a[164:167], a[20:23], v[100:103]
    v_mfma_f32_16x16x32_bf16 v[104:107], a[160:163], a[8:11], v[104:107]
    v_mfma_f32_16x16x32_bf16 v[104:107], a[164:167], a[24:27], v[104:107]
    v_mfma_f32_16x16x32_bf16 v[108:111], a[160:163], a[12:15], v[108:111]
    buffer_load_dwordx4 a[76:79], v1, s[8:11], s34 offen offset:3072
    s_add_u32 s34, s34, 4096
    v_mfma_f32_16x16x32_bf16 v[108:111], a[164:167], a[28:31], v[108:111]
    s_waitcnt lgkmcnt(2)
    v_mfma_f32_16x16x32_bf16 v[220:223], a[168:171], a[12:15], v[220:223]
    ds_read_b128 a[184:187], v1 offset:12288
    v_mfma_f32_16x16x32_bf16 v[220:223], a[172:175], a[28:31], v[220:223]
    ds_read_b128 a[188:191], v1 offset:26624
    v_mfma_f32_16x16x32_bf16 v[216:219], a[168:171], a[8:11], v[216:219]
    v_mfma_f32_16x16x32_bf16 v[216:219], a[172:175], a[24:27], v[216:219]
    buffer_load_dwordx4 a[80:83], v1, s[8:11], s34 offen offset:0
    v_mfma_f32_16x16x32_bf16 v[212:215], a[168:171], a[4:7], v[212:215]
    v_mfma_f32_16x16x32_bf16 v[212:215], a[172:175], a[20:23], v[212:215]
    v_mfma_f32_16x16x32_bf16 v[208:211], a[168:171], a[0:3], v[208:211]
    buffer_load_dwordx4 a[84:87], v1, s[8:11], s34 offen offset:1024
    v_mfma_f32_16x16x32_bf16 v[208:211], a[172:175], a[16:19], v[208:211]
    s_waitcnt lgkmcnt(2)
    v_mfma_f32_16x16x32_bf16 v[112:115], a[176:179], a[0:3], v[112:115]
    ds_read_b128 a[160:163], v1 offset:6144
    v_mfma_f32_16x16x32_bf16 v[112:115], a[180:183], a[16:19], v[112:115]
    ds_read_b128 a[164:167], v1 offset:20480
    v_mfma_f32_16x16x32_bf16 v[116:119], a[176:179], a[4:7], v[116:119]
    v_mfma_f32_16x16x32_bf16 v[116:119], a[180:183], a[20:23], v[116:119]
    v_mfma_f32_16x16x32_bf16 v[120:123], a[176:179], a[8:11], v[120:123]
    v_mfma_f32_16x16x32_bf16 v[120:123], a[180:183], a[24:27], v[120:123]
    v_mfma_f32_16x16x32_bf16 v[124:127], a[176:179], a[12:15], v[124:127]
    buffer_load_dwordx4 a[88:91], v1, s[8:11], s34 offen offset:2048
    v_mfma_f32_16x16x32_bf16 v[124:127], a[180:183], a[28:31], v[124:127]
    s_waitcnt lgkmcnt(2)
    v_mfma_f32_16x16x32_bf16 v[236:239], a[184:187], a[12:15], v[236:239]
    ds_read_b128 a[168:171], v1 offset:13312
    v_mfma_f32_16x16x32_bf16 v[236:239], a[188:191], a[28:31], v[236:239]
    ds_read_b128 a[172:175], v1 offset:27648
    v_mfma_f32_16x16x32_bf16 v[232:235], a[184:187], a[8:11], v[232:235]
    v_mfma_f32_16x16x32_bf16 v[232:235], a[188:191], a[24:27], v[232:235]
    buffer_load_dwordx4 a[92:95], v1, s[8:11], s34 offen offset:3072
    s_add_u32 s34, s34, 4096
    v_mfma_f32_16x16x32_bf16 v[228:231], a[184:187], a[4:7], v[228:231]
    v_mfma_f32_16x16x32_bf16 v[228:231], a[188:191], a[20:23], v[228:231]
    v_mfma_f32_16x16x32_bf16 v[224:227], a[184:187], a[0:3], v[224:227]
    buffer_load_dwordx4 a[192:195], v1, s[4:7], s40 offen offset:0
    v_mfma_f32_16x16x32_bf16 v[224:227], a[188:191], a[16:19], v[224:227]
    s_waitcnt vmcnt(16) lgkmcnt(0)
    s_barrier
    v_mfma_f32_16x16x32_bf16 v[128:131], a[160:163], a[0:3], v[128:131]
    ds_read_b128 a[176:179], v1 offset:28672
    v_mfma_f32_16x16x32_bf16 v[128:131], a[164:167], a[16:19], v[128:131]
    ds_read_b128 a[180:183], v1 offset:43008
    v_mfma_f32_16x16x32_bf16 v[132:135], a[160:163], a[4:7], v[132:135]
    v_mfma_f32_16x16x32_bf16 v[132:135], a[164:167], a[20:23], v[132:135]
    buffer_load_dwordx4 a[196:199], v1, s[4:7], s40 offen offset:1024
    v_mfma_f32_16x16x32_bf16 v[136:139], a[160:163], a[8:11], v[136:139]
    v_mfma_f32_16x16x32_bf16 v[136:139], a[164:167], a[24:27], v[136:139]
    v_mfma_f32_16x16x32_bf16 v[140:143], a[160:163], a[12:15], v[140:143]
    v_mfma_f32_16x16x32_bf16 v[140:143], a[164:167], a[28:31], v[140:143]
    v_mfma_f32_16x16x32_bf16 v[252:255], a[168:171], a[12:15], v[252:255]
    ds_read_b128 a[184:187], v1 offset:35840
    v_mfma_f32_16x16x32_bf16 v[252:255], a[172:175], a[28:31], v[252:255]
    ds_read_b128 a[188:191], v1 offset:50176
    v_mfma_f32_16x16x32_bf16 v[248:251], a[168:171], a[8:11], v[248:251]
    v_mfma_f32_16x16x32_bf16 v[248:251], a[172:175], a[24:27], v[248:251]
    buffer_load_dwordx4 a[200:203], v1, s[4:7], s40 offen offset:2048
    v_mfma_f32_16x16x32_bf16 v[244:247], a[168:171], a[4:7], v[244:247]
    v_mfma_f32_16x16x32_bf16 v[244:247], a[172:175], a[20:23], v[244:247]
    v_mfma_f32_16x16x32_bf16 v[240:243], a[168:171], a[0:3], v[240:243]
    buffer_load_dwordx4 a[204:207], v1, s[4:7], s40 offen offset:3072
    s_add_u32 s40, s40, 4096
    v_mfma_f32_16x16x32_bf16 v[240:243], a[172:175], a[16:19], v[240:243]
    s_waitcnt lgkmcnt(2)
    v_mfma_f32_16x16x32_bf16 v[32:35], a[176:179], a[32:35], v[32:35]
    ds_read_b128 a[160:163], v1 offset:29696
    v_mfma_f32_16x16x32_bf16 v[32:35], a[180:183], a[48:51], v[32:35]
    ds_read_b128 a[164:167], v1 offset:44032
    v_mfma_f32_16x16x32_bf16 v[36:39], a[176:179], a[36:39], v[36:39]
    v_mfma_f32_16x16x32_bf16 v[36:39], a[180:183], a[52:55], v[36:39]
    buffer_load_dwordx4 a[208:211], v1, s[4:7], s40 offen offset:0
    v_mfma_f32_16x16x32_bf16 v[40:43], a[176:179], a[40:43], v[40:43]
    v_mfma_f32_16x16x32_bf16 v[40:43], a[180:183], a[56:59], v[40:43]
    v_mfma_f32_16x16x32_bf16 v[44:47], a[176:179], a[44:47], v[44:47]
    v_mfma_f32_16x16x32_bf16 v[44:47], a[180:183], a[60:63], v[44:47]
    s_waitcnt lgkmcnt(2)
    v_mfma_f32_16x16x32_bf16 v[156:159], a[184:187], a[44:47], v[156:159]
    ds_read_b128 a[168:171], v1 offset:36864
    v_mfma_f32_16x16x32_bf16 v[156:159], a[188:191], a[60:63], v[156:159]
    ds_read_b128 a[172:175], v1 offset:51200
    v_mfma_f32_16x16x32_bf16 v[152:155], a[184:187], a[40:43], v[152:155]
    v_mfma_f32_16x16x32_bf16 v[152:155], a[188:191], a[56:59], v[152:155]
    buffer_load_dwordx4 a[212:215], v1, s[4:7], s40 offen offset:1024
    v_mfma_f32_16x16x32_bf16 v[148:151], a[184:187], a[36:39], v[148:151]
    v_mfma_f32_16x16x32_bf16 v[148:151], a[188:191], a[52:55], v[148:151]
    v_mfma_f32_16x16x32_bf16 v[144:147], a[184:187], a[32:35], v[144:147]
    buffer_load_dwordx4 a[216:219], v1, s[4:7], s40 offen offset:2048
    v_mfma_f32_16x16x32_bf16 v[144:147], a[188:191], a[48:51], v[144:147]
    s_waitcnt lgkmcnt(2)
    v_mfma_f32_16x16x32_bf16 v[48:51], a[160:163], a[32:35], v[48:51]
    ds_read_b128 a[176:179], v1 offset:30720
    v_mfma_f32_16x16x32_bf16 v[48:51], a[164:167], a[48:51], v[48:51]
    ds_read_b128 a[180:183], v1 offset:45056
    v_mfma_f32_16x16x32_bf16 v[52:55], a[160:163], a[36:39], v[52:55]
    v_mfma_f32_16x16x32_bf16 v[52:55], a[164:167], a[52:55], v[52:55]
    buffer_load_dwordx4 a[220:223], v1, s[4:7], s40 offen offset:3072
    v_mfma_f32_16x16x32_bf16 v[56:59], a[160:163], a[40:43], v[56:59]
    v_mfma_f32_16x16x32_bf16 v[56:59], a[164:167], a[56:59], v[56:59]
    v_mfma_f32_16x16x32_bf16 v[60:63], a[160:163], a[44:47], v[60:63]
    v_mfma_f32_16x16x32_bf16 v[60:63], a[164:167], a[60:63], v[60:63]
    s_waitcnt lgkmcnt(2)
    v_mfma_f32_16x16x32_bf16 v[172:175], a[168:171], a[44:47], v[172:175]
    ds_read_b128 a[184:187], v1 offset:37888
    v_mfma_f32_16x16x32_bf16 v[172:175], a[172:175], a[60:63], v[172:175]
    ds_read_b128 a[188:191], v1 offset:52224
    v_mfma_f32_16x16x32_bf16 v[168:171], a[168:171], a[40:43], v[168:171]
    v_mfma_f32_16x16x32_bf16 v[168:171], a[172:175], a[56:59], v[168:171]
    buffer_load_dword a224, v6, s[4:7], s41 offen
    s_add_u32 s41, s41, 28672
    v_mfma_f32_16x16x32_bf16 v[164:167], a[168:171], a[36:39], v[164:167]
    v_mfma_f32_16x16x32_bf16 v[164:167], a[172:175], a[52:55], v[164:167]
    v_mfma_f32_16x16x32_bf16 v[160:163], a[168:171], a[32:35], v[160:163]
    buffer_load_dword a225, v6, s[4:7], s41 offen
    s_add_u32 s41, s41, 28672
    v_mfma_f32_16x16x32_bf16 v[160:163], a[172:175], a[48:51], v[160:163]
    s_waitcnt lgkmcnt(2)
    v_mfma_f32_16x16x32_bf16 v[64:67], a[176:179], a[32:35], v[64:67]
    ds_read_b128 a[160:163], v1 offset:31744
    v_mfma_f32_16x16x32_bf16 v[64:67], a[180:183], a[48:51], v[64:67]
    ds_read_b128 a[164:167], v1 offset:46080
    v_mfma_f32_16x16x32_bf16 v[68:71], a[176:179], a[36:39], v[68:71]
    v_mfma_f32_16x16x32_bf16 v[68:71], a[180:183], a[52:55], v[68:71]
    buffer_load_dword a226, v6, s[4:7], s41 offen
    s_add_u32 s41, s41, 28672
    v_mfma_f32_16x16x32_bf16 v[72:75], a[176:179], a[40:43], v[72:75]
    v_mfma_f32_16x16x32_bf16 v[72:75], a[180:183], a[56:59], v[72:75]
    v_mfma_f32_16x16x32_bf16 v[76:79], a[176:179], a[44:47], v[76:79]
    v_mfma_f32_16x16x32_bf16 v[76:79], a[180:183], a[60:63], v[76:79]
    s_waitcnt lgkmcnt(2)
    v_mfma_f32_16x16x32_bf16 v[188:191], a[184:187], a[44:47], v[188:191]
    ds_read_b128 a[168:171], v1 offset:38912
    v_mfma_f32_16x16x32_bf16 v[188:191], a[188:191], a[60:63], v[188:191]
    ds_read_b128 a[172:175], v1 offset:53248
    v_mfma_f32_16x16x32_bf16 v[184:187], a[184:187], a[40:43], v[184:187]
    v_mfma_f32_16x16x32_bf16 v[184:187], a[188:191], a[56:59], v[184:187]
    buffer_load_dword a227, v6, s[4:7], s41 offen
    s_add_u32 s41, s41, 28672
    v_mfma_f32_16x16x32_bf16 v[180:183], a[184:187], a[36:39], v[180:183]
    v_mfma_f32_16x16x32_bf16 v[180:183], a[188:191], a[52:55], v[180:183]
    v_mfma_f32_16x16x32_bf16 v[176:179], a[184:187], a[32:35], v[176:179]
    buffer_load_dword a228, v6, s[4:7], s41 offen
    s_add_u32 s41, s41, 28672
    v_mfma_f32_16x16x32_bf16 v[176:179], a[188:191], a[48:51], v[176:179]
    s_waitcnt lgkmcnt(2)
    v_mfma_f32_16x16x32_bf16 v[80:83], a[160:163], a[32:35], v[80:83]
    ds_read_b128 a[176:179], v1 offset:32768
    v_mfma_f32_16x16x32_bf16 v[80:83], a[164:167], a[48:51], v[80:83]
    ds_read_b128 a[180:183], v1 offset:47104
    v_mfma_f32_16x16x32_bf16 v[84:87], a[160:163], a[36:39], v[84:87]
    v_mfma_f32_16x16x32_bf16 v[84:87], a[164:167], a[52:55], v[84:87]
    buffer_load_dword a229, v6, s[4:7], s41 offen
    s_add_u32 s41, s41, 28672
    v_mfma_f32_16x16x32_bf16 v[88:91], a[160:163], a[40:43], v[88:91]
    v_mfma_f32_16x16x32_bf16 v[88:91], a[164:167], a[56:59], v[88:91]
    v_mfma_f32_16x16x32_bf16 v[92:95], a[160:163], a[44:47], v[92:95]
    v_mfma_f32_16x16x32_bf16 v[92:95], a[164:167], a[60:63], v[92:95]
    s_waitcnt lgkmcnt(2)
    v_mfma_f32_16x16x32_bf16 v[204:207], a[168:171], a[44:47], v[204:207]
    ds_read_b128 a[184:187], v1 offset:39936
    v_mfma_f32_16x16x32_bf16 v[204:207], a[172:175], a[60:63], v[204:207]
    ds_read_b128 a[188:191], v1 offset:54272
    v_mfma_f32_16x16x32_bf16 v[200:203], a[168:171], a[40:43], v[200:203]
    v_mfma_f32_16x16x32_bf16 v[200:203], a[172:175], a[56:59], v[200:203]
    buffer_load_dword a230, v6, s[4:7], s41 offen
    s_add_u32 s41, s41, 28672
    v_mfma_f32_16x16x32_bf16 v[196:199], a[168:171], a[36:39], v[196:199]
    v_mfma_f32_16x16x32_bf16 v[196:199], a[172:175], a[52:55], v[196:199]
    v_mfma_f32_16x16x32_bf16 v[192:195], a[168:171], a[32:35], v[192:195]
    buffer_load_dword a231, v6, s[4:7], s41 offen
    s_add_u32 s41, s41, 28672
    v_mfma_f32_16x16x32_bf16 v[192:195], a[172:175], a[48:51], v[192:195]
    s_waitcnt lgkmcnt(2)
    v_mfma_f32_16x16x32_bf16 v[96:99], a[176:179], a[32:35], v[96:99]
    ds_read_b128 a[160:163], v1 offset:33792
    v_mfma_f32_16x16x32_bf16 v[96:99], a[180:183], a[48:51], v[96:99]
    ds_read_b128 a[164:167], v1 offset:48128
    v_mfma_f32_16x16x32_bf16 v[100:103], a[176:179], a[36:39], v[100:103]
    s_add_u32 m0, s36, 86016
    v_mfma_f32_16x16x32_bf16 v[100:103], a[180:183], a[52:55], v[100:103]
    buffer_load_dwordx4 v1, s[12:15], s35 offen offset:0 lds
    v_mfma_f32_16x16x32_bf16 v[104:107], a[176:179], a[40:43], v[104:107]
    v_mfma_f32_16x16x32_bf16 v[104:107], a[180:183], a[56:59], v[104:107]
    v_mfma_f32_16x16x32_bf16 v[108:111], a[176:179], a[44:47], v[108:111]
    v_mfma_f32_16x16x32_bf16 v[108:111], a[180:183], a[60:63], v[108:111]
    s_waitcnt lgkmcnt(2)
    v_mfma_f32_16x16x32_bf16 v[220:223], a[184:187], a[44:47], v[220:223]
    ds_read_b128 a[168:171], v1 offset:40960
    v_mfma_f32_16x16x32_bf16 v[220:223], a[188:191], a[60:63], v[220:223]
    ds_read_b128 a[172:175], v1 offset:55296
    v_mfma_f32_16x16x32_bf16 v[216:219], a[184:187], a[40:43], v[216:219]
    v_mfma_f32_16x16x32_bf16 v[216:219], a[188:191], a[56:59], v[216:219]
    buffer_load_dwordx4 v1, s[12:15], s35 offen offset:1024 lds
    v_mfma_f32_16x16x32_bf16 v[212:215], a[184:187], a[36:39], v[212:215]
    v_mfma_f32_16x16x32_bf16 v[212:215], a[188:191], a[52:55], v[212:215]
    v_mfma_f32_16x16x32_bf16 v[208:211], a[184:187], a[32:35], v[208:211]
    buffer_load_dwordx4 v1, s[12:15], s35 offen offset:2048 lds
    v_mfma_f32_16x16x32_bf16 v[208:211], a[188:191], a[48:51], v[208:211]
    s_waitcnt lgkmcnt(2)
    v_mfma_f32_16x16x32_bf16 v[112:115], a[160:163], a[32:35], v[112:115]
    ds_read_b128 a[176:179], v1 offset:34816
    v_mfma_f32_16x16x32_bf16 v[112:115], a[164:167], a[48:51], v[112:115]
    ds_read_b128 a[180:183], v1 offset:49152
    v_mfma_f32_16x16x32_bf16 v[116:119], a[160:163], a[36:39], v[116:119]
    v_mfma_f32_16x16x32_bf16 v[116:119], a[164:167], a[52:55], v[116:119]
    buffer_load_dwordx4 v1, s[12:15], s35 offen offset:3072 lds
    s_add_u32 s35, s35, 4096
    v_mfma_f32_16x16x32_bf16 v[120:123], a[160:163], a[40:43], v[120:123]
    v_mfma_f32_16x16x32_bf16 v[120:123], a[164:167], a[56:59], v[120:123]
    v_mfma_f32_16x16x32_bf16 v[124:127], a[160:163], a[44:47], v[124:127]
    v_mfma_f32_16x16x32_bf16 v[124:127], a[164:167], a[60:63], v[124:127]
    s_waitcnt lgkmcnt(2)
    v_mfma_f32_16x16x32_bf16 v[236:239], a[168:171], a[44:47], v[236:239]
    ds_read_b128 a[184:187], v1 offset:41984
    v_mfma_f32_16x16x32_bf16 v[236:239], a[172:175], a[60:63], v[236:239]
    ds_read_b128 a[188:191], v1 offset:56320
    v_mfma_f32_16x16x32_bf16 v[232:235], a[168:171], a[40:43], v[232:235]
    s_add_u32 m0, s36, 90112
    v_mfma_f32_16x16x32_bf16 v[232:235], a[172:175], a[56:59], v[232:235]
    buffer_load_dwordx4 v1, s[12:15], s35 offen offset:0 lds
    v_mfma_f32_16x16x32_bf16 v[228:231], a[168:171], a[36:39], v[228:231]
    v_mfma_f32_16x16x32_bf16 v[228:231], a[172:175], a[52:55], v[228:231]
    v_mfma_f32_16x16x32_bf16 v[224:227], a[168:171], a[32:35], v[224:227]
    buffer_load_dwordx4 v1, s[12:15], s35 offen offset:1024 lds
    v_mfma_f32_16x16x32_bf16 v[224:227], a[172:175], a[48:51], v[224:227]
    s_waitcnt vmcnt(22) lgkmcnt(0)
    s_barrier
    v_mfma_f32_16x16x32_bf16 v[128:131], a[176:179], a[32:35], v[128:131]
    ds_read_b128 a[160:163], v2 offset:0
    v_mfma_f32_16x16x32_bf16 v[128:131], a[180:183], a[48:51], v[128:131]
    ds_read_b128 a[164:167], v2 offset:14336
    v_mfma_f32_16x16x32_bf16 v[132:135], a[176:179], a[36:39], v[132:135]
    v_mfma_f32_16x16x32_bf16 v[132:135], a[180:183], a[52:55], v[132:135]
    buffer_load_dwordx4 v1, s[12:15], s35 offen offset:2048 lds
    s_add_u32 s35, s35, 24576
    v_mfma_f32_16x16x32_bf16 v[136:139], a[176:179], a[40:43], v[136:139]
    v_mfma_f32_16x16x32_bf16 v[136:139], a[180:183], a[56:59], v[136:139]
    v_mfma_f32_16x16x32_bf16 v[140:143], a[176:179], a[44:47], v[140:143]
    v_mfma_f32_16x16x32_bf16 v[140:143], a[180:183], a[60:63], v[140:143]
    v_mfma_f32_16x16x32_bf16 v[252:255], a[184:187], a[44:47], v[252:255]
    ds_read_b128 a[168:171], v2 offset:7168
    v_mfma_f32_16x16x32_bf16 v[252:255], a[188:191], a[60:63], v[252:255]
    ds_read_b128 a[172:175], v2 offset:21504
    v_mfma_f32_16x16x32_bf16 v[248:251], a[184:187], a[40:43], v[248:251]
    v_mfma_f32_16x16x32_bf16 v[248:251], a[188:191], a[56:59], v[248:251]
    buffer_load_dwordx4 a[96:99], v1, s[8:11], s34 offen offset:0
    v_mfma_f32_16x16x32_bf16 v[244:247], a[184:187], a[36:39], v[244:247]
    v_mfma_f32_16x16x32_bf16 v[244:247], a[188:191], a[52:55], v[244:247]
    v_mfma_f32_16x16x32_bf16 v[240:243], a[184:187], a[32:35], v[240:243]
    buffer_load_dwordx4 a[100:103], v1, s[8:11], s34 offen offset:1024
    v_mfma_f32_16x16x32_bf16 v[240:243], a[188:191], a[48:51], v[240:243]
    s_waitcnt lgkmcnt(2)
    v_mfma_f32_16x16x32_bf16 v[32:35], a[160:163], a[64:67], v[32:35]
    ds_read_b128 a[176:179], v2 offset:1024
    v_mfma_f32_16x16x32_bf16 v[32:35], a[164:167], a[80:83], v[32:35]
    ds_read_b128 a[180:183], v2 offset:15360
    v_mfma_f32_16x16x32_bf16 v[36:39], a[160:163], a[68:71], v[36:39]
    v_mfma_f32_16x16x32_bf16 v[36:39], a[164:167], a[84:87], v[36:39]
    buffer_load_dwordx4 a[104:107], v1, s[8:11], s34 offen offset:2048
    v_mfma_f32_16x16x32_bf16 v[40:43], a[160:163], a[72:75], v[40:43]
    v_mfma_f32_16x16x32_bf16 v[40:43], a[164:167], a[88:91], v[40:43]
    v_mfma_f32_16x16x32_bf16 v[44:47], a[160:163], a[76:79], v[44:47]
    v_mfma_f32_16x16x32_bf16 v[44:47], a[164:167], a[92:95], v[44:47]
    s_waitcnt lgkmcnt(2)
    v_mfma_f32_16x16x32_bf16 v[156:159], a[168:171], a[76:79], v[156:159]
    ds_read_b128 a[184:187], v2 offset:8192
    v_mfma_f32_16x16x32_bf16 v[156:159], a[172:175], a[92:95], v[156:159]
    ds_read_b128 a[188:191], v2 offset:22528
    v_mfma_f32_16x16x32_bf16 v[152:155], a[168:171], a[72:75], v[152:155]
    v_mfma_f32_16x16x32_bf16 v[152:155], a[172:175], a[88:91], v[152:155]
    buffer_load_dwordx4 a[108:111], v1, s[8:11], s34 offen offset:3072
    s_add_u32 s34, s34, 4096
    v_mfma_f32_16x16x32_bf16 v[148:151], a[168:171], a[68:71], v[148:151]
    v_mfma_f32_16x16x32_bf16 v[148:151], a[172:175], a[84:87], v[148:151]
    v_mfma_f32_16x16x32_bf16 v[144:147], a[168:171], a[64:67], v[144:147]
    buffer_load_dwordx4 a[112:115], v1, s[8:11], s34 offen offset:0
    v_mfma_f32_16x16x32_bf16 v[144:147], a[172:175], a[80:83], v[144:147]
    s_waitcnt lgkmcnt(2)
    v_mfma_f32_16x16x32_bf16 v[48:51], a[176:179], a[64:67], v[48:51]
    ds_read_b128 a[160:163], v2 offset:2048
    v_mfma_f32_16x16x32_bf16 v[48:51], a[180:183], a[80:83], v[48:51]
    ds_read_b128 a[164:167], v2 offset:16384
    v_mfma_f32_16x16x32_bf16 v[52:55], a[176:179], a[68:71], v[52:55]
    v_mfma_f32_16x16x32_bf16 v[52:55], a[180:183], a[84:87], v[52:55]
    buffer_load_dwordx4 a[116:119], v1, s[8:11], s34 offen offset:1024
    v_mfma_f32_16x16x32_bf16 v[56:59], a[176:179], a[72:75], v[56:59]
    v_mfma_f32_16x16x32_bf16 v[56:59], a[180:183], a[88:91], v[56:59]
    v_mfma_f32_16x16x32_bf16 v[60:63], a[176:179], a[76:79], v[60:63]
    v_mfma_f32_16x16x32_bf16 v[60:63], a[180:183], a[92:95], v[60:63]
    s_waitcnt lgkmcnt(2)
    v_mfma_f32_16x16x32_bf16 v[172:175], a[184:187], a[76:79], v[172:175]
    ds_read_b128 a[168:171], v2 offset:9216
    v_mfma_f32_16x16x32_bf16 v[172:175], a[188:191], a[92:95], v[172:175]
    ds_read_b128 a[172:175], v2 offset:23552
    v_mfma_f32_16x16x32_bf16 v[168:171], a[184:187], a[72:75], v[168:171]
    v_mfma_f32_16x16x32_bf16 v[168:171], a[188:191], a[88:91], v[168:171]
    buffer_load_dwordx4 a[120:123], v1, s[8:11], s34 offen offset:2048
    v_mfma_f32_16x16x32_bf16 v[164:167], a[184:187], a[68:71], v[164:167]
    v_mfma_f32_16x16x32_bf16 v[164:167], a[188:191], a[84:87], v[164:167]
    v_mfma_f32_16x16x32_bf16 v[160:163], a[184:187], a[64:67], v[160:163]
    buffer_load_dwordx4 a[124:127], v1, s[8:11], s34 offen offset:3072
    s_add_u32 s34, s34, 4096
    v_mfma_f32_16x16x32_bf16 v[160:163], a[188:191], a[80:83], v[160:163]
    s_waitcnt lgkmcnt(2)
    v_mfma_f32_16x16x32_bf16 v[64:67], a[160:163], a[64:67], v[64:67]
    ds_read_b128 a[176:179], v2 offset:3072
    v_mfma_f32_16x16x32_bf16 v[64:67], a[164:167], a[80:83], v[64:67]
    ds_read_b128 a[180:183], v2 offset:17408
    v_mfma_f32_16x16x32_bf16 v[68:71], a[160:163], a[68:71], v[68:71]
    s_add_u32 m0, s36, 114688
    v_mfma_f32_16x16x32_bf16 v[68:71], a[164:167], a[84:87], v[68:71]
    buffer_load_dwordx4 v1, s[12:15], s35 offen offset:0 lds
    v_mfma_f32_16x16x32_bf16 v[72:75], a[160:163], a[72:75], v[72:75]
    v_mfma_f32_16x16x32_bf16 v[72:75], a[164:167], a[88:91], v[72:75]
    v_mfma_f32_16x16x32_bf16 v[76:79], a[160:163], a[76:79], v[76:79]
    v_mfma_f32_16x16x32_bf16 v[76:79], a[164:167], a[92:95], v[76:79]
    s_waitcnt lgkmcnt(2)
    v_mfma_f32_16x16x32_bf16 v[188:191], a[168:171], a[76:79], v[188:191]
    ds_read_b128 a[184:187], v2 offset:10240
    s_waitcnt vmcnt(16)
    v_mfma_f32_16x16x32_bf16 v[188:191], a[172:175], a[92:95], v[188:191]
    ds_read_b128 a[188:191], v2 offset:24576
    v_accvgpr_read_b32 v28, a224
    v_mfma_f32_16x16x32_bf16 v[184:187], a[168:171], a[72:75], v[184:187]
    v_accvgpr_read_b32 v24, a225
    v_add_f32 v28, v28, v24
    v_mfma_f32_16x16x32_bf16 v[184:187], a[172:175], a[88:91], v[184:187]
    buffer_load_dwordx4 v1, s[12:15], s35 offen offset:1024 lds
    v_accvgpr_read_b32 v24, a226
    v_mfma_f32_16x16x32_bf16 v[180:183], a[168:171], a[68:71], v[180:183]
    v_add_f32 v28, v28, v24
    v_accvgpr_read_b32 v24, a227
    v_mfma_f32_16x16x32_bf16 v[180:183], a[172:175], a[84:87], v[180:183]
    v_add_f32 v28, v28, v24
    v_accvgpr_read_b32 v24, a228
    v_mfma_f32_16x16x32_bf16 v[176:179], a[168:171], a[64:67], v[176:179]
    buffer_load_dwordx4 v1, s[12:15], s35 offen offset:2048 lds
    v_add_f32 v28, v28, v24
    v_mfma_f32_16x16x32_bf16 v[176:179], a[172:175], a[80:83], v[176:179]
    s_waitcnt lgkmcnt(2)
    v_accvgpr_read_b32 v24, a229
    v_mfma_f32_16x16x32_bf16 v[80:83], a[176:179], a[64:67], v[80:83]
    ds_read_b128 a[160:163], v2 offset:4096
    v_add_f32 v28, v28, v24
    v_mfma_f32_16x16x32_bf16 v[80:83], a[180:183], a[80:83], v[80:83]
    ds_read_b128 a[164:167], v2 offset:18432
    v_accvgpr_read_b32 v24, a230
    v_mfma_f32_16x16x32_bf16 v[84:87], a[176:179], a[68:71], v[84:87]
    v_add_f32 v28, v28, v24
    v_accvgpr_read_b32 v24, a231
    v_mfma_f32_16x16x32_bf16 v[84:87], a[180:183], a[84:87], v[84:87]
    buffer_load_dwordx4 v1, s[12:15], s35 offen offset:3072 lds
    s_add_u32 s35, s35, 4096
    v_mfma_f32_16x16x32_bf16 v[88:91], a[176:179], a[72:75], v[88:91]
    v_add_f32 v28, v28, v24
    v_add_u32 v6, 143360, v6
    v_mfma_f32_16x16x32_bf16 v[88:91], a[180:183], a[88:91], v[88:91]
    ds_write_b32 v6, v28
    v_accvgpr_read_b32 v20, a192
    v_mfma_f32_16x16x32_bf16 v[92:95], a[176:179], a[76:79], v[92:95]
    v_accvgpr_read_b32 v21, a193
    v_accvgpr_read_b32 v22, a194
    v_mfma_f32_16x16x32_bf16 v[92:95], a[180:183], a[92:95], v[92:95]
    s_waitcnt lgkmcnt(3)
    v_accvgpr_read_b32 v23, a195
    v_mfma_f32_16x16x32_bf16 v[204:207], a[184:187], a[76:79], v[204:207]
    ds_read_b128 a[168:171], v2 offset:11264
    v_accvgpr_read_b32 v24, a196
    v_mfma_f32_16x16x32_bf16 v[204:207], a[188:191], a[92:95], v[204:207]
    ds_read_b128 a[172:175], v2 offset:25600
    v_accvgpr_read_b32 v25, a197
    v_mfma_f32_16x16x32_bf16 v[200:203], a[184:187], a[72:75], v[200:203]
    s_add_u32 m0, s36, 118784
    v_accvgpr_read_b32 v26, a198
    v_mfma_f32_16x16x32_bf16 v[200:203], a[188:191], a[88:91], v[200:203]
    buffer_load_dwordx4 v1, s[12:15], s35 offen offset:0 lds
    v_accvgpr_read_b32 v27, a199
    v_mfma_f32_16x16x32_bf16 v[196:199], a[184:187], a[68:71], v[196:199]
    v_add_f32 v20, v20, v24
    v_add_f32 v21, v21, v25
    v_mfma_f32_16x16x32_bf16 v[196:199], a[188:191], a[84:87], v[196:199]
    v_add_f32 v22, v22, v26
    v_add_f32 v23, v23, v27
    v_mfma_f32_16x16x32_bf16 v[192:195], a[184:187], a[64:67], v[192:195]
    buffer_load_dwordx4 v1, s[12:15], s35 offen offset:1024 lds
    v_accvgpr_read_b32 v24, a200
    v_mfma_f32_16x16x32_bf16 v[192:195], a[188:191], a[80:83], v[192:195]
    s_waitcnt lgkmcnt(3)
    v_accvgpr_read_b32 v25, a201
    v_mfma_f32_16x16x32_bf16 v[96:99], a[160:163], a[64:67], v[96:99]
    ds_read_b128 a[176:179], v2 offset:5120
    v_accvgpr_read_b32 v26, a202
    v_mfma_f32_16x16x32_bf16 v[96:99], a[164:167], a[80:83], v[96:99]
    ds_read_b128 a[180:183], v2 offset:19456
    v_accvgpr_read_b32 v27, a203
    v_mfma_f32_16x16x32_bf16 v[100:103], a[160:163], a[68:71], v[100:103]
    v_add_f32 v20, v20, v24
    v_add_f32 v21, v21, v25
    v_mfma_f32_16x16x32_bf16 v[100:103], a[164:167], a[84:87], v[100:103]
    buffer_load_dwordx4 v1, s[12:15], s35 offen offset:2048 lds
    s_add_u32 s35, s35, 24576
    v_mfma_f32_16x16x32_bf16 v[104:107], a[160:163], a[72:75], v[104:107]
    v_add_f32 v22, v22, v26
    v_add_f32 v23, v23, v27
    v_mfma_f32_16x16x32_bf16 v[104:107], a[164:167], a[88:91], v[104:107]
    v_accvgpr_read_b32 v24, a204
    v_accvgpr_read_b32 v25, a205
    v_mfma_f32_16x16x32_bf16 v[108:111], a[160:163], a[76:79], v[108:111]
    v_accvgpr_read_b32 v26, a206
    v_accvgpr_read_b32 v27, a207
    v_mfma_f32_16x16x32_bf16 v[108:111], a[164:167], a[92:95], v[108:111]
    s_waitcnt lgkmcnt(2)
    v_add_f32 v20, v20, v24
    v_mfma_f32_16x16x32_bf16 v[220:223], a[168:171], a[76:79], v[220:223]
    ds_read_b128 a[184:187], v2 offset:12288
    v_add_f32 v21, v21, v25
    v_mfma_f32_16x16x32_bf16 v[220:223], a[172:175], a[92:95], v[220:223]
    ds_read_b128 a[188:191], v2 offset:26624
    v_add_f32 v22, v22, v26
    v_mfma_f32_16x16x32_bf16 v[216:219], a[168:171], a[72:75], v[216:219]
    v_add_f32 v23, v23, v27
    v_mov_b32 v24, v20
    v_mfma_f32_16x16x32_bf16 v[216:219], a[172:175], a[88:91], v[216:219]
    buffer_load_dwordx4 a[128:131], v1, s[8:11], s34 offen offset:0
    v_mov_b32 v25, v21
    v_mfma_f32_16x16x32_bf16 v[212:215], a[168:171], a[68:71], v[212:215]
    v_mov_b32 v26, v22
    v_mov_b32 v27, v23
    v_mfma_f32_16x16x32_bf16 v[212:215], a[172:175], a[84:87], v[212:215]
    v_permlane16_swap_b32 v20, v24
    v_permlane16_swap_b32 v21, v25
    v_mfma_f32_16x16x32_bf16 v[208:211], a[168:171], a[64:67], v[208:211]
    buffer_load_dwordx4 a[132:135], v1, s[8:11], s34 offen offset:1024
    v_permlane16_swap_b32 v22, v26
    v_mfma_f32_16x16x32_bf16 v[208:211], a[172:175], a[80:83], v[208:211]
    s_waitcnt lgkmcnt(2)
    v_permlane16_swap_b32 v23, v27
    v_mfma_f32_16x16x32_bf16 v[112:115], a[176:179], a[64:67], v[112:115]
    ds_read_b128 a[160:163], v2 offset:6144
    v_add_f32 v20, v20, v24
    v_mfma_f32_16x16x32_bf16 v[112:115], a[180:183], a[80:83], v[112:115]
    ds_read_b128 a[164:167], v2 offset:20480
    v_add_f32 v21, v21, v25
    v_mfma_f32_16x16x32_bf16 v[116:119], a[176:179], a[68:71], v[116:119]
    v_add_f32 v22, v22, v26
    v_add_f32 v23, v23, v27
    v_mfma_f32_16x16x32_bf16 v[116:119], a[180:183], a[84:87], v[116:119]
    buffer_load_dwordx4 a[136:139], v1, s[8:11], s34 offen offset:2048
    v_mov_b32 v24, v20
    v_mfma_f32_16x16x32_bf16 v[120:123], a[176:179], a[72:75], v[120:123]
    v_mov_b32 v25, v21
    v_mov_b32 v26, v22
    v_mfma_f32_16x16x32_bf16 v[120:123], a[180:183], a[88:91], v[120:123]
    v_mov_b32 v27, v23
    v_permlane32_swap_b32 v20, v24
    v_mfma_f32_16x16x32_bf16 v[124:127], a[176:179], a[76:79], v[124:127]
    v_permlane32_swap_b32 v21, v25
    v_permlane32_swap_b32 v22, v26
    v_mfma_f32_16x16x32_bf16 v[124:127], a[180:183], a[92:95], v[124:127]
    s_waitcnt lgkmcnt(2)
    v_permlane32_swap_b32 v23, v27
    v_mfma_f32_16x16x32_bf16 v[236:239], a[184:187], a[76:79], v[236:239]
    ds_read_b128 a[168:171], v2 offset:13312
    v_add_f32 v20, v20, v24
    v_mfma_f32_16x16x32_bf16 v[236:239], a[188:191], a[92:95], v[236:239]
    ds_read_b128 a[172:175], v2 offset:27648
    v_add_f32 v21, v21, v25
    v_mfma_f32_16x16x32_bf16 v[232:235], a[184:187], a[72:75], v[232:235]
    v_add_f32 v22, v22, v26
    v_add_f32 v23, v23, v27
    v_mfma_f32_16x16x32_bf16 v[232:235], a[188:191], a[88:91], v[232:235]
    buffer_load_dwordx4 a[140:143], v1, s[8:11], s34 offen offset:3072
    s_add_u32 s34, s34, 4096
    v_mfma_f32_16x16x32_bf16 v[228:231], a[184:187], a[68:71], v[228:231]
    v_mul_f32 v9, 0xba800000, v20
    v_mul_f32 v8, 0x3a800000, v21
    v_mfma_f32_16x16x32_bf16 v[228:231], a[188:191], a[84:87], v[228:231]
    v_fma_f32 v8, -v9, v9, v8
    v_max_f32 v8, 0, v8
    v_mfma_f32_16x16x32_bf16 v[224:227], a[184:187], a[64:67], v[224:227]
    buffer_load_dwordx4 a[144:147], v1, s[8:11], s34 offen offset:0
    v_add_f32 v16, 0x3727c5ac, v8
    v_mfma_f32_16x16x32_bf16 v[224:227], a[188:191], a[80:83], v[224:227]
    s_waitcnt vmcnt(12) lgkmcnt(0)
    s_barrier
    v_mfma_f32_16x16x32_bf16 v[128:131], a[160:163], a[64:67], v[128:131]
    ds_read_b128 a[176:179], v2 offset:28672
    v_mfma_f32_16x16x32_bf16 v[128:131], a[164:167], a[80:83], v[128:131]
    ds_read_b128 a[180:183], v2 offset:43008
    v_mfma_f32_16x16x32_bf16 v[132:135], a[160:163], a[68:71], v[132:135]
    v_rsq_f32 v8, v16
    v_mfma_f32_16x16x32_bf16 v[132:135], a[164:167], a[84:87], v[132:135]
    buffer_load_dwordx4 a[148:151], v1, s[8:11], s34 offen offset:1024
    v_nop
    v_mfma_f32_16x16x32_bf16 v[136:139], a[160:163], a[72:75], v[136:139]
    v_mul_f32 v16, v16, v8
    v_mul_f32 v8, 0xbfb8aa3b, v8
    s_branch L_isl7_over
.p2align 12
L_isl7:
    s_setpc_b64 s[14:15]
L_isl7_over:
    v_mfma_f32_16x16x32_bf16 v[136:139], a[164:167], a[88:91], v[136:139]
    v_mul_f32 v11, 0xba800000, v22
    v_mul_f32 v10, 0x3a800000, v23
    v_mfma_f32_16x16x32_bf16 v[140:143], a[160:163], a[76:79], v[140:143]
    v_fma_f32 v10, -v11, v11, v10
    v_max_f32 v10, 0, v10
    v_mfma_f32_16x16x32_bf16 v[140:143], a[164:167], a[92:95], v[140:143]
    v_add_f32 v17, 0x3727c5ac, v10
    v_mfma_f32_16x16x32_bf16 v[252:255], a[168:171], a[76:79], v[252:255]
    ds_read_b128 a[184:187], v2 offset:35840
    v_mfma_f32_16x16x32_bf16 v[252:255], a[172:175], a[92:95], v[252:255]
    ds_read_b128 a[188:191], v2 offset:50176
    v_mfma_f32_16x16x32_bf16 v[248:251], a[168:171], a[72:75], v[248:251]
    v_rsq_f32 v10, v17
    v_mfma_f32_16x16x32_bf16 v[248:251], a[172:175], a[88:91], v[248:251]
    buffer_load_dwordx4 a[152:155], v1, s[8:11], s34 offen offset:2048
    v_nop
    v_mfma_f32_16x16x32_bf16 v[244:247], a[168:171], a[68:71], v[244:247]
    v_mul_f32 v17, v17, v10
    v_mul_f32 v10, 0xbfb8aa3b, v10
    v_mfma_f32_16x16x32_bf16 v[244:247], a[172:175], a[84:87], v[244:247]
    v_accvgpr_read_b32 v20, a208
    v_accvgpr_read_b32 v21, a209
    v_mfma_f32_16x16x32_bf16 v[240:243], a[168:171], a[64:67], v[240:243]
    buffer_load_dwordx4 a[156:159], v1, s[8:11], s34 offen offset:3072
    s_add_u32 s34, s34, 4096
    v_mfma_f32_16x16x32_bf16 v[240:243], a[172:175], a[80:83], v[240:243]
    s_waitcnt lgkmcnt(2)
    v_accvgpr_read_b32 v22, a210
    v_mfma_f32_16x16x32_bf16 v[32:35], a[176:179], a[96:99], v[32:35]
    ds_read_b128 a[160:163], v2 offset:29696
    v_accvgpr_read_b32 v23, a211
    v_mfma_f32_16x16x32_bf16 v[32:35], a[180:183], a[112:115], v[32:35]
    ds_read_b128 a[164:167], v2 offset:44032
    v_accvgpr_read_b32 v24, a212
    v_mfma_f32_16x16x32_bf16 v[36:39], a[176:179], a[100:103], v[36:39]
    s_add_u32 m0, s36, 0
    v_accvgpr_read_b32 v25, a213
    v_mfma_f32_16x16x32_bf16 v[36:39], a[180:183], a[116:119], v[36:39]
    buffer_load_dwordx4 v1, s[12:15], s35 offen offset:0 lds
    v_accvgpr_read_b32 v26, a214
    v_mfma_f32_16x16x32_bf16 v[40:43], a[176:179], a[104:107], v[40:43]
    v_accvgpr_read_b32 v27, a215
    v_add_f32 v20, v20, v24
    v_mfma_f32_16x16x32_bf16 v[40:43], a[180:183], a[120:123], v[40:43]
    v_add_f32 v21, v21, v25
    v_add_f32 v22, v22, v26
    v_mfma_f32_16x16x32_bf16 v[44:47], a[176:179], a[108:111], v[44:47]
    v_add_f32 v23, v23, v27
    v_accvgpr_read_b32 v24, a216
    v_mfma_f32_16x16x32_bf16 v[44:47], a[180:183], a[124:127], v[44:47]
    s_waitcnt lgkmcnt(2)
    v_accvgpr_read_b32 v25, a217
    v_mfma_f32_16x16x32_bf16 v[156:159], a[184:187], a[108:111], v[156:159]
    ds_read_b128 a[168:171], v2 offset:36864
    v_accvgpr_read_b32 v26, a218
    v_mfma_f32_16x16x32_bf16 v[156:159], a[188:191], a[124:127], v[156:159]
    ds_read_b128 a[172:175], v2 offset:51200
    v_accvgpr_read_b32 v27, a219
    v_mfma_f32_16x16x32_bf16 v[152:155], a[184:187], a[104:107], v[152:155]
    v_add_f32 v20, v20, v24
    v_add_f32 v21, v21, v25
    v_mfma_f32_16x16x32_bf16 v[152:155], a[188:191], a[120:123], v[152:155]
    buffer_load_dwordx4 v1, s[12:15], s35 offen offset:1024 lds
    v_add_f32 v22, v22, v26
    v_mfma_f32_16x16x32_bf16 v[148:151], a[184:187], a[100:103], v[148:151]
    v_add_f32 v23, v23, v27
    v_accvgpr_read_b32 v24, a220
    v_mfma_f32_16x16x32_bf16 v[148:151], a[188:191], a[116:119], v[148:151]
    v_accvgpr_read_b32 v25, a221
    v_accvgpr_read_b32 v26, a222
    v_mfma_f32_16x16x32_bf16 v[144:147], a[184:187], a[96:99], v[144:147]
    buffer_load_dwordx4 v1, s[12:15], s35 offen offset:2048 lds
    v_accvgpr_read_b32 v27, a223
    v_mfma_f32_16x16x32_bf16 v[144:147], a[188:191], a[112:115], v[144:147]
    s_waitcnt lgkmcnt(2)
    v_add_f32 v20, v20, v24
    v_mfma_f32_16x16x32_bf16 v[48:51], a[160:163], a[96:99], v[48:51]
    ds_read_b128 a[176:179], v2 offset:30720
    v_add_f32 v21, v21, v25
    v_mfma_f32_16x16x32_bf16 v[48:51], a[164:167], a[112:115], v[48:51]
    ds_read_b128 a[180:183], v2 offset:45056
    v_add_f32 v22, v22, v26
    v_mfma_f32_16x16x32_bf16 v[52:55], a[160:163], a[100:103], v[52:55]
    v_add_f32 v23, v23, v27
    v_mov_b32 v24, v20
    v_mfma_f32_16x16x32_bf16 v[52:55], a[164:167], a[116:119], v[52:55]
    buffer_load_dwordx4 v1, s[12:15], s35 offen offset:3072 lds
    s_add_u32 s35, s35, 4096
    v_mfma_f32_16x16x32_bf16 v[56:59], a[160:163], a[104:107], v[56:59]
    v_mov_b32 v25, v21
    v_mov_b32 v26, v22
    v_mfma_f32_16x16x32_bf16 v[56:59], a[164:167], a[120:123], v[56:59]
    v_mov_b32 v27, v23
    v_permlane16_swap_b32 v20, v24
    v_mfma_f32_16x16x32_bf16 v[60:63], a[160:163], a[108:111], v[60:63]
    v_permlane16_swap_b32 v21, v25
    v_permlane16_swap_b32 v22, v26
    v_mfma_f32_16x16x32_bf16 v[60:63], a[164:167], a[124:127], v[60:63]
    s_waitcnt lgkmcnt(2)
    v_permlane16_swap_b32 v23, v27
    v_mfma_f32_16x16x32_bf16 v[172:175], a[168:171], a[108:111], v[172:175]
    ds_read_b128 a[184:187], v2 offset:37888
    v_add_f32 v20, v20, v24
    v_mfma_f32_16x16x32_bf16 v[172:175], a[172:175], a[124:127], v[172:175]
    ds_read_b128 a[188:191], v2 offset:52224
    v_add_f32 v21, v21, v25
    v_mfma_f32_16x16x32_bf16 v[168:171], a[168:171], a[104:107], v[168:171]
    s_add_u32 m0, s36, 4096
    v_add_f32 v22, v22, v26
    v_mfma_f32_16x16x32_bf16 v[168:171], a[172:175], a[120:123], v[168:171]
    buffer_load_dwordx4 v1, s[12:15], s35 offen offset:0 lds
    v_add_f32 v23, v23, v27
    v_mfma_f32_16x16x32_bf16 v[164:167], a[168:171], a[100:103], v[164:167]
    v_mov_b32 v24, v20
    v_mov_b32 v25, v21
    v_mfma_f32_16x16x32_bf16 v[164:167], a[172:175], a[116:119], v[164:167]
    v_mov_b32 v26, v22
    v_mov_b32 v27, v23
    v_mfma_f32_16x16x32_bf16 v[160:163], a[168:171], a[96:99], v[160:163]
    buffer_load_dwordx4 v1, s[12:15], s35 offen offset:1024 lds
    v_permlane32_swap_b32 v20, v24
    v_mfma_f32_16x16x32_bf16 v[160:163], a[172:175], a[112:115], v[160:163]
    s_waitcnt lgkmcnt(2)
    v_permlane32_swap_b32 v21, v25
    v_mfma_f32_16x16x32_bf16 v[64:67], a[176:179], a[96:99], v[64:67]
    ds_read_b128 a[160:163], v2 offset:31744
    v_permlane32_swap_b32 v22, v26
    v_mfma_f32_16x16x32_bf16 v[64:67], a[180:183], a[112:115], v[64:67]
    ds_read_b128 a[164:167], v2 offset:46080
    v_permlane32_swap_b32 v23, v27
    v_mfma_f32_16x16x32_bf16 v[68:71], a[176:179], a[100:103], v[68:71]
    v_add_f32 v20, v20, v24
    v_add_f32 v21, v21, v25
    v_mfma_f32_16x16x32_bf16 v[68:71], a[180:183], a[116:119], v[68:71]
    buffer_load_dwordx4 v1, s[12:15], s35 offen offset:2048 lds
    s_add_u32 s35, s35, 24576
    v_mfma_f32_16x16x32_bf16 v[72:75], a[176:179], a[104:107], v[72:75]
    v_add_f32 v22, v22, v26
    v_add_f32 v23, v23, v27
    v_mfma_f32_16x16x32_bf16 v[72:75], a[180:183], a[120:123], v[72:75]
    v_mul_f32 v13, 0xba800000, v20
    v_mul_f32 v12, 0x3a800000, v21
    v_mfma_f32_16x16x32_bf16 v[76:79], a[176:179], a[108:111], v[76:79]
    v_fma_f32 v12, -v13, v13, v12
    v_max_f32 v12, 0, v12
    v_mfma_f32_16x16x32_bf16 v[76:79], a[180:183], a[124:127], v[76:79]
    s_waitcnt lgkmcnt(2)
    v_add_f32 v18, 0x3727c5ac, v12
    v_mfma_f32_16x16x32_bf16 v[188:191], a[184:187], a[108:111], v[188:191]
    ds_read_b128 a[168:171], v2 offset:38912
    v_mfma_f32_16x16x32_bf16 v[188:191], a[188:191], a[124:127], v[188:191]
    ds_read_b128 a[172:175], v2 offset:53248
    v_mfma_f32_16x16x32_bf16 v[184:187], a[184:187], a[104:107], v[184:187]
    v_rsq_f32 v12, v18
    v_mfma_f32_16x16x32_bf16 v[184:187], a[188:191], a[120:123], v[184:187]
    buffer_load_dwordx4 a[0:3], v1, s[8:11], s34 offen offset:0
    v_nop
    v_mfma_f32_16x16x32_bf16 v[180:183], a[184:187], a[100:103], v[180:183]
    v_mul_f32 v18, v18, v12
    v_mul_f32 v12, 0xbfb8aa3b, v12
    v_mfma_f32_16x16x32_bf16 v[180:183], a[188:191], a[116:119], v[180:183]
    v_mul_f32 v15, 0xba800000, v22
    v_mul_f32 v14, 0x3a800000, v23
    v_mfma_f32_16x16x32_bf16 v[176:179], a[184:187], a[96:99], v[176:179]
    buffer_load_dwordx4 a[4:7], v1, s[8:11], s34 offen offset:1024
    v_fma_f32 v14, -v15, v15, v14
    v_mfma_f32_16x16x32_bf16 v[176:179], a[188:191], a[112:115], v[176:179]
    s_waitcnt lgkmcnt(2)
    v_max_f32 v14, 0, v14
    v_mfma_f32_16x16x32_bf16 v[80:83], a[160:163], a[96:99], v[80:83]
    ds_read_b128 a[176:179], v2 offset:32768
    v_add_f32 v19, 0x3727c5ac, v14
    v_mfma_f32_16x16x32_bf16 v[80:83], a[164:167], a[112:115], v[80:83]
    ds_read_b128 a[180:183], v2 offset:47104
    v_mfma_f32_16x16x32_bf16 v[84:87], a[160:163], a[100:103], v[84:87]
    v_rsq_f32 v14, v19
    v_mfma_f32_16x16x32_bf16 v[84:87], a[164:167], a[116:119], v[84:87]
    buffer_load_dwordx4 a[8:11], v1, s[8:11], s34 offen offset:2048
    v_nop
    v_mfma_f32_16x16x32_bf16 v[88:91], a[160:163], a[104:107], v[88:91]
    v_mul_f32 v19, v19, v14
    v_mul_f32 v14, 0xbfb8aa3b, v14
    v_mfma_f32_16x16x32_bf16 v[88:91], a[164:167], a[120:123], v[88:91]
    v_mfma_f32_16x16x32_bf16 v[92:95], a[160:163], a[108:111], v[92:95]
    v_mfma_f32_16x16x32_bf16 v[92:95], a[164:167], a[124:127], v[92:95]
    s_waitcnt lgkmcnt(2)
    v_mfma_f32_16x16x32_bf16 v[204:207], a[168:171], a[108:111], v[204:207]
    ds_read_b128 a[184:187], v2 offset:39936
    v_mfma_f32_16x16x32_bf16 v[204:207], a[172:175], a[124:127], v[204:207]
    ds_read_b128 a[188:191], v2 offset:54272
    v_mfma_f32_16x16x32_bf16 v[200:203], a[168:171], a[104:107], v[200:203]
    v_mfma_f32_16x16x32_bf16 v[200:203], a[172:175], a[120:123], v[200:203]
    buffer_load_dwordx4 a[12:15], v1, s[8:11], s34 offen offset:3072
    s_add_u32 s34, s34, 4096
    v_mfma_f32_16x16x32_bf16 v[196:199], a[168:171], a[100:103], v[196:199]
    v_mfma_f32_16x16x32_bf16 v[196:199], a[172:175], a[116:119], v[196:199]
    v_mfma_f32_16x16x32_bf16 v[192:195], a[168:171], a[96:99], v[192:195]
    buffer_load_dwordx4 a[16:19], v1, s[8:11], s34 offen offset:0
    v_mfma_f32_16x16x32_bf16 v[192:195], a[172:175], a[112:115], v[192:195]
    s_waitcnt lgkmcnt(2)
    v_mfma_f32_16x16x32_bf16 v[96:99], a[176:179], a[96:99], v[96:99]
    ds_read_b128 a[160:163], v2 offset:33792
    v_mfma_f32_16x16x32_bf16 v[96:99], a[180:183], a[112:115], v[96:99]
    ds_read_b128 a[164:167], v2 offset:48128
    v_mfma_f32_16x16x32_bf16 v[100:103], a[176:179], a[100:103], v[100:103]
    v_mfma_f32_16x16x32_bf16 v[100:103], a[180:183], a[116:119], v[100:103]
    buffer_load_dwordx4 a[20:23], v1, s[8:11], s34 offen offset:1024
    v_mfma_f32_16x16x32_bf16 v[104:107], a[176:179], a[104:107], v[104:107]
    v_mfma_f32_16x16x32_bf16 v[104:107], a[180:183], a[120:123], v[104:107]
    v_mfma_f32_16x16x32_bf16 v[108:111], a[176:179], a[108:111], v[108:111]
    v_mfma_f32_16x16x32_bf16 v[108:111], a[180:183], a[124:127], v[108:111]
    s_waitcnt lgkmcnt(2)
    v_mfma_f32_16x16x32_bf16 v[220:223], a[184:187], a[108:111], v[220:223]
    ds_read_b128 a[168:171], v2 offset:40960
    v_mfma_f32_16x16x32_bf16 v[220:223], a[188:191], a[124:127], v[220:223]
    ds_read_b128 a[172:175], v2 offset:55296
    v_mfma_f32_16x16x32_bf16 v[216:219], a[184:187], a[104:107], v[216:219]
    v_mfma_f32_16x16x32_bf16 v[216:219], a[188:191], a[120:123], v[216:219]
    buffer_load_dwordx4 a[24:27], v1, s[8:11], s34 offen offset:2048
    v_mfma_f32_16x16x32_bf16 v[212:215], a[184:187], a[100:103], v[212:215]
    v_mfma_f32_16x16x32_bf16 v[212:215], a[188:191], a[116:119], v[212:215]
    v_mfma_f32_16x16x32_bf16 v[208:211], a[184:187], a[96:99], v[208:211]
    buffer_load_dwordx4 a[28:31], v1, s[8:11], s34 offen offset:3072
    s_add_u32 s34, s34, 4096
    v_mfma_f32_16x16x32_bf16 v[208:211], a[188:191], a[112:115], v[208:211]
    s_waitcnt lgkmcnt(2)
    v_mfma_f32_16x16x32_bf16 v[112:115], a[160:163], a[96:99], v[112:115]
    ds_read_b128 a[176:179], v2 offset:34816
    v_mfma_f32_16x16x32_bf16 v[112:115], a[164:167], a[112:115], v[112:115]
    ds_read_b128 a[180:183], v2 offset:49152
    v_mfma_f32_16x16x32_bf16 v[116:119], a[160:163], a[100:103], v[116:119]
    s_add_u32 m0, s36, 28672
    v_mfma_f32_16x16x32_bf16 v[116:119], a[164:167], a[116:119], v[116:119]
    buffer_load_dwordx4 v1, s[12:15], s35 offen offset:0 lds
    v_mfma_f32_16x16x32_bf16 v[120:123], a[160:163], a[104:107], v[120:123]
    v_mfma_f32_16x16x32_bf16 v[120:123], a[164:167], a[120:123], v[120:123]
    v_mfma_f32_16x16x32_bf16 v[124:127], a[160:163], a[108:111], v[124:127]
    buffer_load_dwordx4 v1, s[12:15], s35 offen offset:1024 lds
    v_mfma_f32_16x16x32_bf16 v[124:127], a[164:167], a[124:127], v[124:127]
    s_waitcnt lgkmcnt(2)
    v_mfma_f32_16x16x32_bf16 v[236:239], a[168:171], a[108:111], v[236:239]
    ds_read_b128 a[184:187], v2 offset:41984
    v_mfma_f32_16x16x32_bf16 v[236:239], a[172:175], a[124:127], v[236:239]
    ds_read_b128 a[188:191], v2 offset:56320
    v_mfma_f32_16x16x32_bf16 v[232:235], a[168:171], a[104:107], v[232:235]
    v_mfma_f32_16x16x32_bf16 v[232:235], a[172:175], a[120:123], v[232:235]
    v_mfma_f32_16x16x32_bf16 v[228:231], a[168:171], a[100:103], v[228:231]
    v_mfma_f32_16x16x32_bf16 v[228:231], a[172:175], a[116:119], v[228:231]
    v_mfma_f32_16x16x32_bf16 v[224:227], a[168:171], a[96:99], v[224:227]
    buffer_load_dwordx4 v1, s[12:15], s35 offen offset:2048 lds
    v_mfma_f32_16x16x32_bf16 v[224:227], a[172:175], a[112:115], v[224:227]
    s_waitcnt vmcnt(18) lgkmcnt(0)
    s_barrier
    v_mfma_f32_16x16x32_bf16 v[128:131], a[176:179], a[96:99], v[128:131]
    ds_read_b128 a[160:163], v3 offset:0
    ds_read_b128 v[20:23], v4 offset:128
    v_mfma_f32_16x16x32_bf16 v[128:131], a[180:183], a[112:115], v[128:131]
    ds_read_b128 a[164:167], v3 offset:14336
    v_mfma_f32_16x16x32_bf16 v[132:135], a[176:179], a[100:103], v[132:135]
    v_mfma_f32_16x16x32_bf16 v[132:135], a[180:183], a[116:119], v[132:135]
    buffer_load_dwordx4 v1, s[12:15], s35 offen offset:3072 lds
    s_add_u32 s35, s35, 4096
    v_mfma_f32_16x16x32_bf16 v[136:139], a[176:179], a[104:107], v[136:139]
    v_mfma_f32_16x16x32_bf16 v[136:139], a[180:183], a[120:123], v[136:139]
    s_add_u32 m0, s36, 32768
    v_mfma_f32_16x16x32_bf16 v[140:143], a[176:179], a[108:111], v[140:143]
    buffer_load_dwordx4 v1, s[12:15], s35 offen offset:0 lds
    v_mfma_f32_16x16x32_bf16 v[140:143], a[180:183], a[124:127], v[140:143]
    s_waitcnt lgkmcnt(1)
    v_mfma_f32_16x16x32_bf16 v[252:255], a[184:187], a[108:111], v[252:255]
    ds_read_b128 a[168:171], v3 offset:7168
    v_fmac_f32 v64, v9, v20
    v_mfma_f32_16x16x32_bf16 v[252:255], a[188:191], a[124:127], v[252:255]
    ds_read_b128 a[172:175], v3 offset:21504
    v_fmac_f32 v65, v9, v21
    v_mfma_f32_16x16x32_bf16 v[248:251], a[184:187], a[104:107], v[248:251]
    v_fmac_f32 v66, v9, v22
    v_fmac_f32 v67, v9, v23
    v_mfma_f32_16x16x32_bf16 v[248:251], a[188:191], a[120:123], v[248:251]
    v_fmac_f32 v68, v11, v20
    v_fmac_f32 v69, v11, v21
    v_mfma_f32_16x16x32_bf16 v[244:247], a[184:187], a[100:103], v[244:247]
    v_fmac_f32 v70, v11, v22
    v_fmac_f32 v71, v11, v23
    v_mfma_f32_16x16x32_bf16 v[244:247], a[188:191], a[116:119], v[244:247]
    v_fmac_f32 v72, v13, v20
    v_fmac_f32 v73, v13, v21
    v_mfma_f32_16x16x32_bf16 v[240:243], a[184:187], a[96:99], v[240:243]
    buffer_load_dwordx4 v1, s[12:15], s35 offen offset:1024 lds
    v_fmac_f32 v74, v13, v22
    v_mfma_f32_16x16x32_bf16 v[240:243], a[188:191], a[112:115], v[240:243]
    s_waitcnt lgkmcnt(2)
    v_fmac_f32 v75, v13, v23
    v_mfma_f32_16x16x32_bf16 v[32:35], a[160:163], a[128:131], v[32:35]
    ds_read_b128 a[176:179], v3 offset:1024
    v_fmac_f32 v76, v15, v20
    v_mfma_f32_16x16x32_bf16 v[32:35], a[164:167], a[144:147], v[32:35]
    ds_read_b128 a[180:183], v3 offset:15360
    v_fmac_f32 v77, v15, v21
    v_mfma_f32_16x16x32_bf16 v[36:39], a[160:163], a[132:135], v[36:39]
    v_fmac_f32 v78, v15, v22
    v_fmac_f32 v79, v15, v23
    v_mfma_f32_16x16x32_bf16 v[36:39], a[164:167], a[148:151], v[36:39]
    buffer_load_dwordx4 v1, s[12:15], s35 offen offset:2048 lds
    s_add_u32 s35, s35, 24576
    v_mfma_f32_16x16x32_bf16 v[40:43], a[160:163], a[136:139], v[40:43]
    v_mfma_f32_16x16x32_bf16 v[40:43], a[164:167], a[152:155], v[40:43]
    v_mfma_f32_16x16x32_bf16 v[44:47], a[160:163], a[140:143], v[44:47]
    buffer_load_dwordx4 a[32:35], v1, s[8:11], s34 offen offset:0
    v_mfma_f32_16x16x32_bf16 v[44:47], a[164:167], a[156:159], v[44:47]
    s_waitcnt lgkmcnt(2)
    v_mfma_f32_16x16x32_bf16 v[156:159], a[168:171], a[140:143], v[156:159]
    ds_read_b128 a[184:187], v3 offset:8192
    ds_read_b128 v[28:31], v4 offset:640
    v_mfma_f32_16x16x32_bf16 v[156:159], a[172:175], a[156:159], v[156:159]
    ds_read_b128 a[188:191], v3 offset:22528
    v_mfma_f32_16x16x32_bf16 v[152:155], a[168:171], a[136:139], v[152:155]
    v_mfma_f32_16x16x32_bf16 v[152:155], a[172:175], a[152:155], v[152:155]
    v_mfma_f32_16x16x32_bf16 v[148:151], a[168:171], a[132:135], v[148:151]
    v_mfma_f32_16x16x32_bf16 v[148:151], a[172:175], a[148:151], v[148:151]
    v_mfma_f32_16x16x32_bf16 v[144:147], a[168:171], a[128:131], v[144:147]
    buffer_load_dwordx4 a[36:39], v1, s[8:11], s34 offen offset:1024
    v_mfma_f32_16x16x32_bf16 v[144:147], a[172:175], a[144:147], v[144:147]
    s_waitcnt lgkmcnt(3)
    s_waitcnt lgkmcnt(1)
    v_mfma_f32_16x16x32_bf16 v[48:51], a[176:179], a[128:131], v[48:51]
    ds_read_b128 a[160:163], v3 offset:2048
    v_fmac_f32 v192, v9, v28
    v_mfma_f32_16x16x32_bf16 v[48:51], a[180:183], a[144:147], v[48:51]
    ds_read_b128 a[164:167], v3 offset:16384
    v_fmac_f32 v193, v9, v29
    v_mfma_f32_16x16x32_bf16 v[52:55], a[176:179], a[132:135], v[52:55]
    v_fmac_f32 v194, v9, v30
    v_fmac_f32 v195, v9, v31
    v_mfma_f32_16x16x32_bf16 v[52:55], a[180:183], a[148:151], v[52:55]
    buffer_load_dwordx4 a[40:43], v1, s[8:11], s34 offen offset:2048
    v_fmac_f32 v196, v11, v28
    v_mfma_f32_16x16x32_bf16 v[56:59], a[176:179], a[136:139], v[56:59]
    v_fmac_f32 v197, v11, v29
    v_fmac_f32 v198, v11, v30
    v_mfma_f32_16x16x32_bf16 v[56:59], a[180:183], a[152:155], v[56:59]
    v_fmac_f32 v199, v11, v31
    v_fmac_f32 v200, v13, v28
    v_mfma_f32_16x16x32_bf16 v[60:63], a[176:179], a[140:143], v[60:63]
    buffer_load_dwordx4 a[44:47], v1, s[8:11], s34 offen offset:3072
    s_add_u32 s34, s34, 4096
    v_mfma_f32_16x16x32_bf16 v[60:63], a[180:183], a[156:159], v[60:63]
    s_waitcnt lgkmcnt(2)
    v_fmac_f32 v201, v13, v29
    v_mfma_f32_16x16x32_bf16 v[172:175], a[184:187], a[140:143], v[172:175]
    ds_read_b128 a[168:171], v3 offset:9216
    v_fmac_f32 v202, v13, v30
    v_mfma_f32_16x16x32_bf16 v[172:175], a[188:191], a[156:159], v[172:175]
    ds_read_b128 a[172:175], v3 offset:23552
    v_fmac_f32 v203, v13, v31
    v_mfma_f32_16x16x32_bf16 v[168:171], a[184:187], a[136:139], v[168:171]
    v_fmac_f32 v204, v15, v28
    v_fmac_f32 v205, v15, v29
    v_mfma_f32_16x16x32_bf16 v[168:171], a[188:191], a[152:155], v[168:171]
    v_fmac_f32 v206, v15, v30
    v_fmac_f32 v207, v15, v31
    v_mfma_f32_16x16x32_bf16 v[164:167], a[184:187], a[132:135], v[164:167]
    v_mfma_f32_16x16x32_bf16 v[164:167], a[188:191], a[148:151], v[164:167]
    v_mfma_f32_16x16x32_bf16 v[160:163], a[184:187], a[128:131], v[160:163]
    buffer_load_dwordx4 a[48:51], v1, s[8:11], s34 offen offset:0
    v_mfma_f32_16x16x32_bf16 v[160:163], a[188:191], a[144:147], v[160:163]
    s_waitcnt lgkmcnt(2)
    v_mfma_f32_16x16x32_bf16 v[64:67], a[160:163], a[128:131], v[64:67]
    ds_read_b128 a[176:179], v3 offset:3072
    ds_read_b128 v[20:23], v4 offset:0
    v_mfma_f32_16x16x32_bf16 v[64:67], a[164:167], a[144:147], v[64:67]
    ds_read_b128 a[180:183], v3 offset:17408
    v_mfma_f32_16x16x32_bf16 v[68:71], a[160:163], a[132:135], v[68:71]
    v_mfma_f32_16x16x32_bf16 v[68:71], a[164:167], a[148:151], v[68:71]
    buffer_load_dwordx4 a[52:55], v1, s[8:11], s34 offen offset:1024
    v_mfma_f32_16x16x32_bf16 v[72:75], a[160:163], a[136:139], v[72:75]
    v_mfma_f32_16x16x32_bf16 v[72:75], a[164:167], a[152:155], v[72:75]
    v_mfma_f32_16x16x32_bf16 v[76:79], a[160:163], a[140:143], v[76:79]
    buffer_load_dwordx4 a[56:59], v1, s[8:11], s34 offen offset:2048
    v_mfma_f32_16x16x32_bf16 v[76:79], a[164:167], a[156:159], v[76:79]
    s_waitcnt lgkmcnt(3)
    s_waitcnt lgkmcnt(1)
    v_mfma_f32_16x16x32_bf16 v[188:191], a[168:171], a[140:143], v[188:191]
    ds_read_b128 a[184:187], v3 offset:10240
    v_fmac_f32 v32, v9, v20
    v_mfma_f32_16x16x32_bf16 v[188:191], a[172:175], a[156:159], v[188:191]
    ds_read_b128 a[188:191], v3 offset:24576
    v_fmac_f32 v33, v9, v21
    v_mfma_f32_16x16x32_bf16 v[184:187], a[168:171], a[136:139], v[184:187]
    v_fmac_f32 v34, v9, v22
    v_fmac_f32 v35, v9, v23
    v_mfma_f32_16x16x32_bf16 v[184:187], a[172:175], a[152:155], v[184:187]
    v_fmac_f32 v36, v11, v20
    v_fmac_f32 v37, v11, v21
    v_mfma_f32_16x16x32_bf16 v[180:183], a[168:171], a[132:135], v[180:183]
    v_fmac_f32 v38, v11, v22
    v_fmac_f32 v39, v11, v23
    v_mfma_f32_16x16x32_bf16 v[180:183], a[172:175], a[148:151], v[180:183]
    v_fmac_f32 v40, v13, v20
    v_fmac_f32 v41, v13, v21
    v_mfma_f32_16x16x32_bf16 v[176:179], a[168:171], a[128:131], v[176:179]
    buffer_load_dwordx4 a[60:63], v1, s[8:11], s34 offen offset:3072
    s_add_u32 s34, s34, 4096
    v_mfma_f32_16x16x32_bf16 v[176:179], a[172:175], a[144:147], v[176:179]
    s_waitcnt lgkmcnt(2)
    v_fmac_f32 v42, v13, v22
    v_mfma_f32_16x16x32_bf16 v[80:83], a[176:179], a[128:131], v[80:83]
    ds_read_b128 a[160:163], v3 offset:4096
    v_fmac_f32 v43, v13, v23
    v_mfma_f32_16x16x32_bf16 v[80:83], a[180:183], a[144:147], v[80:83]
    ds_read_b128 a[164:167], v3 offset:18432
    v_fmac_f32 v44, v15, v20
    v_mfma_f32_16x16x32_bf16 v[84:87], a[176:179], a[132:135], v[84:87]
    s_add_u32 m0, s36, 57344
    v_fmac_f32 v45, v15, v21
    v_mfma_f32_16x16x32_bf16 v[84:87], a[180:183], a[148:151], v[84:87]
    buffer_load_dwordx4 v1, s[12:15], s35 offen offset:0 lds
    v_fmac_f32 v46, v15, v22
    v_mfma_f32_16x16x32_bf16 v[88:91], a[176:179], a[136:139], v[88:91]
    v_fmac_f32 v47, v15, v23
    v_mfma_f32_16x16x32_bf16 v[88:91], a[180:183], a[152:155], v[88:91]
    v_mfma_f32_16x16x32_bf16 v[92:95], a[176:179], a[140:143], v[92:95]
    buffer_load_dwordx4 v1, s[12:15], s35 offen offset:1024 lds
    v_mfma_f32_16x16x32_bf16 v[92:95], a[180:183], a[156:159], v[92:95]
    s_waitcnt lgkmcnt(2)
    v_mfma_f32_16x16x32_bf16 v[204:207], a[184:187], a[140:143], v[204:207]
    ds_read_b128 a[168:171], v3 offset:11264
    ds_read_b128 v[28:31], v4 offset:448
    v_mfma_f32_16x16x32_bf16 v[204:207], a[188:191], a[156:159], v[204:207]
    ds_read_b128 a[172:175], v3 offset:25600
    v_mfma_f32_16x16x32_bf16 v[200:203], a[184:187], a[136:139], v[200:203]
    v_mfma_f32_16x16x32_bf16 v[200:203], a[188:191], a[152:155], v[200:203]
    v_mfma_f32_16x16x32_bf16 v[196:199], a[184:187], a[132:135], v[196:199]
    v_mfma_f32_16x16x32_bf16 v[196:199], a[188:191], a[148:151], v[196:199]
    v_mfma_f32_16x16x32_bf16 v[192:195], a[184:187], a[128:131], v[192:195]
    buffer_load_dwordx4 v1, s[12:15], s35 offen offset:2048 lds
    v_mfma_f32_16x16x32_bf16 v[192:195], a[188:191], a[144:147], v[192:195]
    s_waitcnt lgkmcnt(3)
    s_waitcnt lgkmcnt(1)
    v_mfma_f32_16x16x32_bf16 v[96:99], a[160:163], a[128:131], v[96:99]
    ds_read_b128 a[176:179], v3 offset:5120
    v_fmac_f32 v144, v9, v28
    v_mfma_f32_16x16x32_bf16 v[96:99], a[164:167], a[144:147], v[96:99]
    ds_read_b128 a[180:183], v3 offset:19456
    v_fmac_f32 v145, v9, v29
    v_mfma_f32_16x16x32_bf16 v[100:103], a[160:163], a[132:135], v[100:103]
    v_fmac_f32 v146, v9, v30
    v_fmac_f32 v147, v9, v31
    v_mfma_f32_16x16x32_bf16 v[100:103], a[164:167], a[148:151], v[100:103]
    buffer_load_dwordx4 v1, s[12:15], s35 offen offset:3072 lds
    s_add_u32 s35, s35, 4096
    v_mfma_f32_16x16x32_bf16 v[104:107], a[160:163], a[136:139], v[104:107]
    v_fmac_f32 v148, v11, v28
    v_fmac_f32 v149, v11, v29
    v_mfma_f32_16x16x32_bf16 v[104:107], a[164:167], a[152:155], v[104:107]
    s_add_u32 m0, s36, 61440
    v_fmac_f32 v150, v11, v30
    v_mfma_f32_16x16x32_bf16 v[108:111], a[160:163], a[140:143], v[108:111]
    buffer_load_dwordx4 v1, s[12:15], s35 offen offset:0 lds
    v_fmac_f32 v151, v11, v31
    v_mfma_f32_16x16x32_bf16 v[108:111], a[164:167], a[156:159], v[108:111]
    s_waitcnt lgkmcnt(2)
    v_fmac_f32 v152, v13, v28
    v_mfma_f32_16x16x32_bf16 v[220:223], a[168:171], a[140:143], v[220:223]
    ds_read_b128 a[184:187], v3 offset:12288
    v_fmac_f32 v153, v13, v29
    v_mfma_f32_16x16x32_bf16 v[220:223], a[172:175], a[156:159], v[220:223]
    ds_read_b128 a[188:191], v3 offset:26624
    v_fmac_f32 v154, v13, v30
    v_mfma_f32_16x16x32_bf16 v[216:219], a[168:171], a[136:139], v[216:219]
    v_fmac_f32 v155, v13, v31
    v_fmac_f32 v156, v15, v28
    v_mfma_f32_16x16x32_bf16 v[216:219], a[172:175], a[152:155], v[216:219]
    v_fmac_f32 v157, v15, v29
    v_fmac_f32 v158, v15, v30
    v_mfma_f32_16x16x32_bf16 v[212:215], a[168:171], a[132:135], v[212:215]
    v_fmac_f32 v159, v15, v31
    v_mfma_f32_16x16x32_bf16 v[212:215], a[172:175], a[148:151], v[212:215]
    v_mfma_f32_16x16x32_bf16 v[208:211], a[168:171], a[128:131], v[208:211]
    buffer_load_dwordx4 v1, s[12:15], s35 offen offset:1024 lds
    v_mfma_f32_16x16x32_bf16 v[208:211], a[172:175], a[144:147], v[208:211]
    s_waitcnt lgkmcnt(2)
    v_mfma_f32_16x16x32_bf16 v[112:115], a[176:179], a[128:131], v[112:115]
    ds_read_b128 a[160:163], v3 offset:6144
    ds_read_b128 v[20:23], v4 offset:64
    v_mfma_f32_16x16x32_bf16 v[112:115], a[180:183], a[144:147], v[112:115]
    ds_read_b128 a[164:167], v3 offset:20480
    v_mfma_f32_16x16x32_bf16 v[116:119], a[176:179], a[132:135], v[116:119]
    v_mfma_f32_16x16x32_bf16 v[116:119], a[180:183], a[148:151], v[116:119]
    buffer_load_dwordx4 v1, s[12:15], s35 offen offset:2048 lds
    s_add_u32 s35, s35, 24576
    v_mfma_f32_16x16x32_bf16 v[120:123], a[176:179], a[136:139], v[120:123]
    v_mfma_f32_16x16x32_bf16 v[120:123], a[180:183], a[152:155], v[120:123]
    v_mfma_f32_16x16x32_bf16 v[124:127], a[176:179], a[140:143], v[124:127]
    buffer_load_dwordx4 a[64:67], v1, s[8:11], s34 offen offset:0
    v_mfma_f32_16x16x32_bf16 v[124:127], a[180:183], a[156:159], v[124:127]
    s_waitcnt lgkmcnt(3)
    s_waitcnt lgkmcnt(1)
    v_mfma_f32_16x16x32_bf16 v[236:239], a[184:187], a[140:143], v[236:239]
    ds_read_b128 a[168:171], v3 offset:13312
    v_fmac_f32 v48, v9, v20
    v_mfma_f32_16x16x32_bf16 v[236:239], a[188:191], a[156:159], v[236:239]
    ds_read_b128 a[172:175], v3 offset:27648
    v_fmac_f32 v49, v9, v21
    v_mfma_f32_16x16x32_bf16 v[232:235], a[184:187], a[136:139], v[232:235]
    v_fmac_f32 v50, v9, v22
    v_fmac_f32 v51, v9, v23
    v_mfma_f32_16x16x32_bf16 v[232:235], a[188:191], a[152:155], v[232:235]
    v_fmac_f32 v52, v11, v20
    v_fmac_f32 v53, v11, v21
    v_mfma_f32_16x16x32_bf16 v[228:231], a[184:187], a[132:135], v[228:231]
    v_fmac_f32 v54, v11, v22
    v_fmac_f32 v55, v11, v23
    v_mfma_f32_16x16x32_bf16 v[228:231], a[188:191], a[148:151], v[228:231]
    v_fmac_f32 v56, v13, v20
    v_fmac_f32 v57, v13, v21
    v_mfma_f32_16x16x32_bf16 v[224:227], a[184:187], a[128:131], v[224:227]
    buffer_load_dwordx4 a[68:71], v1, s[8:11], s34 offen offset:1024
    v_fmac_f32 v58, v13, v22
    v_mfma_f32_16x16x32_bf16 v[224:227], a[188:191], a[144:147], v[224:227]
    s_waitcnt vmcnt(24) lgkmcnt(0)
    s_barrier
    v_fmac_f32 v59, v13, v23
    v_mfma_f32_16x16x32_bf16 v[128:131], a[160:163], a[128:131], v[128:131]
    ds_read_b128 a[176:179], v1 offset:0
    v_fmac_f32 v60, v15, v20
    v_mfma_f32_16x16x32_bf16 v[128:131], a[164:167], a[144:147], v[128:131]
    ds_read_b128 a[180:183], v1 offset:14336
    v_fmac_f32 v61, v15, v21
    v_mfma_f32_16x16x32_bf16 v[132:135], a[160:163], a[132:135], v[132:135]
    v_fmac_f32 v62, v15, v22
    v_fmac_f32 v63, v15, v23
    v_mfma_f32_16x16x32_bf16 v[132:135], a[164:167], a[148:151], v[132:135]
    buffer_load_dwordx4 a[72:75], v1, s[8:11], s34 offen offset:2048
    v_mfma_f32_16x16x32_bf16 v[136:139], a[160:163], a[136:139], v[136:139]
    v_mfma_f32_16x16x32_bf16 v[136:139], a[164:167], a[152:155], v[136:139]
    v_mfma_f32_16x16x32_bf16 v[140:143], a[160:163], a[140:143], v[140:143]
    buffer_load_dwordx4 a[76:79], v1, s[8:11], s34 offen offset:3072
    s_add_u32 s34, s34, 4096
    v_mfma_f32_16x16x32_bf16 v[140:143], a[164:167], a[156:159], v[140:143]
    v_mfma_f32_16x16x32_bf16 v[252:255], a[168:171], a[140:143], v[252:255]
    ds_read_b128 a[184:187], v1 offset:7168
    ds_read_b128 v[28:31], v4 offset:576
    v_mfma_f32_16x16x32_bf16 v[252:255], a[172:175], a[156:159], v[252:255]
    ds_read_b128 a[188:191], v1 offset:21504
    v_mfma_f32_16x16x32_bf16 v[248:251], a[168:171], a[136:139], v[248:251]
    v_mfma_f32_16x16x32_bf16 v[248:251], a[172:175], a[152:155], v[248:251]
    v_mfma_f32_16x16x32_bf16 v[244:247], a[168:171], a[132:135], v[244:247]
    v_mfma_f32_16x16x32_bf16 v[244:247], a[172:175], a[148:151], v[244:247]
    v_mfma_f32_16x16x32_bf16 v[240:243], a[168:171], a[128:131], v[240:243]
    buffer_load_dwordx4 a[80:83], v1, s[8:11], s34 offen offset:0
    v_mfma_f32_16x16x32_bf16 v[240:243], a[172:175], a[144:147], v[240:243]
    s_waitcnt lgkmcnt(3)
    s_waitcnt lgkmcnt(1)
    v_mfma_f32_16x16x32_bf16 v[32:35], a[176:179], a[0:3], v[32:35]
    ds_read_b128 a[160:163], v1 offset:1024
    v_fmac_f32 v176, v9, v28
    v_mfma_f32_16x16x32_bf16 v[32:35], a[180:183], a[16:19], v[32:35]
    ds_read_b128 a[164:167], v1 offset:15360
    v_fmac_f32 v177, v9, v29
    v_mfma_f32_16x16x32_bf16 v[36:39], a[176:179], a[4:7], v[36:39]
    v_fmac_f32 v178, v9, v30
    v_fmac_f32 v179, v9, v31
    s_branch L_isl8_over
.p2align 12
L_isl8:
    s_setpc_b64 s[14:15]
L_isl8_over:
    v_mfma_f32_16x16x32_bf16 v[36:39], a[180:183], a[20:23], v[36:39]
    buffer_load_dwordx4 a[84:87], v1, s[8:11], s34 offen offset:1024
    v_fmac_f32 v180, v11, v28
    v_mfma_f32_16x16x32_bf16 v[40:43], a[176:179], a[8:11], v[40:43]
    v_fmac_f32 v181, v11, v29
    v_fmac_f32 v182, v11, v30
    v_mfma_f32_16x16x32_bf16 v[40:43], a[180:183], a[24:27], v[40:43]
    v_fmac_f32 v183, v11, v31
    v_fmac_f32 v184, v13, v28
    v_mfma_f32_16x16x32_bf16 v[44:47], a[176:179], a[12:15], v[44:47]
    buffer_load_dwordx4 a[88:91], v1, s[8:11], s34 offen offset:2048
    v_fmac_f32 v185, v13, v29
    v_mfma_f32_16x16x32_bf16 v[44:47], a[180:183], a[28:31], v[44:47]
    s_waitcnt lgkmcnt(2)
    v_fmac_f32 v186, v13, v30
    v_mfma_f32_16x16x32_bf16 v[156:159], a[184:187], a[12:15], v[156:159]
    ds_read_b128 a[168:171], v1 offset:8192
    v_fmac_f32 v187, v13, v31
    v_mfma_f32_16x16x32_bf16 v[156:159], a[188:191], a[28:31], v[156:159]
    ds_read_b128 a[172:175], v1 offset:22528
    v_fmac_f32 v188, v15, v28
    v_mfma_f32_16x16x32_bf16 v[152:155], a[184:187], a[8:11], v[152:155]
    v_fmac_f32 v189, v15, v29
    v_fmac_f32 v190, v15, v30
    v_mfma_f32_16x16x32_bf16 v[152:155], a[188:191], a[24:27], v[152:155]
    v_fmac_f32 v191, v15, v31
    v_mfma_f32_16x16x32_bf16 v[148:151], a[184:187], a[4:7], v[148:151]
    v_mfma_f32_16x16x32_bf16 v[148:151], a[188:191], a[20:23], v[148:151]
    v_mfma_f32_16x16x32_bf16 v[144:147], a[184:187], a[0:3], v[144:147]
    buffer_load_dwordx4 a[92:95], v1, s[8:11], s34 offen offset:3072
    s_add_u32 s34, s34, 4096
    v_mfma_f32_16x16x32_bf16 v[144:147], a[188:191], a[16:19], v[144:147]
    s_waitcnt lgkmcnt(2)
    v_mfma_f32_16x16x32_bf16 v[48:51], a[160:163], a[0:3], v[48:51]
    ds_read_b128 a[176:179], v1 offset:2048
    ds_read_b128 v[20:23], v4 offset:256
    v_mfma_f32_16x16x32_bf16 v[48:51], a[164:167], a[16:19], v[48:51]
    ds_read_b128 a[180:183], v1 offset:16384
    v_mfma_f32_16x16x32_bf16 v[52:55], a[160:163], a[4:7], v[52:55]
    s_add_u32 m0, s36, 86016
    v_mfma_f32_16x16x32_bf16 v[52:55], a[164:167], a[20:23], v[52:55]
    buffer_load_dwordx4 v1, s[12:15], s35 offen offset:0 lds
    v_mfma_f32_16x16x32_bf16 v[56:59], a[160:163], a[8:11], v[56:59]
    v_mfma_f32_16x16x32_bf16 v[56:59], a[164:167], a[24:27], v[56:59]
    v_mfma_f32_16x16x32_bf16 v[60:63], a[160:163], a[12:15], v[60:63]
    buffer_load_dwordx4 v1, s[12:15], s35 offen offset:1024 lds
    v_mfma_f32_16x16x32_bf16 v[60:63], a[164:167], a[28:31], v[60:63]
    s_waitcnt lgkmcnt(3)
    s_waitcnt lgkmcnt(1)
    v_mfma_f32_16x16x32_bf16 v[172:175], a[168:171], a[12:15], v[172:175]
    ds_read_b128 a[184:187], v1 offset:9216
    v_fmac_f32 v96, v9, v20
    v_mfma_f32_16x16x32_bf16 v[172:175], a[172:175], a[28:31], v[172:175]
    ds_read_b128 a[188:191], v1 offset:23552
    v_fmac_f32 v97, v9, v21
    v_mfma_f32_16x16x32_bf16 v[168:171], a[168:171], a[8:11], v[168:171]
    v_fmac_f32 v98, v9, v22
    v_fmac_f32 v99, v9, v23
    v_mfma_f32_16x16x32_bf16 v[168:171], a[172:175], a[24:27], v[168:171]
    v_fmac_f32 v100, v11, v20
    v_fmac_f32 v101, v11, v21
    v_mfma_f32_16x16x32_bf16 v[164:167], a[168:171], a[4:7], v[164:167]
    v_fmac_f32 v102, v11, v22
    v_fmac_f32 v103, v11, v23
    v_mfma_f32_16x16x32_bf16 v[164:167], a[172:175], a[20:23], v[164:167]
    v_fmac_f32 v104, v13, v20
    v_fmac_f32 v105, v13, v21
    v_mfma_f32_16x16x32_bf16 v[160:163], a[168:171], a[0:3], v[160:163]
    buffer_load_dwordx4 v1, s[12:15], s35 offen offset:2048 lds
    v_fmac_f32 v106, v13, v22
    v_mfma_f32_16x16x32_bf16 v[160:163], a[172:175], a[16:19], v[160:163]
    s_waitcnt lgkmcnt(2)
    v_fmac_f32 v107, v13, v23
    v_mfma_f32_16x16x32_bf16 v[64:67], a[176:179], a[0:3], v[64:67]
    ds_read_b128 a[160:163], v1 offset:3072
    v_fmac_f32 v108, v15, v20
    v_mfma_f32_16x16x32_bf16 v[64:67], a[180:183], a[16:19], v[64:67]
    ds_read_b128 a[164:167], v1 offset:17408
    v_fmac_f32 v109, v15, v21
    v_mfma_f32_16x16x32_bf16 v[68:71], a[176:179], a[4:7], v[68:71]
    v_fmac_f32 v110, v15, v22
    v_fmac_f32 v111, v15, v23
    v_mfma_f32_16x16x32_bf16 v[68:71], a[180:183], a[20:23], v[68:71]
    buffer_load_dwordx4 v1, s[12:15], s35 offen offset:3072 lds
    s_add_u32 s35, s35, 4096
    v_mfma_f32_16x16x32_bf16 v[72:75], a[176:179], a[8:11], v[72:75]
    v_mfma_f32_16x16x32_bf16 v[72:75], a[180:183], a[24:27], v[72:75]
    s_add_u32 m0, s36, 90112
    v_mfma_f32_16x16x32_bf16 v[76:79], a[176:179], a[12:15], v[76:79]
    buffer_load_dwordx4 v1, s[12:15], s35 offen offset:0 lds
    v_mfma_f32_16x16x32_bf16 v[76:79], a[180:183], a[28:31], v[76:79]
    s_waitcnt lgkmcnt(2)
    v_mfma_f32_16x16x32_bf16 v[188:191], a[184:187], a[12:15], v[188:191]
    ds_read_b128 a[168:171], v1 offset:10240
    ds_read_b128 v[28:31], v4 offset:512
    v_mfma_f32_16x16x32_bf16 v[188:191], a[188:191], a[28:31], v[188:191]
    ds_read_b128 a[172:175], v1 offset:24576
    v_mfma_f32_16x16x32_bf16 v[184:187], a[184:187], a[8:11], v[184:187]
    v_mfma_f32_16x16x32_bf16 v[184:187], a[188:191], a[24:27], v[184:187]
    v_mfma_f32_16x16x32_bf16 v[180:183], a[184:187], a[4:7], v[180:183]
    v_mfma_f32_16x16x32_bf16 v[180:183], a[188:191], a[20:23], v[180:183]
    v_mfma_f32_16x16x32_bf16 v[176:179], a[184:187], a[0:3], v[176:179]
    buffer_load_dwordx4 v1, s[12:15], s35 offen offset:1024 lds
    v_mfma_f32_16x16x32_bf16 v[176:179], a[188:191], a[16:19], v[176:179]
    s_waitcnt lgkmcnt(3)
    s_waitcnt lgkmcnt(1)
    v_mfma_f32_16x16x32_bf16 v[80:83], a[160:163], a[0:3], v[80:83]
    ds_read_b128 a[176:179], v1 offset:4096
    v_fmac_f32 v160, v9, v28
    v_mfma_f32_16x16x32_bf16 v[80:83], a[164:167], a[16:19], v[80:83]
    ds_read_b128 a[180:183], v1 offset:18432
    v_fmac_f32 v161, v9, v29
    v_mfma_f32_16x16x32_bf16 v[84:87], a[160:163], a[4:7], v[84:87]
    v_fmac_f32 v162, v9, v30
    v_fmac_f32 v163, v9, v31
    v_mfma_f32_16x16x32_bf16 v[84:87], a[164:167], a[20:23], v[84:87]
    buffer_load_dwordx4 v1, s[12:15], s35 offen offset:2048 lds
    s_add_u32 s35, s35, 24576
    v_mfma_f32_16x16x32_bf16 v[88:91], a[160:163], a[8:11], v[88:91]
    v_fmac_f32 v164, v11, v28
    v_fmac_f32 v165, v11, v29
    v_mfma_f32_16x16x32_bf16 v[88:91], a[164:167], a[24:27], v[88:91]
    v_fmac_f32 v166, v11, v30
    v_fmac_f32 v167, v11, v31
    v_mfma_f32_16x16x32_bf16 v[92:95], a[160:163], a[12:15], v[92:95]
    buffer_load_dwordx4 a[96:99], v1, s[8:11], s34 offen offset:0
    v_fmac_f32 v168, v13, v28
    v_mfma_f32_16x16x32_bf16 v[92:95], a[164:167], a[28:31], v[92:95]
    s_waitcnt lgkmcnt(2)
    v_fmac_f32 v169, v13, v29
    v_mfma_f32_16x16x32_bf16 v[204:207], a[168:171], a[12:15], v[204:207]
    ds_read_b128 a[184:187], v1 offset:11264
    v_fmac_f32 v170, v13, v30
    v_mfma_f32_16x16x32_bf16 v[204:207], a[172:175], a[28:31], v[204:207]
    ds_read_b128 a[188:191], v1 offset:25600
    v_fmac_f32 v171, v13, v31
    v_mfma_f32_16x16x32_bf16 v[200:203], a[168:171], a[8:11], v[200:203]
    v_fmac_f32 v172, v15, v28
    v_fmac_f32 v173, v15, v29
    v_mfma_f32_16x16x32_bf16 v[200:203], a[172:175], a[24:27], v[200:203]
    v_fmac_f32 v174, v15, v30
    v_fmac_f32 v175, v15, v31
    v_mfma_f32_16x16x32_bf16 v[196:199], a[168:171], a[4:7], v[196:199]
    v_mfma_f32_16x16x32_bf16 v[196:199], a[172:175], a[20:23], v[196:199]
    v_mfma_f32_16x16x32_bf16 v[192:195], a[168:171], a[0:3], v[192:195]
    buffer_load_dwordx4 a[100:103], v1, s[8:11], s34 offen offset:1024
    v_mfma_f32_16x16x32_bf16 v[192:195], a[172:175], a[16:19], v[192:195]
    s_waitcnt lgkmcnt(2)
    v_mfma_f32_16x16x32_bf16 v[96:99], a[176:179], a[0:3], v[96:99]
    ds_read_b128 a[160:163], v1 offset:5120
    ds_read_b128 v[20:23], v4 offset:192
    v_mfma_f32_16x16x32_bf16 v[96:99], a[180:183], a[16:19], v[96:99]
    ds_read_b128 a[164:167], v1 offset:19456
    v_mfma_f32_16x16x32_bf16 v[100:103], a[176:179], a[4:7], v[100:103]
    v_mfma_f32_16x16x32_bf16 v[100:103], a[180:183], a[20:23], v[100:103]
    buffer_load_dwordx4 a[104:107], v1, s[8:11], s34 offen offset:2048
    v_mfma_f32_16x16x32_bf16 v[104:107], a[176:179], a[8:11], v[104:107]
    v_mfma_f32_16x16x32_bf16 v[104:107], a[180:183], a[24:27], v[104:107]
    v_mfma_f32_16x16x32_bf16 v[108:111], a[176:179], a[12:15], v[108:111]
    buffer_load_dwordx4 a[108:111], v1, s[8:11], s34 offen offset:3072
    s_add_u32 s34, s34, 4096
    v_mfma_f32_16x16x32_bf16 v[108:111], a[180:183], a[28:31], v[108:111]
    s_waitcnt lgkmcnt(3)
    s_waitcnt lgkmcnt(1)
    v_mfma_f32_16x16x32_bf16 v[220:223], a[184:187], a[12:15], v[220:223]
    ds_read_b128 a[168:171], v1 offset:12288
    v_fmac_f32 v80, v9, v20
    v_mfma_f32_16x16x32_bf16 v[220:223], a[188:191], a[28:31], v[220:223]
    ds_read_b128 a[172:175], v1 offset:26624
    v_fmac_f32 v81, v9, v21
    v_mfma_f32_16x16x32_bf16 v[216:219], a[184:187], a[8:11], v[216:219]
    v_fmac_f32 v82, v9, v22
    v_fmac_f32 v83, v9, v23
    v_mfma_f32_16x16x32_bf16 v[216:219], a[188:191], a[24:27], v[216:219]
    v_fmac_f32 v84, v11, v20
    v_fmac_f32 v85, v11, v21
    v_mfma_f32_16x16x32_bf16 v[212:215], a[184:187], a[4:7], v[212:215]
    v_fmac_f32 v86, v11, v22
    v_fmac_f32 v87, v11, v23
    v_mfma_f32_16x16x32_bf16 v[212:215], a[188:191], a[20:23], v[212:215]
    v_fmac_f32 v88, v13, v20
    v_fmac_f32 v89, v13, v21
    v_mfma_f32_16x16x32_bf16 v[208:211], a[184:187], a[0:3], v[208:211]
    buffer_load_dwordx4 a[112:115], v1, s[8:11], s34 offen offset:0
    v_fmac_f32 v90, v13, v22
    v_mfma_f32_16x16x32_bf16 v[208:211], a[188:191], a[16:19], v[208:211]
    s_waitcnt lgkmcnt(2)
    v_fmac_f32 v91, v13, v23
    v_mfma_f32_16x16x32_bf16 v[112:115], a[160:163], a[0:3], v[112:115]
    ds_read_b128 a[176:179], v1 offset:6144
    v_fmac_f32 v92, v15, v20
    v_mfma_f32_16x16x32_bf16 v[112:115], a[164:167], a[16:19], v[112:115]
    ds_read_b128 a[180:183], v1 offset:20480
    v_fmac_f32 v93, v15, v21
    v_mfma_f32_16x16x32_bf16 v[116:119], a[160:163], a[4:7], v[116:119]
    v_fmac_f32 v94, v15, v22
    v_fmac_f32 v95, v15, v23
    v_mfma_f32_16x16x32_bf16 v[116:119], a[164:167], a[20:23], v[116:119]
    buffer_load_dwordx4 a[116:119], v1, s[8:11], s34 offen offset:1024
    v_mfma_f32_16x16x32_bf16 v[120:123], a[160:163], a[8:11], v[120:123]
    v_mfma_f32_16x16x32_bf16 v[120:123], a[164:167], a[24:27], v[120:123]
    v_mfma_f32_16x16x32_bf16 v[124:127], a[160:163], a[12:15], v[124:127]
    buffer_load_dwordx4 a[120:123], v1, s[8:11], s34 offen offset:2048
    v_mfma_f32_16x16x32_bf16 v[124:127], a[164:167], a[28:31], v[124:127]
    s_waitcnt lgkmcnt(2)
    v_mfma_f32_16x16x32_bf16 v[236:239], a[168:171], a[12:15], v[236:239]
    ds_read_b128 a[184:187], v1 offset:13312
    ds_read_b128 v[28:31], v4 offset:704
    v_mfma_f32_16x16x32_bf16 v[236:239], a[172:175], a[28:31], v[236:239]
    ds_read_b128 a[188:191], v1 offset:27648
    v_mfma_f32_16x16x32_bf16 v[232:235], a[168:171], a[8:11], v[232:235]
    v_mfma_f32_16x16x32_bf16 v[232:235], a[172:175], a[24:27], v[232:235]
    v_mfma_f32_16x16x32_bf16 v[228:231], a[168:171], a[4:7], v[228:231]
    v_mfma_f32_16x16x32_bf16 v[228:231], a[172:175], a[20:23], v[228:231]
    v_mfma_f32_16x16x32_bf16 v[224:227], a[168:171], a[0:3], v[224:227]
    buffer_load_dwordx4 a[124:127], v1, s[8:11], s34 offen offset:3072
    s_add_u32 s34, s34, 4096
    v_mfma_f32_16x16x32_bf16 v[224:227], a[172:175], a[16:19], v[224:227]
    s_waitcnt vmcnt(30) lgkmcnt(0)
    s_barrier
    v_mfma_f32_16x16x32_bf16 v[128:131], a[176:179], a[0:3], v[128:131]
    ds_read_b128 a[160:163], v1 offset:28672
    v_fmac_f32 v208, v9, v28
    v_mfma_f32_16x16x32_bf16 v[128:131], a[180:183], a[16:19], v[128:131]
    ds_read_b128 a[164:167], v1 offset:43008
    v_fmac_f32 v209, v9, v29
    v_mfma_f32_16x16x32_bf16 v[132:135], a[176:179], a[4:7], v[132:135]
    s_add_u32 m0, s36, 114688
    v_fmac_f32 v210, v9, v30
    v_mfma_f32_16x16x32_bf16 v[132:135], a[180:183], a[20:23], v[132:135]
    buffer_load_dwordx4 v1, s[12:15], s35 offen offset:0 lds
    v_fmac_f32 v211, v9, v31
    v_mfma_f32_16x16x32_bf16 v[136:139], a[176:179], a[8:11], v[136:139]
    v_fmac_f32 v212, v11, v28
    v_fmac_f32 v213, v11, v29
    v_mfma_f32_16x16x32_bf16 v[136:139], a[180:183], a[24:27], v[136:139]
    v_fmac_f32 v214, v11, v30
    v_fmac_f32 v215, v11, v31
    v_mfma_f32_16x16x32_bf16 v[140:143], a[176:179], a[12:15], v[140:143]
    buffer_load_dwordx4 v1, s[12:15], s35 offen offset:1024 lds
    v_fmac_f32 v216, v13, v28
    v_mfma_f32_16x16x32_bf16 v[140:143], a[180:183], a[28:31], v[140:143]
    v_fmac_f32 v217, v13, v29
    v_mfma_f32_16x16x32_bf16 v[252:255], a[184:187], a[12:15], v[252:255]
    ds_read_b128 a[168:171], v1 offset:35840
    v_fmac_f32 v218, v13, v30
    v_mfma_f32_16x16x32_bf16 v[252:255], a[188:191], a[28:31], v[252:255]
    ds_read_b128 a[172:175], v1 offset:50176
    v_fmac_f32 v219, v13, v31
    v_mfma_f32_16x16x32_bf16 v[248:251], a[184:187], a[8:11], v[248:251]
    v_fmac_f32 v220, v15, v28
    v_fmac_f32 v221, v15, v29
    v_mfma_f32_16x16x32_bf16 v[248:251], a[188:191], a[24:27], v[248:251]
    v_fmac_f32 v222, v15, v30
    v_fmac_f32 v223, v15, v31
    v_mfma_f32_16x16x32_bf16 v[244:247], a[184:187], a[4:7], v[244:247]
    v_mfma_f32_16x16x32_bf16 v[244:247], a[188:191], a[20:23], v[244:247]
    v_mfma_f32_16x16x32_bf16 v[240:243], a[184:187], a[0:3], v[240:243]
    buffer_load_dwordx4 v1, s[12:15], s35 offen offset:2048 lds
    v_mfma_f32_16x16x32_bf16 v[240:243], a[188:191], a[16:19], v[240:243]
    s_waitcnt lgkmcnt(2)
    v_mfma_f32_16x16x32_bf16 v[32:35], a[160:163], a[32:35], v[32:35]
    ds_read_b128 a[176:179], v1 offset:29696
    ds_read_b128 v[20:23], v4 offset:320
    v_mfma_f32_16x16x32_bf16 v[32:35], a[164:167], a[48:51], v[32:35]
    ds_read_b128 a[180:183], v1 offset:44032
    v_mfma_f32_16x16x32_bf16 v[36:39], a[160:163], a[36:39], v[36:39]
    v_mfma_f32_16x16x32_bf16 v[36:39], a[164:167], a[52:55], v[36:39]
    buffer_load_dwordx4 v1, s[12:15], s35 offen offset:3072 lds
    s_add_u32 s35, s35, 4096
    v_mfma_f32_16x16x32_bf16 v[40:43], a[160:163], a[40:43], v[40:43]
    v_mfma_f32_16x16x32_bf16 v[40:43], a[164:167], a[56:59], v[40:43]
    s_add_u32 m0, s36, 118784
    v_mfma_f32_16x16x32_bf16 v[44:47], a[160:163], a[44:47], v[44:47]
    buffer_load_dwordx4 v1, s[12:15], s35 offen offset:0 lds
    v_mfma_f32_16x16x32_bf16 v[44:47], a[164:167], a[60:63], v[44:47]
    s_waitcnt lgkmcnt(3)
    s_waitcnt lgkmcnt(1)
    v_mfma_f32_16x16x32_bf16 v[156:159], a[168:171], a[44:47], v[156:159]
    ds_read_b128 a[184:187], v1 offset:36864
    v_fmac_f32 v112, v9, v20
    v_mfma_f32_16x16x32_bf16 v[156:159], a[172:175], a[60:63], v[156:159]
    ds_read_b128 a[188:191], v1 offset:51200
    v_fmac_f32 v113, v9, v21
    v_mfma_f32_16x16x32_bf16 v[152:155], a[168:171], a[40:43], v[152:155]
    v_fmac_f32 v114, v9, v22
    v_fmac_f32 v115, v9, v23
    v_mfma_f32_16x16x32_bf16 v[152:155], a[172:175], a[56:59], v[152:155]
    v_fmac_f32 v116, v11, v20
    v_fmac_f32 v117, v11, v21
    v_mfma_f32_16x16x32_bf16 v[148:151], a[168:171], a[36:39], v[148:151]
    v_fmac_f32 v118, v11, v22
    v_fmac_f32 v119, v11, v23
    v_mfma_f32_16x16x32_bf16 v[148:151], a[172:175], a[52:55], v[148:151]
    v_fmac_f32 v120, v13, v20
    v_fmac_f32 v121, v13, v21
    v_mfma_f32_16x16x32_bf16 v[144:147], a[168:171], a[32:35], v[144:147]
    buffer_load_dwordx4 v1, s[12:15], s35 offen offset:1024 lds
    v_fmac_f32 v122, v13, v22
    v_mfma_f32_16x16x32_bf16 v[144:147], a[172:175], a[48:51], v[144:147]
    s_waitcnt lgkmcnt(2)
    v_fmac_f32 v123, v13, v23
    v_mfma_f32_16x16x32_bf16 v[48:51], a[176:179], a[32:35], v[48:51]
    ds_read_b128 a[160:163], v1 offset:30720
    v_fmac_f32 v124, v15, v20
    v_mfma_f32_16x16x32_bf16 v[48:51], a[180:183], a[48:51], v[48:51]
    ds_read_b128 a[164:167], v1 offset:45056
    v_fmac_f32 v125, v15, v21
    v_mfma_f32_16x16x32_bf16 v[52:55], a[176:179], a[36:39], v[52:55]
    v_fmac_f32 v126, v15, v22
    v_fmac_f32 v127, v15, v23
    v_mfma_f32_16x16x32_bf16 v[52:55], a[180:183], a[52:55], v[52:55]
    buffer_load_dwordx4 v1, s[12:15], s35 offen offset:2048 lds
    s_add_u32 s35, s35, 24576
    v_mfma_f32_16x16x32_bf16 v[56:59], a[176:179], a[40:43], v[56:59]
    v_mfma_f32_16x16x32_bf16 v[56:59], a[180:183], a[56:59], v[56:59]
    v_mfma_f32_16x16x32_bf16 v[60:63], a[176:179], a[44:47], v[60:63]
    buffer_load_dwordx4 a[128:131], v1, s[8:11], s34 offen offset:0
    v_mfma_f32_16x16x32_bf16 v[60:63], a[180:183], a[60:63], v[60:63]
    s_waitcnt lgkmcnt(2)
    v_mfma_f32_16x16x32_bf16 v[172:175], a[184:187], a[44:47], v[172:175]
    ds_read_b128 a[168:171], v1 offset:37888
    ds_read_b128 v[28:31], v4 offset:768
    v_mfma_f32_16x16x32_bf16 v[172:175], a[188:191], a[60:63], v[172:175]
    ds_read_b128 a[172:175], v1 offset:52224
    v_mfma_f32_16x16x32_bf16 v[168:171], a[184:187], a[40:43], v[168:171]
    v_mfma_f32_16x16x32_bf16 v[168:171], a[188:191], a[56:59], v[168:171]
    v_mfma_f32_16x16x32_bf16 v[164:167], a[184:187], a[36:39], v[164:167]
    v_mfma_f32_16x16x32_bf16 v[164:167], a[188:191], a[52:55], v[164:167]
    v_mfma_f32_16x16x32_bf16 v[160:163], a[184:187], a[32:35], v[160:163]
    buffer_load_dwordx4 a[132:135], v1, s[8:11], s34 offen offset:1024
    v_mfma_f32_16x16x32_bf16 v[160:163], a[188:191], a[48:51], v[160:163]
    s_waitcnt lgkmcnt(3)
    s_waitcnt lgkmcnt(1)
    v_mfma_f32_16x16x32_bf16 v[64:67], a[160:163], a[32:35], v[64:67]
    ds_read_b128 a[176:179], v1 offset:31744
    v_fmac_f32 v224, v9, v28
    v_mfma_f32_16x16x32_bf16 v[64:67], a[164:167], a[48:51], v[64:67]
    ds_read_b128 a[180:183], v1 offset:46080
    v_fmac_f32 v225, v9, v29
    v_mfma_f32_16x16x32_bf16 v[68:71], a[160:163], a[36:39], v[68:71]
    v_fmac_f32 v226, v9, v30
    v_fmac_f32 v227, v9, v31
    v_mfma_f32_16x16x32_bf16 v[68:71], a[164:167], a[52:55], v[68:71]
    buffer_load_dwordx4 a[136:139], v1, s[8:11], s34 offen offset:2048
    v_fmac_f32 v228, v11, v28
    v_mfma_f32_16x16x32_bf16 v[72:75], a[160:163], a[40:43], v[72:75]
    v_fmac_f32 v229, v11, v29
    v_fmac_f32 v230, v11, v30
    v_mfma_f32_16x16x32_bf16 v[72:75], a[164:167], a[56:59], v[72:75]
    v_fmac_f32 v231, v11, v31
    v_fmac_f32 v232, v13, v28
    v_mfma_f32_16x16x32_bf16 v[76:79], a[160:163], a[44:47], v[76:79]
    buffer_load_dwordx4 a[140:143], v1, s[8:11], s34 offen offset:3072
    s_add_u32 s34, s34, 4096
    v_mfma_f32_16x16x32_bf16 v[76:79], a[164:167], a[60:63], v[76:79]
    s_waitcnt lgkmcnt(2)
    v_fmac_f32 v233, v13, v29
    v_mfma_f32_16x16x32_bf16 v[188:191], a[168:171], a[44:47], v[188:191]
    ds_read_b128 a[184:187], v1 offset:38912
    v_fmac_f32 v234, v13, v30
    v_mfma_f32_16x16x32_bf16 v[188:191], a[172:175], a[60:63], v[188:191]
    ds_read_b128 a[188:191], v1 offset:53248
    v_fmac_f32 v235, v13, v31
    v_mfma_f32_16x16x32_bf16 v[184:187], a[168:171], a[40:43], v[184:187]
    v_fmac_f32 v236, v15, v28
    v_fmac_f32 v237, v15, v29
    v_mfma_f32_16x16x32_bf16 v[184:187], a[172:175], a[56:59], v[184:187]
    v_fmac_f32 v238, v15, v30
    v_fmac_f32 v239, v15, v31
    v_mfma_f32_16x16x32_bf16 v[180:183], a[168:171], a[36:39], v[180:183]
    v_mfma_f32_16x16x32_bf16 v[180:183], a[172:175], a[52:55], v[180:183]
    v_mfma_f32_16x16x32_bf16 v[176:179], a[168:171], a[32:35], v[176:179]
    buffer_load_dwordx4 a[144:147], v1, s[8:11], s34 offen offset:0
    v_mfma_f32_16x16x32_bf16 v[176:179], a[172:175], a[48:51], v[176:179]
    s_waitcnt lgkmcnt(2)
    v_mfma_f32_16x16x32_bf16 v[80:83], a[176:179], a[32:35], v[80:83]
    ds_read_b128 a[160:163], v1 offset:32768
    ds_read_b128 v[20:23], v4 offset:384
    v_mfma_f32_16x16x32_bf16 v[80:83], a[180:183], a[48:51], v[80:83]
    ds_read_b128 a[164:167], v1 offset:47104
    v_mfma_f32_16x16x32_bf16 v[84:87], a[176:179], a[36:39], v[84:87]
    v_mfma_f32_16x16x32_bf16 v[84:87], a[180:183], a[52:55], v[84:87]
    buffer_load_dwordx4 a[148:151], v1, s[8:11], s34 offen offset:1024
    v_mfma_f32_16x16x32_bf16 v[88:91], a[176:179], a[40:43], v[88:91]
    v_mfma_f32_16x16x32_bf16 v[88:91], a[180:183], a[56:59], v[88:91]
    v_mfma_f32_16x16x32_bf16 v[92:95], a[176:179], a[44:47], v[92:95]
    buffer_load_dwordx4 a[152:155], v1, s[8:11], s34 offen offset:2048
    v_mfma_f32_16x16x32_bf16 v[92:95], a[180:183], a[60:63], v[92:95]
    s_waitcnt lgkmcnt(3)
    s_waitcnt lgkmcnt(1)
    v_mfma_f32_16x16x32_bf16 v[204:207], a[184:187], a[44:47], v[204:207]
    ds_read_b128 a[168:171], v1 offset:39936
    v_fmac_f32 v128, v9, v20
    v_mfma_f32_16x16x32_bf16 v[204:207], a[188:191], a[60:63], v[204:207]
    ds_read_b128 a[172:175], v1 offset:54272
    v_fmac_f32 v129, v9, v21
    v_mfma_f32_16x16x32_bf16 v[200:203], a[184:187], a[40:43], v[200:203]
    v_fmac_f32 v130, v9, v22
    v_fmac_f32 v131, v9, v23
    v_mfma_f32_16x16x32_bf16 v[200:203], a[188:191], a[56:59], v[200:203]
    v_fmac_f32 v132, v11, v20
    v_fmac_f32 v133, v11, v21
    v_mfma_f32_16x16x32_bf16 v[196:199], a[184:187], a[36:39], v[196:199]
    v_fmac_f32 v134, v11, v22
    v_fmac_f32 v135, v11, v23
    v_mfma_f32_16x16x32_bf16 v[196:199], a[188:191], a[52:55], v[196:199]
    v_fmac_f32 v136, v13, v20
    v_fmac_f32 v137, v13, v21
    v_mfma_f32_16x16x32_bf16 v[192:195], a[184:187], a[32:35], v[192:195]
    buffer_load_dwordx4 a[156:159], v1, s[8:11], s34 offen offset:3072
    s_add_u32 s34, s34, 4096
    v_mfma_f32_16x16x32_bf16 v[192:195], a[188:191], a[48:51], v[192:195]
    s_waitcnt lgkmcnt(2)
    v_fmac_f32 v138, v13, v22
    v_mfma_f32_16x16x32_bf16 v[96:99], a[160:163], a[32:35], v[96:99]
    ds_read_b128 a[176:179], v1 offset:33792
    v_fmac_f32 v139, v13, v23
    v_mfma_f32_16x16x32_bf16 v[96:99], a[164:167], a[48:51], v[96:99]
    ds_read_b128 a[180:183], v1 offset:48128
    v_fmac_f32 v140, v15, v20
    v_mfma_f32_16x16x32_bf16 v[100:103], a[160:163], a[36:39], v[100:103]
    s_add_u32 m0, s36, 0
    v_fmac_f32 v141, v15, v21
    v_mfma_f32_16x16x32_bf16 v[100:103], a[164:167], a[52:55], v[100:103]
    buffer_load_dwordx4 v1, s[12:15], s35 offen offset:0 lds
    v_fmac_f32 v142, v15, v22
    v_mfma_f32_16x16x32_bf16 v[104:107], a[160:163], a[40:43], v[104:107]
    v_fmac_f32 v143, v15, v23
    v_mfma_f32_16x16x32_bf16 v[104:107], a[164:167], a[56:59], v[104:107]
    v_mfma_f32_16x16x32_bf16 v[108:111], a[160:163], a[44:47], v[108:111]
    buffer_load_dwordx4 v1, s[12:15], s35 offen offset:1024 lds
    v_mfma_f32_16x16x32_bf16 v[108:111], a[164:167], a[60:63], v[108:111]
    s_waitcnt lgkmcnt(2)
    v_mfma_f32_16x16x32_bf16 v[220:223], a[168:171], a[44:47], v[220:223]
    ds_read_b128 a[184:187], v1 offset:40960
    v_mfma_f32_16x16x32_bf16 v[220:223], a[172:175], a[60:63], v[220:223]
    ds_read_b128 a[188:191], v1 offset:55296
    v_mfma_f32_16x16x32_bf16 v[216:219], a[168:171], a[40:43], v[216:219]
    v_mfma_f32_16x16x32_bf16 v[216:219], a[172:175], a[56:59], v[216:219]
    buffer_load_dwordx4 v1, s[12:15], s35 offen offset:2048 lds
    v_mfma_f32_16x16x32_bf16 v[212:215], a[168:171], a[36:39], v[212:215]
    v_mfma_f32_16x16x32_bf16 v[212:215], a[172:175], a[52:55], v[212:215]
    v_mfma_f32_16x16x32_bf16 v[208:211], a[168:171], a[32:35], v[208:211]
    v_mfma_f32_16x16x32_bf16 v[208:211], a[172:175], a[48:51], v[208:211]
    s_waitcnt lgkmcnt(2)
    v_mfma_f32_16x16x32_bf16 v[112:115], a[176:179], a[32:35], v[112:115]
    ds_read_b128 a[160:163], v1 offset:34816
    v_mfma_f32_16x16x32_bf16 v[112:115], a[180:183], a[48:51], v[112:115]
    ds_read_b128 a[164:167], v1 offset:49152
    v_mfma_f32_16x16x32_bf16 v[116:119], a[176:179], a[36:39], v[116:119]
    v_mfma_f32_16x16x32_bf16 v[116:119], a[180:183], a[52:55], v[116:119]
    buffer_load_dwordx4 v1, s[12:15], s35 offen offset:3072 lds
    s_add_u32 s35, s35, 4096
    v_mfma_f32_16x16x32_bf16 v[120:123], a[176:179], a[40:43], v[120:123]
    v_mfma_f32_16x16x32_bf16 v[120:123], a[180:183], a[56:59], v[120:123]
    s_add_u32 m0, s36, 4096
    v_mfma_f32_16x16x32_bf16 v[124:127], a[176:179], a[44:47], v[124:127]
    buffer_load_dwordx4 v1, s[12:15], s35 offen offset:0 lds
    v_mfma_f32_16x16x32_bf16 v[124:127], a[180:183], a[60:63], v[124:127]
    s_waitcnt lgkmcnt(2)
    v_mfma_f32_16x16x32_bf16 v[236:239], a[184:187], a[44:47], v[236:239]
    ds_read_b128 a[168:171], v1 offset:41984
    v_mfma_f32_16x16x32_bf16 v[236:239], a[188:191], a[60:63], v[236:239]
    ds_read_b128 a[172:175], v1 offset:56320
    v_mfma_f32_16x16x32_bf16 v[232:235], a[184:187], a[40:43], v[232:235]
    v_mfma_f32_16x16x32_bf16 v[232:235], a[188:191], a[56:59], v[232:235]
    buffer_load_dwordx4 v1, s[12:15], s35 offen offset:1024 lds
    v_mfma_f32_16x16x32_bf16 v[228:231], a[184:187], a[36:39], v[228:231]
    v_mfma_f32_16x16x32_bf16 v[228:231], a[188:191], a[52:55], v[228:231]
    v_mfma_f32_16x16x32_bf16 v[224:227], a[184:187], a[32:35], v[224:227]
    v_mfma_f32_16x16x32_bf16 v[224:227], a[188:191], a[48:51], v[224:227]
    s_waitcnt vmcnt(36) lgkmcnt(0)
    s_barrier
    v_mfma_f32_16x16x32_bf16 v[128:131], a[160:163], a[32:35], v[128:131]
    ds_read_b128 a[176:179], v2 offset:0
    v_mfma_f32_16x16x32_bf16 v[128:131], a[164:167], a[48:51], v[128:131]
    ds_read_b128 a[180:183], v2 offset:14336
    v_mfma_f32_16x16x32_bf16 v[132:135], a[160:163], a[36:39], v[132:135]
    v_mfma_f32_16x16x32_bf16 v[132:135], a[164:167], a[52:55], v[132:135]
    buffer_load_dwordx4 v1, s[12:15], s35 offen offset:2048 lds
    s_add_u32 s35, s35, 24576
    v_mfma_f32_16x16x32_bf16 v[136:139], a[160:163], a[40:43], v[136:139]
    v_mfma_f32_16x16x32_bf16 v[136:139], a[164:167], a[56:59], v[136:139]
    v_mfma_f32_16x16x32_bf16 v[140:143], a[160:163], a[44:47], v[140:143]
    buffer_load_dwordx4 a[0:3], v1, s[8:11], s34 offen offset:0
    v_mfma_f32_16x16x32_bf16 v[140:143], a[164:167], a[60:63], v[140:143]
    v_mfma_f32_16x16x32_bf16 v[252:255], a[168:171], a[44:47], v[252:255]
    ds_read_b128 a[184:187], v2 offset:7168
    v_mfma_f32_16x16x32_bf16 v[252:255], a[172:175], a[60:63], v[252:255]
    ds_read_b128 a[188:191], v2 offset:21504
    v_mfma_f32_16x16x32_bf16 v[248:251], a[168:171], a[40:43], v[248:251]
    v_mfma_f32_16x16x32_bf16 v[248:251], a[172:175], a[56:59], v[248:251]
    buffer_load_dwordx4 a[4:7], v1, s[8:11], s34 offen offset:1024
    v_mfma_f32_16x16x32_bf16 v[244:247], a[168:171], a[36:39], v[244:247]
    v_mfma_f32_16x16x32_bf16 v[244:247], a[172:175], a[52:55], v[244:247]
    v_mfma_f32_16x16x32_bf16 v[240:243], a[168:171], a[32:35], v[240:243]
    v_mfma_f32_16x16x32_bf16 v[240:243], a[172:175], a[48:51], v[240:243]
    s_waitcnt lgkmcnt(2)
    v_mfma_f32_16x16x32_bf16 v[32:35], a[176:179], a[64:67], v[32:35]
    ds_read_b128 a[160:163], v2 offset:1024
    v_mfma_f32_16x16x32_bf16 v[32:35], a[180:183], a[80:83], v[32:35]
    ds_read_b128 a[164:167], v2 offset:15360
    v_mfma_f32_16x16x32_bf16 v[36:39], a[176:179], a[68:71], v[36:39]
    v_mfma_f32_16x16x32_bf16 v[36:39], a[180:183], a[84:87], v[36:39]
    buffer_load_dwordx4 a[8:11], v1, s[8:11], s34 offen offset:2048
    v_mfma_f32_16x16x32_bf16 v[40:43], a[176:179], a[72:75], v[40:43]
    ds_read_b128 v[28:31], v4 offset:832
    v_mfma_f32_16x16x32_bf16 v[40:43], a[180:183], a[88:91], v[40:43]
    v_mfma_f32_16x16x32_bf16 v[44:47], a[176:179], a[76:79], v[44:47]
    buffer_load_dwordx4 a[12:15], v1, s[8:11], s34 offen offset:3072
    s_add_u32 s34, s34, 4096
    v_mfma_f32_16x16x32_bf16 v[44:47], a[180:183], a[92:95], v[44:47]
    s_waitcnt lgkmcnt(3)
    v_mfma_f32_16x16x32_bf16 v[156:159], a[184:187], a[76:79], v[156:159]
    ds_read_b128 a[168:171], v2 offset:8192
    v_mfma_f32_16x16x32_bf16 v[156:159], a[188:191], a[92:95], v[156:159]
    ds_read_b128 a[172:175], v2 offset:22528
    v_mfma_f32_16x16x32_bf16 v[152:155], a[184:187], a[72:75], v[152:155]
    v_mfma_f32_16x16x32_bf16 v[152:155], a[188:191], a[88:91], v[152:155]
    buffer_load_dwordx4 a[16:19], v1, s[8:11], s34 offen offset:0
    s_waitcnt lgkmcnt(2)
    v_mfma_f32_16x16x32_bf16 v[148:151], a[184:187], a[68:71], v[148:151]
    v_fmac_f32 v240, v9, v28
    v_fmac_f32 v241, v9, v29
    v_mfma_f32_16x16x32_bf16 v[148:151], a[188:191], a[84:87], v[148:151]
    v_fmac_f32 v242, v9, v30
    v_fmac_f32 v243, v9, v31
    v_mfma_f32_16x16x32_bf16 v[144:147], a[184:187], a[64:67], v[144:147]
    v_fmac_f32 v244, v11, v28
    v_fmac_f32 v245, v11, v29
    v_mfma_f32_16x16x32_bf16 v[144:147], a[188:191], a[80:83], v[144:147]
    v_fmac_f32 v246, v11, v30
    v_mfma_f32_16x16x32_bf16 v[48:51], a[160:163], a[64:67], v[48:51]
    ds_read_b128 a[176:179], v2 offset:2048
    v_fmac_f32 v247, v11, v31
    v_mfma_f32_16x16x32_bf16 v[48:51], a[164:167], a[80:83], v[48:51]
    ds_read_b128 a[180:183], v2 offset:16384
    v_fmac_f32 v248, v13, v28
    v_mfma_f32_16x16x32_bf16 v[52:55], a[160:163], a[68:71], v[52:55]
    v_fmac_f32 v249, v13, v29
    v_fmac_f32 v250, v13, v30
    v_mfma_f32_16x16x32_bf16 v[52:55], a[164:167], a[84:87], v[52:55]
    buffer_load_dwordx4 a[20:23], v1, s[8:11], s34 offen offset:1024
    v_fmac_f32 v251, v13, v31
    v_mfma_f32_16x16x32_bf16 v[56:59], a[160:163], a[72:75], v[56:59]
    v_fmac_f32 v252, v15, v28
    v_fmac_f32 v253, v15, v29
    v_mfma_f32_16x16x32_bf16 v[56:59], a[164:167], a[88:91], v[56:59]
    v_fmac_f32 v254, v15, v30
    v_fmac_f32 v255, v15, v31
    v_mfma_f32_16x16x32_bf16 v[60:63], a[160:163], a[76:79], v[60:63]
    buffer_load_dwordx4 a[24:27], v1, s[8:11], s34 offen offset:2048
    v_mfma_f32_16x16x32_bf16 v[60:63], a[164:167], a[92:95], v[60:63]
    s_waitcnt lgkmcnt(2)
    v_mfma_f32_16x16x32_bf16 v[172:175], a[168:171], a[76:79], v[172:175]
    ds_read_b128 a[184:187], v2 offset:9216
    v_mfma_f32_16x16x32_bf16 v[172:175], a[172:175], a[92:95], v[172:175]
    ds_read_b128 a[188:191], v2 offset:23552
    v_mfma_f32_16x16x32_bf16 v[168:171], a[168:171], a[72:75], v[168:171]
    s_branch L_isl9_over
.p2align 12
L_isl9:
    s_setpc_b64 s[14:15]
L_isl9_over:
    v_mfma_f32_16x16x32_bf16 v[168:171], a[172:175], a[88:91], v[168:171]
    buffer_load_dwordx4 a[28:31], v1, s[8:11], s34 offen offset:3072
    s_add_u32 s34, s34, 4096
    v_mfma_f32_16x16x32_bf16 v[164:167], a[168:171], a[68:71], v[164:167]
    v_mfma_f32_16x16x32_bf16 v[164:167], a[172:175], a[84:87], v[164:167]
    v_mfma_f32_16x16x32_bf16 v[160:163], a[168:171], a[64:67], v[160:163]
    v_mfma_f32_16x16x32_bf16 v[160:163], a[172:175], a[80:83], v[160:163]
    s_waitcnt lgkmcnt(2)
    v_mfma_f32_16x16x32_bf16 v[64:67], a[176:179], a[64:67], v[64:67]
    ds_read_b128 a[160:163], v2 offset:3072
    v_mfma_f32_16x16x32_bf16 v[64:67], a[180:183], a[80:83], v[64:67]
    ds_read_b128 a[164:167], v2 offset:17408
    v_mfma_f32_16x16x32_bf16 v[68:71], a[176:179], a[68:71], v[68:71]
    s_add_u32 m0, s36, 28672
    v_mfma_f32_16x16x32_bf16 v[68:71], a[180:183], a[84:87], v[68:71]
    buffer_load_dwordx4 v1, s[12:15], s35 offen offset:0 lds
    v_mfma_f32_16x16x32_bf16 v[72:75], a[176:179], a[72:75], v[72:75]
    v_mfma_f32_16x16x32_bf16 v[72:75], a[180:183], a[88:91], v[72:75]
    v_mfma_f32_16x16x32_bf16 v[76:79], a[176:179], a[76:79], v[76:79]
    buffer_load_dwordx4 v1, s[12:15], s35 offen offset:1024 lds
    v_mfma_f32_16x16x32_bf16 v[76:79], a[180:183], a[92:95], v[76:79]
    s_waitcnt lgkmcnt(2)
    v_mfma_f32_16x16x32_bf16 v[188:191], a[184:187], a[76:79], v[188:191]
    ds_read_b128 a[168:171], v2 offset:10240
    v_mfma_f32_16x16x32_bf16 v[188:191], a[188:191], a[92:95], v[188:191]
    ds_read_b128 a[172:175], v2 offset:24576
    v_mfma_f32_16x16x32_bf16 v[184:187], a[184:187], a[72:75], v[184:187]
    v_mfma_f32_16x16x32_bf16 v[184:187], a[188:191], a[88:91], v[184:187]
    buffer_load_dwordx4 v1, s[12:15], s35 offen offset:2048 lds
    v_mfma_f32_16x16x32_bf16 v[180:183], a[184:187], a[68:71], v[180:183]
    v_mfma_f32_16x16x32_bf16 v[180:183], a[188:191], a[84:87], v[180:183]
    v_mfma_f32_16x16x32_bf16 v[176:179], a[184:187], a[64:67], v[176:179]
    v_mfma_f32_16x16x32_bf16 v[176:179], a[188:191], a[80:83], v[176:179]
    s_waitcnt lgkmcnt(2)
    v_mfma_f32_16x16x32_bf16 v[80:83], a[160:163], a[64:67], v[80:83]
    ds_read_b128 a[176:179], v2 offset:4096
    v_mfma_f32_16x16x32_bf16 v[80:83], a[164:167], a[80:83], v[80:83]
    ds_read_b128 a[180:183], v2 offset:18432
    v_mfma_f32_16x16x32_bf16 v[84:87], a[160:163], a[68:71], v[84:87]
    v_mfma_f32_16x16x32_bf16 v[84:87], a[164:167], a[84:87], v[84:87]
    buffer_load_dwordx4 v1, s[12:15], s35 offen offset:3072 lds
    s_add_u32 s35, s35, 4096
    v_mfma_f32_16x16x32_bf16 v[88:91], a[160:163], a[72:75], v[88:91]
    v_mfma_f32_16x16x32_bf16 v[88:91], a[164:167], a[88:91], v[88:91]
    s_add_u32 m0, s36, 32768
    v_mfma_f32_16x16x32_bf16 v[92:95], a[160:163], a[76:79], v[92:95]
    buffer_load_dwordx4 v1, s[12:15], s35 offen offset:0 lds
    v_mfma_f32_16x16x32_bf16 v[92:95], a[164:167], a[92:95], v[92:95]
    s_waitcnt lgkmcnt(2)
    v_mfma_f32_16x16x32_bf16 v[204:207], a[168:171], a[76:79], v[204:207]
    ds_read_b128 a[184:187], v2 offset:11264
    v_mfma_f32_16x16x32_bf16 v[204:207], a[172:175], a[92:95], v[204:207]
    ds_read_b128 a[188:191], v2 offset:25600
    v_mfma_f32_16x16x32_bf16 v[200:203], a[168:171], a[72:75], v[200:203]
    v_mfma_f32_16x16x32_bf16 v[200:203], a[172:175], a[88:91], v[200:203]
    buffer_load_dwordx4 v1, s[12:15], s35 offen offset:1024 lds
    v_mfma_f32_16x16x32_bf16 v[196:199], a[168:171], a[68:71], v[196:199]
    v_mfma_f32_16x16x32_bf16 v[196:199], a[172:175], a[84:87], v[196:199]
    v_mfma_f32_16x16x32_bf16 v[192:195], a[168:171], a[64:67], v[192:195]
    v_mfma_f32_16x16x32_bf16 v[192:195], a[172:175], a[80:83], v[192:195]
    s_waitcnt lgkmcnt(2)
    v_mfma_f32_16x16x32_bf16 v[96:99], a[176:179], a[64:67], v[96:99]
    ds_read_b128 a[160:163], v2 offset:5120
    v_mfma_f32_16x16x32_bf16 v[96:99], a[180:183], a[80:83], v[96:99]
    ds_read_b128 a[164:167], v2 offset:19456
    v_mfma_f32_16x16x32_bf16 v[100:103], a[176:179], a[68:71], v[100:103]
    v_mfma_f32_16x16x32_bf16 v[100:103], a[180:183], a[84:87], v[100:103]
    buffer_load_dwordx4 v1, s[12:15], s35 offen offset:2048 lds
    s_add_u32 s35, s35, 24576
    v_mfma_f32_16x16x32_bf16 v[104:107], a[176:179], a[72:75], v[104:107]
    v_mfma_f32_16x16x32_bf16 v[104:107], a[180:183], a[88:91], v[104:107]
    v_mfma_f32_16x16x32_bf16 v[108:111], a[176:179], a[76:79], v[108:111]
    buffer_load_dwordx4 a[32:35], v1, s[8:11], s34 offen offset:0
    v_mfma_f32_16x16x32_bf16 v[108:111], a[180:183], a[92:95], v[108:111]
    s_waitcnt lgkmcnt(2)
    v_mfma_f32_16x16x32_bf16 v[220:223], a[184:187], a[76:79], v[220:223]
    ds_read_b128 a[168:171], v2 offset:12288
    v_mfma_f32_16x16x32_bf16 v[220:223], a[188:191], a[92:95], v[220:223]
    ds_read_b128 a[172:175], v2 offset:26624
    v_mfma_f32_16x16x32_bf16 v[216:219], a[184:187], a[72:75], v[216:219]
    v_mfma_f32_16x16x32_bf16 v[216:219], a[188:191], a[88:91], v[216:219]
    buffer_load_dwordx4 a[36:39], v1, s[8:11], s34 offen offset:1024
    v_mfma_f32_16x16x32_bf16 v[212:215], a[184:187], a[68:71], v[212:215]
    v_mfma_f32_16x16x32_bf16 v[212:215], a[188:191], a[84:87], v[212:215]
    v_mfma_f32_16x16x32_bf16 v[208:211], a[184:187], a[64:67], v[208:211]
    v_mfma_f32_16x16x32_bf16 v[208:211], a[188:191], a[80:83], v[208:211]
    s_waitcnt lgkmcnt(2)
    v_mfma_f32_16x16x32_bf16 v[112:115], a[160:163], a[64:67], v[112:115]
    ds_read_b128 a[176:179], v2 offset:6144
    v_mfma_f32_16x16x32_bf16 v[112:115], a[164:167], a[80:83], v[112:115]
    ds_read_b128 a[180:183], v2 offset:20480
    v_mfma_f32_16x16x32_bf16 v[116:119], a[160:163], a[68:71], v[116:119]
    v_mfma_f32_16x16x32_bf16 v[116:119], a[164:167], a[84:87], v[116:119]
    buffer_load_dwordx4 a[40:43], v1, s[8:11], s34 offen offset:2048
    v_mfma_f32_16x16x32_bf16 v[120:123], a[160:163], a[72:75], v[120:123]
    v_mfma_f32_16x16x32_bf16 v[120:123], a[164:167], a[88:91], v[120:123]
    v_mfma_f32_16x16x32_bf16 v[124:127], a[160:163], a[76:79], v[124:127]
    buffer_load_dwordx4 a[44:47], v1, s[8:11], s34 offen offset:3072
    s_add_u32 s34, s34, 4096
    v_mfma_f32_16x16x32_bf16 v[124:127], a[164:167], a[92:95], v[124:127]
    s_waitcnt lgkmcnt(2)
    v_mfma_f32_16x16x32_bf16 v[236:239], a[168:171], a[76:79], v[236:239]
    ds_read_b128 a[184:187], v2 offset:13312
    v_mfma_f32_16x16x32_bf16 v[236:239], a[172:175], a[92:95], v[236:239]
    ds_read_b128 a[188:191], v2 offset:27648
    v_mfma_f32_16x16x32_bf16 v[232:235], a[168:171], a[72:75], v[232:235]
    v_mfma_f32_16x16x32_bf16 v[232:235], a[172:175], a[88:91], v[232:235]
    buffer_load_dwordx4 a[48:51], v1, s[8:11], s34 offen offset:0
    v_mfma_f32_16x16x32_bf16 v[228:231], a[168:171], a[68:71], v[228:231]
    v_mfma_f32_16x16x32_bf16 v[228:231], a[172:175], a[84:87], v[228:231]
    v_mfma_f32_16x16x32_bf16 v[224:227], a[168:171], a[64:67], v[224:227]
    v_mfma_f32_16x16x32_bf16 v[224:227], a[172:175], a[80:83], v[224:227]
    s_waitcnt vmcnt(42) lgkmcnt(0)
    s_barrier
    v_mfma_f32_16x16x32_bf16 v[128:131], a[176:179], a[64:67], v[128:131]
    ds_read_b128 a[160:163], v2 offset:28672
    v_mfma_f32_16x16x32_bf16 v[128:131], a[180:183], a[80:83], v[128:131]
    ds_read_b128 a[164:167], v2 offset:43008
    v_mfma_f32_16x16x32_bf16 v[132:135], a[176:179], a[68:71], v[132:135]
    v_mfma_f32_16x16x32_bf16 v[132:135], a[180:183], a[84:87], v[132:135]
    buffer_load_dwordx4 a[52:55], v1, s[8:11], s34 offen offset:1024
    v_mfma_f32_16x16x32_bf16 v[136:139], a[176:179], a[72:75], v[136:139]
    v_mfma_f32_16x16x32_bf16 v[136:139], a[180:183], a[88:91], v[136:139]
    v_mfma_f32_16x16x32_bf16 v[140:143], a[176:179], a[76:79], v[140:143]
    buffer_load_dwordx4 a[56:59], v1, s[8:11], s34 offen offset:2048
    v_mfma_f32_16x16x32_bf16 v[140:143], a[180:183], a[92:95], v[140:143]
    v_mfma_f32_16x16x32_bf16 v[252:255], a[184:187], a[76:79], v[252:255]
    ds_read_b128 a[168:171], v2 offset:35840
    v_mfma_f32_16x16x32_bf16 v[252:255], a[188:191], a[92:95], v[252:255]
    ds_read_b128 a[172:175], v2 offset:50176
    v_mfma_f32_16x16x32_bf16 v[248:251], a[184:187], a[72:75], v[248:251]
    v_mfma_f32_16x16x32_bf16 v[248:251], a[188:191], a[88:91], v[248:251]
    buffer_load_dwordx4 a[60:63], v1, s[8:11], s34 offen offset:3072
    s_add_u32 s34, s34, 4096
    v_mfma_f32_16x16x32_bf16 v[244:247], a[184:187], a[68:71], v[244:247]
    v_mfma_f32_16x16x32_bf16 v[244:247], a[188:191], a[84:87], v[244:247]
    v_mfma_f32_16x16x32_bf16 v[240:243], a[184:187], a[64:67], v[240:243]
    v_mfma_f32_16x16x32_bf16 v[240:243], a[188:191], a[80:83], v[240:243]
    s_waitcnt lgkmcnt(2)
    v_mfma_f32_16x16x32_bf16 v[32:35], a[160:163], a[96:99], v[32:35]
    ds_read_b128 a[176:179], v2 offset:29696
    v_mfma_f32_16x16x32_bf16 v[32:35], a[164:167], a[112:115], v[32:35]
    ds_read_b128 a[180:183], v2 offset:44032
    v_mfma_f32_16x16x32_bf16 v[36:39], a[160:163], a[100:103], v[36:39]
    s_add_u32 m0, s36, 57344
    v_mfma_f32_16x16x32_bf16 v[36:39], a[164:167], a[116:119], v[36:39]
    buffer_load_dwordx4 v1, s[12:15], s35 offen offset:0 lds
    v_mfma_f32_16x16x32_bf16 v[40:43], a[160:163], a[104:107], v[40:43]
    v_mfma_f32_16x16x32_bf16 v[40:43], a[164:167], a[120:123], v[40:43]
    v_mfma_f32_16x16x32_bf16 v[44:47], a[160:163], a[108:111], v[44:47]
    buffer_load_dwordx4 v1, s[12:15], s35 offen offset:1024 lds
    v_mfma_f32_16x16x32_bf16 v[44:47], a[164:167], a[124:127], v[44:47]
    s_waitcnt lgkmcnt(2)
    v_mfma_f32_16x16x32_bf16 v[156:159], a[168:171], a[108:111], v[156:159]
    ds_read_b128 a[184:187], v2 offset:36864
    v_mfma_f32_16x16x32_bf16 v[156:159], a[172:175], a[124:127], v[156:159]
    ds_read_b128 a[188:191], v2 offset:51200
    v_mfma_f32_16x16x32_bf16 v[152:155], a[168:171], a[104:107], v[152:155]
    v_mfma_f32_16x16x32_bf16 v[152:155], a[172:175], a[120:123], v[152:155]
    buffer_load_dwordx4 v1, s[12:15], s35 offen offset:2048 lds
    v_mfma_f32_16x16x32_bf16 v[148:151], a[168:171], a[100:103], v[148:151]
    v_mfma_f32_16x16x32_bf16 v[148:151], a[172:175], a[116:119], v[148:151]
    v_mfma_f32_16x16x32_bf16 v[144:147], a[168:171], a[96:99], v[144:147]
    v_mfma_f32_16x16x32_bf16 v[144:147], a[172:175], a[112:115], v[144:147]
    s_waitcnt lgkmcnt(2)
    v_mfma_f32_16x16x32_bf16 v[48:51], a[176:179], a[96:99], v[48:51]
    ds_read_b128 a[160:163], v2 offset:30720
    v_mfma_f32_16x16x32_bf16 v[48:51], a[180:183], a[112:115], v[48:51]
    ds_read_b128 a[164:167], v2 offset:45056
    v_mfma_f32_16x16x32_bf16 v[52:55], a[176:179], a[100:103], v[52:55]
    v_mfma_f32_16x16x32_bf16 v[52:55], a[180:183], a[116:119], v[52:55]
    buffer_load_dwordx4 v1, s[12:15], s35 offen offset:3072 lds
    s_add_u32 s35, s35, 4096
    v_mfma_f32_16x16x32_bf16 v[56:59], a[176:179], a[104:107], v[56:59]
    v_mfma_f32_16x16x32_bf16 v[56:59], a[180:183], a[120:123], v[56:59]
    s_add_u32 m0, s36, 61440
    v_mfma_f32_16x16x32_bf16 v[60:63], a[176:179], a[108:111], v[60:63]
    buffer_load_dwordx4 v1, s[12:15], s35 offen offset:0 lds
    v_mfma_f32_16x16x32_bf16 v[60:63], a[180:183], a[124:127], v[60:63]
    s_waitcnt lgkmcnt(2)
    v_mfma_f32_16x16x32_bf16 v[172:175], a[184:187], a[108:111], v[172:175]
    ds_read_b128 a[168:171], v2 offset:37888
    v_mfma_f32_16x16x32_bf16 v[172:175], a[188:191], a[124:127], v[172:175]
    ds_read_b128 a[172:175], v2 offset:52224
    v_mfma_f32_16x16x32_bf16 v[168:171], a[184:187], a[104:107], v[168:171]
    v_mfma_f32_16x16x32_bf16 v[168:171], a[188:191], a[120:123], v[168:171]
    buffer_load_dwordx4 v1, s[12:15], s35 offen offset:1024 lds
    v_mfma_f32_16x16x32_bf16 v[164:167], a[184:187], a[100:103], v[164:167]
    v_mfma_f32_16x16x32_bf16 v[164:167], a[188:191], a[116:119], v[164:167]
    v_mfma_f32_16x16x32_bf16 v[160:163], a[184:187], a[96:99], v[160:163]
    v_mfma_f32_16x16x32_bf16 v[160:163], a[188:191], a[112:115], v[160:163]
    s_waitcnt lgkmcnt(2)
    v_mfma_f32_16x16x32_bf16 v[64:67], a[160:163], a[96:99], v[64:67]
    ds_read_b128 a[176:179], v2 offset:31744
    v_mfma_f32_16x16x32_bf16 v[64:67], a[164:167], a[112:115], v[64:67]
    ds_read_b128 a[180:183], v2 offset:46080
    v_mfma_f32_16x16x32_bf16 v[68:71], a[160:163], a[100:103], v[68:71]
    v_mfma_f32_16x16x32_bf16 v[68:71], a[164:167], a[116:119], v[68:71]
    buffer_load_dwordx4 v1, s[12:15], s35 offen offset:2048 lds
    s_add_u32 s35, s35, 24576
    v_mfma_f32_16x16x32_bf16 v[72:75], a[160:163], a[104:107], v[72:75]
    v_mfma_f32_16x16x32_bf16 v[72:75], a[164:167], a[120:123], v[72:75]
    v_mfma_f32_16x16x32_bf16 v[76:79], a[160:163], a[108:111], v[76:79]
    buffer_load_dwordx4 a[64:67], v1, s[8:11], s34 offen offset:0
    v_mfma_f32_16x16x32_bf16 v[76:79], a[164:167], a[124:127], v[76:79]
    s_waitcnt lgkmcnt(2)
    v_mfma_f32_16x16x32_bf16 v[188:191], a[168:171], a[108:111], v[188:191]
    ds_read_b128 a[184:187], v2 offset:38912
    v_mfma_f32_16x16x32_bf16 v[188:191], a[172:175], a[124:127], v[188:191]
    ds_read_b128 a[188:191], v2 offset:53248
    v_mfma_f32_16x16x32_bf16 v[184:187], a[168:171], a[104:107], v[184:187]
    v_mfma_f32_16x16x32_bf16 v[184:187], a[172:175], a[120:123], v[184:187]
    buffer_load_dwordx4 a[68:71], v1, s[8:11], s34 offen offset:1024
    v_mfma_f32_16x16x32_bf16 v[180:183], a[168:171], a[100:103], v[180:183]
    v_mfma_f32_16x16x32_bf16 v[180:183], a[172:175], a[116:119], v[180:183]
    v_mfma_f32_16x16x32_bf16 v[176:179], a[168:171], a[96:99], v[176:179]
    v_mfma_f32_16x16x32_bf16 v[176:179], a[172:175], a[112:115], v[176:179]
    s_waitcnt lgkmcnt(2)
    v_mfma_f32_16x16x32_bf16 v[80:83], a[176:179], a[96:99], v[80:83]
    ds_read_b128 a[160:163], v2 offset:32768
    v_mfma_f32_16x16x32_bf16 v[80:83], a[180:183], a[112:115], v[80:83]
    ds_read_b128 a[164:167], v2 offset:47104
    v_mfma_f32_16x16x32_bf16 v[84:87], a[176:179], a[100:103], v[84:87]
    v_mfma_f32_16x16x32_bf16 v[84:87], a[180:183], a[116:119], v[84:87]
    buffer_load_dwordx4 a[72:75], v1, s[8:11], s34 offen offset:2048
    v_mfma_f32_16x16x32_bf16 v[88:91], a[176:179], a[104:107], v[88:91]
    v_mfma_f32_16x16x32_bf16 v[88:91], a[180:183], a[120:123], v[88:91]
    v_mfma_f32_16x16x32_bf16 v[92:95], a[176:179], a[108:111], v[92:95]
    buffer_load_dwordx4 a[76:79], v1, s[8:11], s34 offen offset:3072
    s_add_u32 s34, s34, 4096
    v_mfma_f32_16x16x32_bf16 v[92:95], a[180:183], a[124:127], v[92:95]
    s_waitcnt lgkmcnt(2)
    v_mfma_f32_16x16x32_bf16 v[204:207], a[184:187], a[108:111], v[204:207]
    ds_read_b128 a[168:171], v2 offset:39936
    v_mfma_f32_16x16x32_bf16 v[204:207], a[188:191], a[124:127], v[204:207]
    ds_read_b128 a[172:175], v2 offset:54272
    v_mfma_f32_16x16x32_bf16 v[200:203], a[184:187], a[104:107], v[200:203]
    v_mfma_f32_16x16x32_bf16 v[200:203], a[188:191], a[120:123], v[200:203]
    buffer_load_dwordx4 a[80:83], v1, s[8:11], s34 offen offset:0
    v_mfma_f32_16x16x32_bf16 v[196:199], a[184:187], a[100:103], v[196:199]
    v_mfma_f32_16x16x32_bf16 v[196:199], a[188:191], a[116:119], v[196:199]
    v_mfma_f32_16x16x32_bf16 v[192:195], a[184:187], a[96:99], v[192:195]
    v_mfma_f32_16x16x32_bf16 v[192:195], a[188:191], a[112:115], v[192:195]
    s_waitcnt lgkmcnt(2)
    v_mfma_f32_16x16x32_bf16 v[96:99], a[160:163], a[96:99], v[96:99]
    ds_read_b128 a[176:179], v2 offset:33792
    v_mfma_f32_16x16x32_bf16 v[96:99], a[164:167], a[112:115], v[96:99]
    ds_read_b128 a[180:183], v2 offset:48128
    v_mfma_f32_16x16x32_bf16 v[100:103], a[160:163], a[100:103], v[100:103]
    v_mfma_f32_16x16x32_bf16 v[100:103], a[164:167], a[116:119], v[100:103]
    buffer_load_dwordx4 a[84:87], v1, s[8:11], s34 offen offset:1024
    v_mfma_f32_16x16x32_bf16 v[104:107], a[160:163], a[104:107], v[104:107]
    v_mfma_f32_16x16x32_bf16 v[104:107], a[164:167], a[120:123], v[104:107]
    v_mfma_f32_16x16x32_bf16 v[108:111], a[160:163], a[108:111], v[108:111]
    buffer_load_dwordx4 a[88:91], v1, s[8:11], s34 offen offset:2048
    v_mfma_f32_16x16x32_bf16 v[108:111], a[164:167], a[124:127], v[108:111]
    s_waitcnt lgkmcnt(2)
    v_mfma_f32_16x16x32_bf16 v[220:223], a[168:171], a[108:111], v[220:223]
    ds_read_b128 a[184:187], v2 offset:40960
    v_mfma_f32_16x16x32_bf16 v[220:223], a[172:175], a[124:127], v[220:223]
    ds_read_b128 a[188:191], v2 offset:55296
    v_mfma_f32_16x16x32_bf16 v[216:219], a[168:171], a[104:107], v[216:219]
    v_mfma_f32_16x16x32_bf16 v[216:219], a[172:175], a[120:123], v[216:219]
    buffer_load_dwordx4 a[92:95], v1, s[8:11], s34 offen offset:3072
    s_add_u32 s34, s34, 4096
    v_mfma_f32_16x16x32_bf16 v[212:215], a[168:171], a[100:103], v[212:215]
    v_mfma_f32_16x16x32_bf16 v[212:215], a[172:175], a[116:119], v[212:215]
    v_mfma_f32_16x16x32_bf16 v[208:211], a[168:171], a[96:99], v[208:211]
    v_mfma_f32_16x16x32_bf16 v[208:211], a[172:175], a[112:115], v[208:211]
    s_waitcnt lgkmcnt(2)
    v_mfma_f32_16x16x32_bf16 v[112:115], a[176:179], a[96:99], v[112:115]
    ds_read_b128 a[160:163], v2 offset:34816
    v_mfma_f32_16x16x32_bf16 v[112:115], a[180:183], a[112:115], v[112:115]
    ds_read_b128 a[164:167], v2 offset:49152
    v_mfma_f32_16x16x32_bf16 v[116:119], a[176:179], a[100:103], v[116:119]
    v_mfma_f32_16x16x32_bf16 v[116:119], a[180:183], a[116:119], v[116:119]
    v_mfma_f32_16x16x32_bf16 v[120:123], a[176:179], a[104:107], v[120:123]
    v_mfma_f32_16x16x32_bf16 v[120:123], a[180:183], a[120:123], v[120:123]
    v_mfma_f32_16x16x32_bf16 v[124:127], a[176:179], a[108:111], v[124:127]
    v_mfma_f32_16x16x32_bf16 v[124:127], a[180:183], a[124:127], v[124:127]
    s_waitcnt lgkmcnt(2)
    v_mfma_f32_16x16x32_bf16 v[236:239], a[184:187], a[108:111], v[236:239]
    ds_read_b128 a[168:171], v2 offset:41984
    v_mfma_f32_16x16x32_bf16 v[236:239], a[188:191], a[124:127], v[236:239]
    ds_read_b128 a[172:175], v2 offset:56320
    v_mfma_f32_16x16x32_bf16 v[232:235], a[184:187], a[104:107], v[232:235]
    v_mfma_f32_16x16x32_bf16 v[232:235], a[188:191], a[120:123], v[232:235]
    v_mfma_f32_16x16x32_bf16 v[228:231], a[184:187], a[100:103], v[228:231]
    v_mfma_f32_16x16x32_bf16 v[228:231], a[188:191], a[116:119], v[228:231]
    v_mfma_f32_16x16x32_bf16 v[224:227], a[184:187], a[96:99], v[224:227]
    v_mfma_f32_16x16x32_bf16 v[224:227], a[188:191], a[112:115], v[224:227]
    s_waitcnt vmcnt(45) lgkmcnt(0)
    s_barrier
    v_mfma_f32_16x16x32_bf16 v[128:131], a[160:163], a[96:99], v[128:131]
    ds_read_b128 a[176:179], v3 offset:0
    v_mfma_f32_16x16x32_bf16 v[128:131], a[164:167], a[112:115], v[128:131]
    ds_read_b128 a[180:183], v3 offset:14336
    v_mfma_f32_16x16x32_bf16 v[132:135], a[160:163], a[100:103], v[132:135]
    s_add_u32 m0, s36, 86016
    v_mfma_f32_16x16x32_bf16 v[132:135], a[164:167], a[116:119], v[132:135]
    buffer_load_dwordx4 v1, s[12:15], s35 offen offset:0 lds
    v_mfma_f32_16x16x32_bf16 v[136:139], a[160:163], a[104:107], v[136:139]
    v_mfma_f32_16x16x32_bf16 v[136:139], a[164:167], a[120:123], v[136:139]
    v_mfma_f32_16x16x32_bf16 v[140:143], a[160:163], a[108:111], v[140:143]
    buffer_load_dwordx4 v1, s[12:15], s35 offen offset:1024 lds
    v_mfma_f32_16x16x32_bf16 v[140:143], a[164:167], a[124:127], v[140:143]
    v_mfma_f32_16x16x32_bf16 v[252:255], a[168:171], a[108:111], v[252:255]
    ds_read_b128 a[184:187], v3 offset:7168
    v_mfma_f32_16x16x32_bf16 v[252:255], a[172:175], a[124:127], v[252:255]
    ds_read_b128 a[188:191], v3 offset:21504
    v_mfma_f32_16x16x32_bf16 v[248:251], a[168:171], a[104:107], v[248:251]
    v_mfma_f32_16x16x32_bf16 v[248:251], a[172:175], a[120:123], v[248:251]
    buffer_load_dwordx4 v1, s[12:15], s35 offen offset:2048 lds
    v_mfma_f32_16x16x32_bf16 v[244:247], a[168:171], a[100:103], v[244:247]
    v_mfma_f32_16x16x32_bf16 v[244:247], a[172:175], a[116:119], v[244:247]
    v_mfma_f32_16x16x32_bf16 v[240:243], a[168:171], a[96:99], v[240:243]
    buffer_load_dwordx4 v1, s[12:15], s35 offen offset:3072 lds
    s_add_u32 s35, s35, 4096
    v_mfma_f32_16x16x32_bf16 v[240:243], a[172:175], a[112:115], v[240:243]
    s_waitcnt lgkmcnt(2)
    v_mfma_f32_16x16x32_bf16 v[32:35], a[176:179], a[128:131], v[32:35]
    ds_read_b128 a[160:163], v3 offset:1024
    v_mfma_f32_16x16x32_bf16 v[32:35], a[180:183], a[144:147], v[32:35]
    ds_read_b128 a[164:167], v3 offset:15360
    v_mfma_f32_16x16x32_bf16 v[36:39], a[176:179], a[132:135], v[36:39]
    s_add_u32 m0, s36, 90112
    v_mfma_f32_16x16x32_bf16 v[36:39], a[180:183], a[148:151], v[36:39]
    buffer_load_dwordx4 v1, s[12:15], s35 offen offset:0 lds
    v_mfma_f32_16x16x32_bf16 v[40:43], a[176:179], a[136:139], v[40:43]
    v_mfma_f32_16x16x32_bf16 v[40:43], a[180:183], a[152:155], v[40:43]
    v_mfma_f32_16x16x32_bf16 v[44:47], a[176:179], a[140:143], v[44:47]
    buffer_load_dwordx4 v1, s[12:15], s35 offen offset:1024 lds
    v_mfma_f32_16x16x32_bf16 v[44:47], a[180:183], a[156:159], v[44:47]
    s_waitcnt lgkmcnt(2)
    v_mfma_f32_16x16x32_bf16 v[156:159], a[184:187], a[140:143], v[156:159]
    ds_read_b128 a[168:171], v3 offset:8192
    v_mfma_f32_16x16x32_bf16 v[156:159], a[188:191], a[156:159], v[156:159]
    ds_read_b128 a[172:175], v3 offset:22528
    v_mfma_f32_16x16x32_bf16 v[152:155], a[184:187], a[136:139], v[152:155]
    v_mfma_f32_16x16x32_bf16 v[152:155], a[188:191], a[152:155], v[152:155]
    buffer_load_dwordx4 v1, s[12:15], s35 offen offset:2048 lds
    s_add_u32 s35, s35, 24576
    v_mfma_f32_16x16x32_bf16 v[148:151], a[184:187], a[132:135], v[148:151]
    v_mfma_f32_16x16x32_bf16 v[148:151], a[188:191], a[148:151], v[148:151]
    v_mfma_f32_16x16x32_bf16 v[144:147], a[184:187], a[128:131], v[144:147]
    buffer_load_dwordx4 a[96:99], v1, s[8:11], s34 offen offset:0
    v_mfma_f32_16x16x32_bf16 v[144:147], a[188:191], a[144:147], v[144:147]
    s_waitcnt lgkmcnt(2)
    v_mfma_f32_16x16x32_bf16 v[48:51], a[160:163], a[128:131], v[48:51]
    ds_read_b128 a[176:179], v3 offset:2048
    s_mov_b32 s22, 4194304
    v_mfma_f32_16x16x32_bf16 v[48:51], a[164:167], a[144:147], v[48:51]
    ds_read_b128 a[180:183], v3 offset:16384
    s_mov_b32 s23, 0x00020000
    v_mfma_f32_16x16x32_bf16 v[52:55], a[160:163], a[132:135], v[52:55]
    s_bfe_u32 s45, s2, 0x20003
    s_and_b32 s32, s2, 1
    v_mfma_f32_16x16x32_bf16 v[52:55], a[164:167], a[148:151], v[52:55]
    buffer_load_dwordx4 a[100:103], v1, s[8:11], s34 offen offset:1024
    s_lshl_b32 s32, s32, 2
    v_mfma_f32_16x16x32_bf16 v[56:59], a[160:163], a[136:139], v[56:59]
    s_add_u32 s45, s45, s32
    s_lshr_b32 s44, s2, 5
    v_mfma_f32_16x16x32_bf16 v[56:59], a[164:167], a[152:155], v[56:59]
    s_and_b32 s32, s2, 4
    s_lshl_b32 s32, s32, 1
    v_mfma_f32_16x16x32_bf16 v[60:63], a[160:163], a[140:143], v[60:63]
    buffer_load_dwordx4 a[104:107], v1, s[8:11], s34 offen offset:2048
    s_add_u32 s44, s44, s32
    v_mfma_f32_16x16x32_bf16 v[60:63], a[164:167], a[156:159], v[60:63]
    s_waitcnt lgkmcnt(2)
    s_lshr_b32 s55, s44, 1
    v_mfma_f32_16x16x32_bf16 v[172:175], a[168:171], a[140:143], v[172:175]
    ds_read_b128 a[184:187], v3 offset:9216
    s_lshl_b32 s55, s55, 10
    v_mfma_f32_16x16x32_bf16 v[172:175], a[172:175], a[156:159], v[172:175]
    ds_read_b128 a[188:191], v3 offset:23552
    s_add_u32 s55, s55, 56688640
    v_mfma_f32_16x16x32_bf16 v[168:171], a[168:171], a[136:139], v[168:171]
    s_lshl_b32 s54, s29, 10
    s_add_u32 s54, s54, 56688640
    v_mfma_f32_16x16x32_bf16 v[168:171], a[172:175], a[152:155], v[168:171]
    buffer_load_dwordx4 a[108:111], v1, s[8:11], s34 offen offset:3072
    s_add_u32 s34, s34, 4096
    v_mfma_f32_16x16x32_bf16 v[164:167], a[168:171], a[132:135], v[164:167]
    s_cmp_eq_u32 s28, 0
    s_cselect_b32 s54, s54, 1073741824
    s_cselect_b32 s55, s55, 1073741824
    s_cselect_b32 s70, 16, 0
    s_lshl_b32 s71, s70, 1
    v_mfma_f32_16x16x32_bf16 v[164:167], a[172:175], a[148:151], v[164:167]
    s_lshl_b32 s44, s44, 1
    s_bfe_u32 s32, s2, 0x10001
    v_mfma_f32_16x16x32_bf16 v[160:163], a[168:171], a[128:131], v[160:163]
    buffer_load_dwordx4 a[112:115], v1, s[8:11], s34 offen offset:0
    s_add_u32 s44, s44, s32
    v_mfma_f32_16x16x32_bf16 v[160:163], a[172:175], a[144:147], v[160:163]
    s_waitcnt lgkmcnt(2)
    s_lshl_b32 s57, s32, 7
    v_mfma_f32_16x16x32_bf16 v[64:67], a[176:179], a[128:131], v[64:67]
    ds_read_b128 a[160:163], v3 offset:3072
    s_add_u32 s57, s57, s55
    v_mfma_f32_16x16x32_bf16 v[64:67], a[180:183], a[144:147], v[64:67]
    ds_read_b128 a[164:167], v3 offset:17408
    s_lshr_b32 s56, s30, 4
    v_mfma_f32_16x16x32_bf16 v[68:71], a[176:179], a[132:135], v[68:71]
    s_lshl_b32 s56, s56, 7
    s_add_u32 s56, s56, s54
    v_mfma_f32_16x16x32_bf16 v[68:71], a[180:183], a[148:151], v[68:71]
    buffer_load_dwordx4 a[116:119], v1, s[8:11], s34 offen offset:1024
    s_lshl_b32 s49, s28, 11
    v_mfma_f32_16x16x32_bf16 v[72:75], a[176:179], a[136:139], v[72:75]
    s_lshl_b32 s50, s28, 12
    s_mul_i32 s58, s32, -180224
    v_mfma_f32_16x16x32_bf16 v[72:75], a[180:183], a[152:155], v[72:75]
    s_add_u32 s58, s58, 196608
    s_mul_i32 s32, s32, 196608
    v_mfma_f32_16x16x32_bf16 v[76:79], a[176:179], a[140:143], v[76:79]
    buffer_load_dwordx4 a[120:123], v1, s[8:11], s34 offen offset:2048
    s_add_u32 s32, s32, s49
    v_mfma_f32_16x16x32_bf16 v[76:79], a[180:183], a[156:159], v[76:79]
    s_waitcnt lgkmcnt(2)
    s_mul_i32 s48, s45, 458752
    v_mfma_f32_16x16x32_bf16 v[188:191], a[184:187], a[140:143], v[188:191]
    ds_read_b128 a[168:171], v3 offset:10240
    s_add_u32 s48, s48, s32
    v_mfma_f32_16x16x32_bf16 v[188:191], a[188:191], a[156:159], v[188:191]
    ds_read_b128 a[172:175], v3 offset:24576
    s_lshl_b32 s48, s48, 1
    v_mfma_f32_16x16x32_bf16 v[184:187], a[184:187], a[136:139], v[184:187]
    s_add_u32 s48, s48, 46137344
    s_add_u32 s32, s32, 13631488
    v_mfma_f32_16x16x32_bf16 v[184:187], a[188:191], a[152:155], v[184:187]
    buffer_load_dwordx4 a[124:127], v1, s[8:11], s34 offen offset:3072
    s_add_u32 s34, s34, 4096
    v_mfma_f32_16x16x32_bf16 v[180:183], a[184:187], a[132:135], v[180:183]
    s_mul_i32 s46, s44, 458752
    s_add_u32 s46, s46, s32
    v_mfma_f32_16x16x32_bf16 v[180:183], a[188:191], a[148:151], v[180:183]
    s_xor_b32 s47, s44, 1
    s_mul_i32 s47, s47, 458752
    v_mfma_f32_16x16x32_bf16 v[176:179], a[184:187], a[128:131], v[176:179]
    s_add_u32 s47, s47, s32
    s_and_b32 s32, s45, 3
    v_mfma_f32_16x16x32_bf16 v[176:179], a[188:191], a[144:147], v[176:179]
    s_waitcnt lgkmcnt(2)
    s_lshl_b32 s32, s32, 13
    v_mfma_f32_16x16x32_bf16 v[80:83], a[160:163], a[128:131], v[80:83]
    ds_read_b128 a[176:179], v3 offset:4096
    s_add_u32 s46, s46, s32
    v_mfma_f32_16x16x32_bf16 v[80:83], a[164:167], a[144:147], v[80:83]
    ds_read_b128 a[180:183], v3 offset:18432
    s_add_u32 s47, s47, s32
    v_mfma_f32_16x16x32_bf16 v[84:87], a[160:163], a[132:135], v[84:87]
    s_add_u32 s48, s48, s32
    s_add_u32 s48, s48, s32
    v_mfma_f32_16x16x32_bf16 v[84:87], a[164:167], a[148:151], v[84:87]
    s_sub_u32 s58, s58, s32
    s_xor_b32 s62, s32, 8192
    v_mfma_f32_16x16x32_bf16 v[88:91], a[160:163], a[136:139], v[88:91]
    s_xor_b32 s33, s32, 0
    s_sub_u32 s62, s62, s33
    v_mfma_f32_16x16x32_bf16 v[88:91], a[164:167], a[152:155], v[88:91]
    s_lshl_b32 s66, s62, 1
    s_xor_b32 s63, s32, 16384
    v_mfma_f32_16x16x32_bf16 v[92:95], a[160:163], a[140:143], v[92:95]
    s_xor_b32 s33, s32, 8192
    s_sub_u32 s63, s63, s33
    v_mfma_f32_16x16x32_bf16 v[92:95], a[164:167], a[156:159], v[92:95]
    s_waitcnt lgkmcnt(2)
    s_lshl_b32 s67, s63, 1
    v_mfma_f32_16x16x32_bf16 v[204:207], a[168:171], a[140:143], v[204:207]
    ds_read_b128 a[184:187], v3 offset:11264
    s_xor_b32 s64, s32, 24576
    v_mfma_f32_16x16x32_bf16 v[204:207], a[172:175], a[156:159], v[204:207]
    ds_read_b128 a[188:191], v3 offset:25600
    s_xor_b32 s33, s32, 16384
    v_mfma_f32_16x16x32_bf16 v[200:203], a[168:171], a[136:139], v[200:203]
    s_sub_u32 s64, s64, s33
    s_lshl_b32 s68, s64, 1
    v_mfma_f32_16x16x32_bf16 v[200:203], a[172:175], a[152:155], v[200:203]
    s_xor_b32 s65, s32, 32768
    s_xor_b32 s33, s32, 24576
    v_mfma_f32_16x16x32_bf16 v[196:199], a[168:171], a[132:135], v[196:199]
    s_sub_u32 s65, s65, s33
    s_lshl_b32 s69, s65, 1
    v_mfma_f32_16x16x32_bf16 v[196:199], a[172:175], a[148:151], v[196:199]
    s_lshr_b32 s32, s28, 1
    s_lshl_b32 s33, s45, 1
    v_mfma_f32_16x16x32_bf16 v[192:195], a[168:171], a[128:131], v[192:195]
    s_add_u32 s33, s33, s32
    s_lshl_b32 s32, s32, 12
    v_mfma_f32_16x16x32_bf16 v[192:195], a[172:175], a[144:147], v[192:195]
    s_waitcnt lgkmcnt(2)
    s_add_u32 s32, s32, 16384
    v_mfma_f32_16x16x32_bf16 v[96:99], a[176:179], a[128:131], v[96:99]
    ds_read_b128 a[160:163], v3 offset:5120
    v_add_u32 v24, s32, v1
    v_mfma_f32_16x16x32_bf16 v[96:99], a[180:183], a[144:147], v[96:99]
    ds_read_b128 a[164:167], v3 offset:19456
    v_add_u32 v25, 0x10000, v24
    v_mfma_f32_16x16x32_bf16 v[100:103], a[176:179], a[132:135], v[100:103]
    v_add_u32 v26, 0x20000, v24
    s_and_b32 s32, s28, 1
    v_mfma_f32_16x16x32_bf16 v[100:103], a[180:183], a[148:151], v[100:103]
    s_lshl_b32 s32, s32, 11
    v_add_u32 v20, s32, v1
    v_mfma_f32_16x16x32_bf16 v[104:107], a[176:179], a[136:139], v[104:107]
    v_add_u32 v21, 0x10000, v20
    v_add_u32 v22, 0x20000, v20
    v_mfma_f32_16x16x32_bf16 v[104:107], a[180:183], a[152:155], v[104:107]
    s_lshl_b32 s51, s33, 13
    s_add_u32 s51, s51, s32
    v_mfma_f32_16x16x32_bf16 v[108:111], a[176:179], a[140:143], v[108:111]
    s_lshl_b32 s52, s44, 17
    s_add_u32 s51, s51, s52
    v_mfma_f32_16x16x32_bf16 v[108:111], a[180:183], a[156:159], v[108:111]
    s_waitcnt lgkmcnt(2)
    s_lshl_b32 s32, s32, 5
    v_mfma_f32_16x16x32_bf16 v[220:223], a[184:187], a[140:143], v[220:223]
    ds_read_b128 a[168:171], v3 offset:12288
    s_add_u32 s32, s32, s52
    v_mfma_f32_16x16x32_bf16 v[220:223], a[188:191], a[156:159], v[220:223]
    ds_read_b128 a[172:175], v3 offset:26624
    s_lshl_b32 s33, s33, 7
    v_mfma_f32_16x16x32_bf16 v[216:219], a[184:187], a[136:139], v[216:219]
    s_add_u32 s32, s32, s33
    v_and_b32 v29, 0xf0, v1
    s_branch L_isl10_over
.p2align 12
L_isl10:
    s_setpc_b64 s[14:15]
L_isl10_over:
    v_mfma_f32_16x16x32_bf16 v[216:219], a[188:191], a[152:155], v[216:219]
    v_lshlrev_b32 v29, 7, v29
    v_lshrrev_b32 v30, 8, v1
    v_mfma_f32_16x16x32_bf16 v[212:215], a[184:187], a[132:135], v[212:215]
    v_lshl_add_u32 v29, v30, 4, v29
    v_add_u32 v23, s32, v29
    v_mfma_f32_16x16x32_bf16 v[212:215], a[188:191], a[148:151], v[212:215]
    v_mov_b32 v28, 1
    s_add_u32 s52, s51, 9437184
    v_mfma_f32_16x16x32_bf16 v[208:211], a[184:187], a[128:131], v[208:211]
    s_add_u32 s53, s51, 9441280
    v_add_u32 v4, 4096, v1
    v_mfma_f32_16x16x32_bf16 v[208:211], a[188:191], a[144:147], v[208:211]
    s_waitcnt lgkmcnt(2)
    v_add_u32 v6, 8192, v1
    v_mfma_f32_16x16x32_bf16 v[112:115], a[160:163], a[128:131], v[112:115]
    ds_read_b128 a[176:179], v3 offset:6144
    s_and_b32 s32, s49, 4096
    v_mfma_f32_16x16x32_bf16 v[112:115], a[164:167], a[144:147], v[112:115]
    ds_read_b128 a[180:183], v3 offset:20480
    s_sub_u32 s33, s50, s32
    v_mfma_f32_16x16x32_bf16 v[116:119], a[160:163], a[132:135], v[116:119]
    s_sub_u32 s72, s46, s32
    s_sub_u32 s73, s47, s32
    v_mfma_f32_16x16x32_bf16 v[116:119], a[164:167], a[148:151], v[116:119]
    s_sub_u32 s74, s48, s33
    s_add_u32 s46, s46, s62
    v_mfma_f32_16x16x32_bf16 v[120:123], a[160:163], a[136:139], v[120:123]
    s_add_u32 s47, s47, s62
    s_add_u32 s48, s48, s66
    v_mfma_f32_16x16x32_bf16 v[120:123], a[164:167], a[152:155], v[120:123]
    s_sub_u32 s75, s46, s32
    s_sub_u32 s76, s47, s32
    v_mfma_f32_16x16x32_bf16 v[124:127], a[160:163], a[140:143], v[124:127]
    s_sub_u32 s77, s48, s33
    s_add_u32 s46, s46, s63
    v_mfma_f32_16x16x32_bf16 v[124:127], a[164:167], a[156:159], v[124:127]
    s_waitcnt lgkmcnt(2)
    s_add_u32 s47, s47, s63
    v_mfma_f32_16x16x32_bf16 v[236:239], a[168:171], a[140:143], v[236:239]
    ds_read_b128 a[184:187], v3 offset:13312
    s_add_u32 s48, s48, s67
    v_mfma_f32_16x16x32_bf16 v[236:239], a[172:175], a[156:159], v[236:239]
    ds_read_b128 a[188:191], v3 offset:27648
    s_lshr_b32 s32, s2, 5
    v_mfma_f32_16x16x32_bf16 v[232:235], a[168:171], a[136:139], v[232:235]
    s_add_u32 s32, s32, 2
    s_lshl_b32 s32, s32, 14
    v_mfma_f32_16x16x32_bf16 v[232:235], a[172:175], a[152:155], v[232:235]
    s_add_u32 s32, s32, s48
    v_lshlrev_b32 v29, 2, v1
    v_mfma_f32_16x16x32_bf16 v[228:231], a[168:171], a[132:135], v[228:231]
    v_mfma_f32_16x16x32_bf16 v[228:231], a[172:175], a[148:151], v[228:231]
    v_mfma_f32_16x16x32_bf16 v[224:227], a[168:171], a[128:131], v[224:227]
    v_mfma_f32_16x16x32_bf16 v[224:227], a[172:175], a[144:147], v[224:227]
    s_waitcnt vmcnt(45) lgkmcnt(0)
    s_barrier
    v_mfma_f32_16x16x32_bf16 v[128:131], a[176:179], a[128:131], v[128:131]
    ds_read_b128 a[160:163], v1 offset:0
    v_mfma_f32_16x16x32_bf16 v[128:131], a[180:183], a[144:147], v[128:131]
    ds_read_b128 a[164:167], v1 offset:14336
    v_mfma_f32_16x16x32_bf16 v[132:135], a[176:179], a[132:135], v[132:135]
    v_mfma_f32_16x16x32_bf16 v[132:135], a[180:183], a[148:151], v[132:135]
    v_mfma_f32_16x16x32_bf16 v[136:139], a[176:179], a[136:139], v[136:139]
    v_mfma_f32_16x16x32_bf16 v[136:139], a[180:183], a[152:155], v[136:139]
    v_mfma_f32_16x16x32_bf16 v[140:143], a[176:179], a[140:143], v[140:143]
    v_mfma_f32_16x16x32_bf16 v[140:143], a[180:183], a[156:159], v[140:143]
    v_mfma_f32_16x16x32_bf16 v[252:255], a[184:187], a[140:143], v[252:255]
    ds_read_b128 a[168:171], v1 offset:7168
    v_mfma_f32_16x16x32_bf16 v[252:255], a[188:191], a[156:159], v[252:255]
    ds_read_b128 a[172:175], v1 offset:21504
    v_mfma_f32_16x16x32_bf16 v[248:251], a[184:187], a[136:139], v[248:251]
    v_mfma_f32_16x16x32_bf16 v[248:251], a[188:191], a[152:155], v[248:251]
    v_mfma_f32_16x16x32_bf16 v[244:247], a[184:187], a[132:135], v[244:247]
    v_mfma_f32_16x16x32_bf16 v[244:247], a[188:191], a[148:151], v[244:247]
    v_mfma_f32_16x16x32_bf16 v[240:243], a[184:187], a[128:131], v[240:243]
    v_mfma_f32_16x16x32_bf16 v[240:243], a[188:191], a[144:147], v[240:243]
    s_waitcnt vmcnt(30) lgkmcnt(0)
    s_barrier
    v_mfma_f32_16x16x32_bf16 v[32:35], a[160:163], a[0:3], v[32:35]
    ds_read_b128 a[176:179], v1 offset:28672
    v_mfma_f32_16x16x32_bf16 v[32:35], a[164:167], a[16:19], v[32:35]
    ds_read_b128 a[180:183], v1 offset:43008
    v_mfma_f32_16x16x32_bf16 v[36:39], a[160:163], a[4:7], v[36:39]
    v_mfma_f32_16x16x32_bf16 v[36:39], a[164:167], a[20:23], v[36:39]
    v_mfma_f32_16x16x32_bf16 v[40:43], a[160:163], a[8:11], v[40:43]
    v_mfma_f32_16x16x32_bf16 v[40:43], a[164:167], a[24:27], v[40:43]
    v_mfma_f32_16x16x32_bf16 v[44:47], a[160:163], a[12:15], v[44:47]
    v_mfma_f32_16x16x32_bf16 v[44:47], a[164:167], a[28:31], v[44:47]
    v_mfma_f32_16x16x32_bf16 v[156:159], a[168:171], a[12:15], v[156:159]
    ds_read_b128 a[184:187], v1 offset:35840
    v_mfma_f32_16x16x32_bf16 v[156:159], a[172:175], a[28:31], v[156:159]
    ds_read_b128 a[188:191], v1 offset:50176
    v_mfma_f32_16x16x32_bf16 v[152:155], a[168:171], a[8:11], v[152:155]
    v_mfma_f32_16x16x32_bf16 v[152:155], a[172:175], a[24:27], v[152:155]
    v_mfma_f32_16x16x32_bf16 v[148:151], a[168:171], a[4:7], v[148:151]
    v_mfma_f32_16x16x32_bf16 v[148:151], a[172:175], a[20:23], v[148:151]
    v_mfma_f32_16x16x32_bf16 v[144:147], a[168:171], a[0:3], v[144:147]
    v_mfma_f32_16x16x32_bf16 v[144:147], a[172:175], a[16:19], v[144:147]
    s_waitcnt vmcnt(15) lgkmcnt(0)
    s_barrier
    v_mfma_f32_16x16x32_bf16 v[32:35], a[176:179], a[32:35], v[32:35]
    ds_read_b128 a[160:163], v2 offset:0
    v_mfma_f32_16x16x32_bf16 v[32:35], a[180:183], a[48:51], v[32:35]
    ds_read_b128 a[164:167], v2 offset:14336
    v_mfma_f32_16x16x32_bf16 v[36:39], a[176:179], a[36:39], v[36:39]
    s_add_u32 m0, s50, 147456
    v_mfma_f32_16x16x32_bf16 v[36:39], a[180:183], a[52:55], v[36:39]
    buffer_load_dwordx4 v1, s[4:7], s48 offen offset:0 lds
    v_mfma_f32_16x16x32_bf16 v[40:43], a[176:179], a[40:43], v[40:43]
    v_mfma_f32_16x16x32_bf16 v[40:43], a[180:183], a[56:59], v[40:43]
    v_mfma_f32_16x16x32_bf16 v[44:47], a[176:179], a[44:47], v[44:47]
    buffer_load_dwordx4 v1, s[4:7], s48 offen offset:1024 lds
    v_mfma_f32_16x16x32_bf16 v[44:47], a[180:183], a[60:63], v[44:47]
    v_mfma_f32_16x16x32_bf16 v[156:159], a[184:187], a[44:47], v[156:159]
    ds_read_b128 a[168:171], v2 offset:7168
    v_mfma_f32_16x16x32_bf16 v[156:159], a[188:191], a[60:63], v[156:159]
    ds_read_b128 a[172:175], v2 offset:21504
    v_mfma_f32_16x16x32_bf16 v[152:155], a[184:187], a[40:43], v[152:155]
    v_mfma_f32_16x16x32_bf16 v[152:155], a[188:191], a[56:59], v[152:155]
    buffer_load_dwordx4 v1, s[4:7], s48 offen offset:2048 lds
    v_mfma_f32_16x16x32_bf16 v[148:151], a[184:187], a[36:39], v[148:151]
    v_mfma_f32_16x16x32_bf16 v[148:151], a[188:191], a[52:55], v[148:151]
    v_mfma_f32_16x16x32_bf16 v[144:147], a[184:187], a[32:35], v[144:147]
    buffer_load_dwordx4 v1, s[4:7], s48 offen offset:3072 lds
    s_add_u32 s48, s48, s68
    v_mfma_f32_16x16x32_bf16 v[144:147], a[188:191], a[48:51], v[144:147]
    s_waitcnt vmcnt(4) lgkmcnt(0)
    s_barrier
    v_mfma_f32_16x16x32_bf16 v[32:35], a[160:163], a[64:67], v[32:35]
    ds_read_b128 a[176:179], v2 offset:28672
    v_mfma_f32_16x16x32_bf16 v[32:35], a[164:167], a[80:83], v[32:35]
    ds_read_b128 a[180:183], v2 offset:43008
    v_mfma_f32_16x16x32_bf16 v[36:39], a[160:163], a[68:71], v[36:39]
    s_add_u32 m0, s50, 114688
    v_mfma_f32_16x16x32_bf16 v[36:39], a[164:167], a[84:87], v[36:39]
    buffer_load_dwordx4 v1, s[4:7], s48 offen offset:0 lds
    v_mfma_f32_16x16x32_bf16 v[40:43], a[160:163], a[72:75], v[40:43]
    v_mfma_f32_16x16x32_bf16 v[40:43], a[164:167], a[88:91], v[40:43]
    v_mfma_f32_16x16x32_bf16 v[44:47], a[160:163], a[76:79], v[44:47]
    buffer_load_dwordx4 v1, s[4:7], s48 offen offset:1024 lds
    v_mfma_f32_16x16x32_bf16 v[44:47], a[164:167], a[92:95], v[44:47]
    v_mfma_f32_16x16x32_bf16 v[156:159], a[168:171], a[76:79], v[156:159]
    ds_read_b128 a[184:187], v2 offset:35840
    v_mfma_f32_16x16x32_bf16 v[156:159], a[172:175], a[92:95], v[156:159]
    ds_read_b128 a[188:191], v2 offset:50176
    v_mfma_f32_16x16x32_bf16 v[152:155], a[168:171], a[72:75], v[152:155]
    v_mfma_f32_16x16x32_bf16 v[152:155], a[172:175], a[88:91], v[152:155]
    buffer_load_dwordx4 v1, s[4:7], s48 offen offset:2048 lds
    v_mfma_f32_16x16x32_bf16 v[148:151], a[168:171], a[68:71], v[148:151]
    v_mfma_f32_16x16x32_bf16 v[148:151], a[172:175], a[84:87], v[148:151]
    v_mfma_f32_16x16x32_bf16 v[144:147], a[168:171], a[64:67], v[144:147]
    buffer_load_dwordx4 v1, s[4:7], s48 offen offset:3072 lds
    s_add_u32 s48, s48, s69
    v_mfma_f32_16x16x32_bf16 v[144:147], a[172:175], a[80:83], v[144:147]
    s_waitcnt lgkmcnt(2)
    v_mfma_f32_16x16x32_bf16 v[32:35], a[176:179], a[96:99], v[32:35]
    ds_read_b128 a[160:163], v1 offset:1024
    v_mfma_f32_16x16x32_bf16 v[32:35], a[180:183], a[112:115], v[32:35]
    ds_read_b128 a[164:167], v1 offset:15360
    v_mfma_f32_16x16x32_bf16 v[36:39], a[176:179], a[100:103], v[36:39]
    v_mfma_f32_16x16x32_bf16 v[36:39], a[180:183], a[116:119], v[36:39]
    buffer_load_dwordx4 a[128:131], v1, s[4:7], s52 offen offset:0
    v_mfma_f32_16x16x32_bf16 v[40:43], a[176:179], a[104:107], v[40:43]
    v_mfma_f32_16x16x32_bf16 v[40:43], a[180:183], a[120:123], v[40:43]
    v_mfma_f32_16x16x32_bf16 v[44:47], a[176:179], a[108:111], v[44:47]
    buffer_load_dwordx4 a[132:135], v1, s[4:7], s53 offen offset:0
    v_mfma_f32_16x16x32_bf16 v[44:47], a[180:183], a[124:127], v[44:47]
    s_waitcnt lgkmcnt(2)
    v_mfma_f32_16x16x32_bf16 v[156:159], a[184:187], a[108:111], v[156:159]
    ds_read_b128 a[168:171], v1 offset:8192
    v_mfma_f32_16x16x32_bf16 v[156:159], a[188:191], a[124:127], v[156:159]
    ds_read_b128 a[172:175], v1 offset:22528
    v_mfma_f32_16x16x32_bf16 v[152:155], a[184:187], a[104:107], v[152:155]
    v_mfma_f32_16x16x32_bf16 v[152:155], a[188:191], a[120:123], v[152:155]
    buffer_load_dwordx4 a[136:139], v1, s[4:7], s52 offen offset:1024
    v_mfma_f32_16x16x32_bf16 v[148:151], a[184:187], a[100:103], v[148:151]
    v_mfma_f32_16x16x32_bf16 v[148:151], a[188:191], a[116:119], v[148:151]
    v_mfma_f32_16x16x32_bf16 v[144:147], a[184:187], a[96:99], v[144:147]
    buffer_load_dwordx4 a[140:143], v1, s[4:7], s53 offen offset:1024
    v_mfma_f32_16x16x32_bf16 v[144:147], a[188:191], a[112:115], v[144:147]
    s_waitcnt lgkmcnt(2)
    v_mfma_f32_16x16x32_bf16 v[48:51], a[160:163], a[0:3], v[48:51]
    ds_read_b128 a[176:179], v1 offset:29696
    v_mul_f32 v32, v8, v32
    v_mul_f32 v33, v8, v33
    v_mfma_f32_16x16x32_bf16 v[48:51], a[164:167], a[16:19], v[48:51]
    ds_read_b128 a[180:183], v1 offset:44032
    v_mul_f32 v34, v8, v34
    v_mfma_f32_16x16x32_bf16 v[52:55], a[160:163], a[4:7], v[52:55]
    v_mul_f32 v35, v8, v35
    v_exp_f32 v32, v32
    v_mfma_f32_16x16x32_bf16 v[52:55], a[164:167], a[20:23], v[52:55]
    v_exp_f32 v33, v33
    v_mfma_f32_16x16x32_bf16 v[56:59], a[160:163], a[8:11], v[56:59]
    v_exp_f32 v34, v34
    v_mfma_f32_16x16x32_bf16 v[56:59], a[164:167], a[24:27], v[56:59]
    buffer_load_dwordx4 a[208:211], v1, s[4:7], s74 offen offset:0
    v_exp_f32 v35, v35
    v_mfma_f32_16x16x32_bf16 v[60:63], a[160:163], a[12:15], v[60:63]
    v_fma_f32 v32, v32, v16, v16
    v_fma_f32 v33, v33, v16, v16
    v_fma_f32 v34, v34, v16, v16
    v_mfma_f32_16x16x32_bf16 v[60:63], a[164:167], a[28:31], v[60:63]
    s_waitcnt lgkmcnt(2)
    v_fma_f32 v35, v35, v16, v16
    v_mfma_f32_16x16x32_bf16 v[172:175], a[168:171], a[12:15], v[172:175]
    ds_read_b128 a[184:187], v1 offset:36864
    v_rcp_f32 v32, v32
    v_mfma_f32_16x16x32_bf16 v[172:175], a[172:175], a[28:31], v[172:175]
    ds_read_b128 a[188:191], v1 offset:51200
    v_mfma_f32_16x16x32_bf16 v[168:171], a[168:171], a[8:11], v[168:171]
    v_rcp_f32 v33, v33
    v_rcp_f32 v34, v34
    v_mfma_f32_16x16x32_bf16 v[168:171], a[172:175], a[24:27], v[168:171]
    buffer_load_dword v30, v29, s[4:7], s32 offen
    s_add_u32 s32, s32, 131072
    v_mfma_f32_16x16x32_bf16 v[164:167], a[168:171], a[4:7], v[164:167]
    v_rcp_f32 v35, v35
    v_mul_f32 v144, v144, v32
    v_mfma_f32_16x16x32_bf16 v[164:167], a[172:175], a[20:23], v[164:167]
    buffer_load_dwordx4 a[212:215], v1, s[4:7], s74 offen offset:1024
    v_mul_f32 v145, v145, v33
    v_mul_f32 v146, v146, v34
    v_mfma_f32_16x16x32_bf16 v[160:163], a[168:171], a[0:3], v[160:163]
    v_mul_f32 v147, v147, v35
    v_cvt_pk_bf16_f32 v32, v144, v145
    v_mfma_f32_16x16x32_bf16 v[160:163], a[172:175], a[16:19], v[160:163]
    s_waitcnt lgkmcnt(2)
    v_cvt_pk_bf16_f32 v33, v146, v147
    v_mul_f32 v36, v10, v36
    v_mfma_f32_16x16x32_bf16 v[48:51], a[176:179], a[32:35], v[48:51]
    ds_read_b128 a[160:163], v2 offset:1024
    v_mul_f32 v37, v10, v37
    v_mfma_f32_16x16x32_bf16 v[48:51], a[180:183], a[48:51], v[48:51]
    ds_read_b128 a[164:167], v2 offset:15360
    v_mul_f32 v38, v10, v38
    v_mul_f32 v39, v10, v39
    v_mfma_f32_16x16x32_bf16 v[52:55], a[176:179], a[36:39], v[52:55]
    v_exp_f32 v36, v36
    v_mfma_f32_16x16x32_bf16 v[52:55], a[180:183], a[52:55], v[52:55]
    v_exp_f32 v37, v37
    v_mfma_f32_16x16x32_bf16 v[56:59], a[176:179], a[40:43], v[56:59]
    v_exp_f32 v38, v38
    v_mfma_f32_16x16x32_bf16 v[56:59], a[180:183], a[56:59], v[56:59]
    buffer_load_dwordx4 a[216:219], v1, s[4:7], s74 offen offset:2048
    v_exp_f32 v39, v39
    v_fma_f32 v36, v36, v17, v17
    v_mfma_f32_16x16x32_bf16 v[60:63], a[176:179], a[44:47], v[60:63]
    v_fma_f32 v37, v37, v17, v17
    v_fma_f32 v38, v38, v17, v17
    v_fma_f32 v39, v39, v17, v17
    v_mfma_f32_16x16x32_bf16 v[60:63], a[180:183], a[60:63], v[60:63]
    s_waitcnt lgkmcnt(2)
    v_mfma_f32_16x16x32_bf16 v[172:175], a[184:187], a[44:47], v[172:175]
    ds_read_b128 a[168:171], v2 offset:8192
    v_rcp_f32 v36, v36
    v_mfma_f32_16x16x32_bf16 v[172:175], a[188:191], a[60:63], v[172:175]
    ds_read_b128 a[172:175], v2 offset:22528
    v_rcp_f32 v37, v37
    v_mfma_f32_16x16x32_bf16 v[168:171], a[184:187], a[40:43], v[168:171]
    v_rcp_f32 v38, v38
    v_mfma_f32_16x16x32_bf16 v[168:171], a[188:191], a[56:59], v[168:171]
    v_rcp_f32 v39, v39
    v_mul_f32 v148, v148, v36
    v_mfma_f32_16x16x32_bf16 v[164:167], a[184:187], a[36:39], v[164:167]
    v_mul_f32 v149, v149, v37
    v_mul_f32 v150, v150, v38
    v_mul_f32 v151, v151, v39
    v_mfma_f32_16x16x32_bf16 v[164:167], a[188:191], a[52:55], v[164:167]
    buffer_load_dwordx4 a[220:223], v1, s[4:7], s74 offen offset:3072
    v_cvt_pk_bf16_f32 v34, v148, v149
    v_mfma_f32_16x16x32_bf16 v[160:163], a[184:187], a[32:35], v[160:163]
    v_cvt_pk_bf16_f32 v35, v150, v151
    v_nop
    v_permlane16_swap_b32 v32, v34
    v_mfma_f32_16x16x32_bf16 v[160:163], a[188:191], a[48:51], v[160:163]
    s_waitcnt lgkmcnt(2)
    v_permlane16_swap_b32 v33, v35
    buffer_store_dwordx4 v[32:35], v7, s[4:7], s38 offen offset:0 sc1
    v_mfma_f32_16x16x32_bf16 v[48:51], a[160:163], a[64:67], v[48:51]
    ds_read_b128 a[176:179], v2 offset:29696
    v_mul_f32 v40, v12, v40
    v_mfma_f32_16x16x32_bf16 v[48:51], a[164:167], a[80:83], v[48:51]
    ds_read_b128 a[180:183], v2 offset:44032
    v_mul_f32 v41, v12, v41
    v_mul_f32 v42, v12, v42
    v_mfma_f32_16x16x32_bf16 v[52:55], a[160:163], a[68:71], v[52:55]
    v_mul_f32 v43, v12, v43
    v_mfma_f32_16x16x32_bf16 v[52:55], a[164:167], a[84:87], v[52:55]
    v_exp_f32 v40, v40
    v_exp_f32 v41, v41
    v_mfma_f32_16x16x32_bf16 v[56:59], a[160:163], a[72:75], v[56:59]
    v_exp_f32 v42, v42
    v_mfma_f32_16x16x32_bf16 v[56:59], a[164:167], a[88:91], v[56:59]
    buffer_load_dwordx4 a[240:243], v6, s[4:7], s74 offen offset:0
    v_exp_f32 v43, v43
    v_mfma_f32_16x16x32_bf16 v[60:63], a[160:163], a[76:79], v[60:63]
    v_fma_f32 v40, v40, v18, v18
    v_fma_f32 v41, v41, v18, v18
    v_mfma_f32_16x16x32_bf16 v[60:63], a[164:167], a[92:95], v[60:63]
    s_waitcnt lgkmcnt(2)
    v_fma_f32 v42, v42, v18, v18
    v_fma_f32 v43, v43, v18, v18
    v_mfma_f32_16x16x32_bf16 v[172:175], a[168:171], a[76:79], v[172:175]
    ds_read_b128 a[184:187], v2 offset:36864
    v_mfma_f32_16x16x32_bf16 v[172:175], a[172:175], a[92:95], v[172:175]
    ds_read_b128 a[188:191], v2 offset:51200
    v_rcp_f32 v40, v40
    v_mfma_f32_16x16x32_bf16 v[168:171], a[168:171], a[72:75], v[168:171]
    v_rcp_f32 v41, v41
    v_rcp_f32 v42, v42
    v_mfma_f32_16x16x32_bf16 v[168:171], a[172:175], a[88:91], v[168:171]
    v_rcp_f32 v43, v43
    v_mfma_f32_16x16x32_bf16 v[164:167], a[168:171], a[68:71], v[164:167]
    v_mul_f32 v152, v152, v40
    v_mul_f32 v153, v153, v41
    v_mul_f32 v154, v154, v42
    v_mfma_f32_16x16x32_bf16 v[164:167], a[172:175], a[84:87], v[164:167]
    buffer_load_dwordx4 a[244:247], v6, s[4:7], s74 offen offset:1024
    v_mul_f32 v155, v155, v43
    v_mfma_f32_16x16x32_bf16 v[160:163], a[168:171], a[64:67], v[160:163]
    v_cvt_pk_bf16_f32 v40, v152, v153
    v_cvt_pk_bf16_f32 v41, v154, v155
    v_mul_f32 v44, v14, v44
    v_mfma_f32_16x16x32_bf16 v[160:163], a[172:175], a[80:83], v[160:163]
    s_waitcnt lgkmcnt(2)
    v_mul_f32 v45, v14, v45
    v_mfma_f32_16x16x32_bf16 v[48:51], a[176:179], a[96:99], v[48:51]
    ds_read_b128 a[160:163], v1 offset:2048
    v_mul_f32 v46, v14, v46
    v_mul_f32 v47, v14, v47
    v_mfma_f32_16x16x32_bf16 v[48:51], a[180:183], a[112:115], v[48:51]
    ds_read_b128 a[164:167], v1 offset:16384
    v_mfma_f32_16x16x32_bf16 v[52:55], a[176:179], a[100:103], v[52:55]
    v_exp_f32 v44, v44
    v_exp_f32 v45, v45
    v_mfma_f32_16x16x32_bf16 v[52:55], a[180:183], a[116:119], v[52:55]
    v_exp_f32 v46, v46
    v_mfma_f32_16x16x32_bf16 v[56:59], a[176:179], a[104:107], v[56:59]
    v_exp_f32 v47, v47
    v_fma_f32 v44, v44, v19, v19
    v_mfma_f32_16x16x32_bf16 v[56:59], a[180:183], a[120:123], v[56:59]
    buffer_load_dwordx4 a[248:251], v6, s[4:7], s74 offen offset:2048
    v_fma_f32 v45, v45, v19, v19
    v_fma_f32 v46, v46, v19, v19
    v_mfma_f32_16x16x32_bf16 v[60:63], a[176:179], a[108:111], v[60:63]
    v_fma_f32 v47, v47, v19, v19
    v_mfma_f32_16x16x32_bf16 v[60:63], a[180:183], a[124:127], v[60:63]
    s_waitcnt lgkmcnt(2)
    v_rcp_f32 v44, v44
    v_mfma_f32_16x16x32_bf16 v[172:175], a[184:187], a[108:111], v[172:175]
    ds_read_b128 a[168:171], v1 offset:9216
    v_rcp_f32 v45, v45
    v_mfma_f32_16x16x32_bf16 v[172:175], a[188:191], a[124:127], v[172:175]
    ds_read_b128 a[172:175], v1 offset:23552
    v_rcp_f32 v46, v46
    v_mfma_f32_16x16x32_bf16 v[168:171], a[184:187], a[104:107], v[168:171]
    v_rcp_f32 v47, v47
    v_mfma_f32_16x16x32_bf16 v[168:171], a[188:191], a[120:123], v[168:171]
    v_mul_f32 v156, v156, v44
    v_mul_f32 v157, v157, v45
    v_mul_f32 v158, v158, v46
    v_mfma_f32_16x16x32_bf16 v[164:167], a[184:187], a[100:103], v[164:167]
    v_mul_f32 v159, v159, v47
    v_cvt_pk_bf16_f32 v42, v156, v157
    v_mfma_f32_16x16x32_bf16 v[164:167], a[188:191], a[116:119], v[164:167]
    buffer_load_dwordx4 a[252:255], v6, s[4:7], s74 offen offset:3072
    v_cvt_pk_bf16_f32 v43, v158, v159
    v_nop
    v_mfma_f32_16x16x32_bf16 v[160:163], a[184:187], a[96:99], v[160:163]
    v_permlane16_swap_b32 v40, v42
    v_permlane16_swap_b32 v41, v43
    v_mfma_f32_16x16x32_bf16 v[160:163], a[188:191], a[112:115], v[160:163]
    s_waitcnt lgkmcnt(2)
    buffer_store_dwordx4 v[40:43], v7, s[4:7], s38 offen offset:2048 sc1
    s_add_u32 s38, s38, 32768
    v_mfma_f32_16x16x32_bf16 v[64:67], a[160:163], a[0:3], v[64:67]
    ds_read_b128 a[176:179], v1 offset:30720
    v_mul_f32 v48, v8, v48
    v_mfma_f32_16x16x32_bf16 v[64:67], a[164:167], a[16:19], v[64:67]
    ds_read_b128 a[180:183], v1 offset:45056
    v_mul_f32 v49, v8, v49
    v_mul_f32 v50, v8, v50
    v_mfma_f32_16x16x32_bf16 v[68:71], a[160:163], a[4:7], v[68:71]
    v_mul_f32 v51, v8, v51
    v_mfma_f32_16x16x32_bf16 v[68:71], a[164:167], a[20:23], v[68:71]
    v_exp_f32 v48, v48
    v_exp_f32 v49, v49
    v_mfma_f32_16x16x32_bf16 v[72:75], a[160:163], a[8:11], v[72:75]
    v_exp_f32 v50, v50
    v_mfma_f32_16x16x32_bf16 v[72:75], a[164:167], a[24:27], v[72:75]
    v_exp_f32 v51, v51
    v_mfma_f32_16x16x32_bf16 v[76:79], a[160:163], a[12:15], v[76:79]
    v_fma_f32 v48, v48, v16, v16
    v_fma_f32 v49, v49, v16, v16
    v_fma_f32 v50, v50, v16, v16
    v_mfma_f32_16x16x32_bf16 v[76:79], a[164:167], a[28:31], v[76:79]
    s_waitcnt lgkmcnt(2)
    v_fma_f32 v51, v51, v16, v16
    v_mfma_f32_16x16x32_bf16 v[188:191], a[168:171], a[12:15], v[188:191]
    ds_read_b128 a[184:187], v1 offset:37888
    v_rcp_f32 v48, v48
    v_mfma_f32_16x16x32_bf16 v[188:191], a[172:175], a[28:31], v[188:191]
    ds_read_b128 a[188:191], v1 offset:52224
    v_mfma_f32_16x16x32_bf16 v[184:187], a[168:171], a[8:11], v[184:187]
    v_rcp_f32 v49, v49
    v_mfma_f32_16x16x32_bf16 v[184:187], a[172:175], a[24:27], v[184:187]
    v_rcp_f32 v50, v50
    v_rcp_f32 v51, v51
    v_mfma_f32_16x16x32_bf16 v[180:183], a[168:171], a[4:7], v[180:183]
    v_mul_f32 v160, v160, v48
    v_mul_f32 v161, v161, v49
    v_mfma_f32_16x16x32_bf16 v[180:183], a[172:175], a[20:23], v[180:183]
    v_mul_f32 v162, v162, v50
    v_mul_f32 v163, v163, v51
    v_cvt_pk_bf16_f32 v48, v160, v161
    v_mfma_f32_16x16x32_bf16 v[176:179], a[168:171], a[0:3], v[176:179]
    v_cvt_pk_bf16_f32 v49, v162, v163
    v_mul_f32 v52, v10, v52
    v_mfma_f32_16x16x32_bf16 v[176:179], a[172:175], a[16:19], v[176:179]
    s_waitcnt lgkmcnt(2)
    v_mul_f32 v53, v10, v53
    v_mul_f32 v54, v10, v54
    v_mfma_f32_16x16x32_bf16 v[64:67], a[176:179], a[32:35], v[64:67]
    ds_read_b128 a[160:163], v2 offset:2048
    v_mul_f32 v55, v10, v55
    v_mfma_f32_16x16x32_bf16 v[64:67], a[180:183], a[48:51], v[64:67]
    ds_read_b128 a[164:167], v2 offset:16384
    v_mfma_f32_16x16x32_bf16 v[68:71], a[176:179], a[36:39], v[68:71]
    v_exp_f32 v52, v52
    v_exp_f32 v53, v53
    v_mfma_f32_16x16x32_bf16 v[68:71], a[180:183], a[52:55], v[68:71]
    v_exp_f32 v54, v54
    v_mfma_f32_16x16x32_bf16 v[72:75], a[176:179], a[40:43], v[72:75]
    v_exp_f32 v55, v55
    v_fma_f32 v52, v52, v17, v17
    v_mfma_f32_16x16x32_bf16 v[72:75], a[180:183], a[56:59], v[72:75]
    v_fma_f32 v53, v53, v17, v17
    v_fma_f32 v54, v54, v17, v17
    v_mfma_f32_16x16x32_bf16 v[76:79], a[176:179], a[44:47], v[76:79]
    v_fma_f32 v55, v55, v17, v17
    v_mfma_f32_16x16x32_bf16 v[76:79], a[180:183], a[60:63], v[76:79]
    s_waitcnt lgkmcnt(2)
    v_rcp_f32 v52, v52
    v_mfma_f32_16x16x32_bf16 v[188:191], a[184:187], a[44:47], v[188:191]
    ds_read_b128 a[168:171], v2 offset:9216
    v_rcp_f32 v53, v53
    v_mfma_f32_16x16x32_bf16 v[188:191], a[188:191], a[60:63], v[188:191]
    ds_read_b128 a[172:175], v2 offset:23552
    v_rcp_f32 v54, v54
    v_mfma_f32_16x16x32_bf16 v[184:187], a[184:187], a[40:43], v[184:187]
    v_rcp_f32 v55, v55
    v_mfma_f32_16x16x32_bf16 v[184:187], a[188:191], a[56:59], v[184:187]
    v_mul_f32 v164, v164, v52
    v_mul_f32 v165, v165, v53
    v_mfma_f32_16x16x32_bf16 v[180:183], a[184:187], a[36:39], v[180:183]
    v_mul_f32 v166, v166, v54
    v_mul_f32 v167, v167, v55
    v_cvt_pk_bf16_f32 v50, v164, v165
    v_mfma_f32_16x16x32_bf16 v[180:183], a[188:191], a[52:55], v[180:183]
    v_cvt_pk_bf16_f32 v51, v166, v167
    v_nop
    v_mfma_f32_16x16x32_bf16 v[176:179], a[184:187], a[32:35], v[176:179]
    v_permlane16_swap_b32 v48, v50
    v_permlane16_swap_b32 v49, v51
    buffer_store_dwordx4 v[48:51], v7, s[4:7], s38 offen offset:0 sc1
    v_mfma_f32_16x16x32_bf16 v[176:179], a[188:191], a[48:51], v[176:179]
    s_waitcnt lgkmcnt(2)
    v_mul_f32 v56, v12, v56
    v_mfma_f32_16x16x32_bf16 v[64:67], a[160:163], a[64:67], v[64:67]
    ds_read_b128 a[176:179], v2 offset:30720
    v_mul_f32 v57, v12, v57
    v_mfma_f32_16x16x32_bf16 v[64:67], a[164:167], a[80:83], v[64:67]
    ds_read_b128 a[180:183], v2 offset:45056
    v_mul_f32 v58, v12, v58
    v_mul_f32 v59, v12, v59
    v_mfma_f32_16x16x32_bf16 v[68:71], a[160:163], a[68:71], v[68:71]
    v_exp_f32 v56, v56
    v_mfma_f32_16x16x32_bf16 v[68:71], a[164:167], a[84:87], v[68:71]
    v_exp_f32 v57, v57
    v_mfma_f32_16x16x32_bf16 v[72:75], a[160:163], a[72:75], v[72:75]
    v_exp_f32 v58, v58
    v_mfma_f32_16x16x32_bf16 v[72:75], a[164:167], a[88:91], v[72:75]
    v_exp_f32 v59, v59
    v_fma_f32 v56, v56, v18, v18
    v_mfma_f32_16x16x32_bf16 v[76:79], a[160:163], a[76:79], v[76:79]
    v_fma_f32 v57, v57, v18, v18
    v_fma_f32 v58, v58, v18, v18
    v_fma_f32 v59, v59, v18, v18
    v_mfma_f32_16x16x32_bf16 v[76:79], a[164:167], a[92:95], v[76:79]
    s_waitcnt lgkmcnt(2)
    v_mfma_f32_16x16x32_bf16 v[188:191], a[168:171], a[76:79], v[188:191]
    ds_read_b128 a[184:187], v2 offset:37888
    v_rcp_f32 v56, v56
    v_mfma_f32_16x16x32_bf16 v[188:191], a[172:175], a[92:95], v[188:191]
    ds_read_b128 a[188:191], v2 offset:52224
    v_rcp_f32 v57, v57
    v_mfma_f32_16x16x32_bf16 v[184:187], a[168:171], a[72:75], v[184:187]
    v_rcp_f32 v58, v58
    v_mfma_f32_16x16x32_bf16 v[184:187], a[172:175], a[88:91], v[184:187]
    v_rcp_f32 v59, v59
    v_mul_f32 v168, v168, v56
    v_mfma_f32_16x16x32_bf16 v[180:183], a[168:171], a[68:71], v[180:183]
    v_mul_f32 v169, v169, v57
    v_mul_f32 v170, v170, v58
    v_mfma_f32_16x16x32_bf16 v[180:183], a[172:175], a[84:87], v[180:183]
    v_mul_f32 v171, v171, v59
    v_cvt_pk_bf16_f32 v56, v168, v169
    v_cvt_pk_bf16_f32 v57, v170, v171
    v_mfma_f32_16x16x32_bf16 v[176:179], a[168:171], a[64:67], v[176:179]
    v_mul_f32 v60, v14, v60
    v_mul_f32 v61, v14, v61
    v_mfma_f32_16x16x32_bf16 v[176:179], a[172:175], a[80:83], v[176:179]
    s_waitcnt lgkmcnt(2)
    v_mul_f32 v62, v14, v62
    v_mul_f32 v63, v14, v63
    v_mfma_f32_16x16x32_bf16 v[64:67], a[176:179], a[96:99], v[64:67]
    ds_read_b128 a[160:163], v1 offset:3072
    v_mfma_f32_16x16x32_bf16 v[64:67], a[180:183], a[112:115], v[64:67]
    ds_read_b128 a[164:167], v1 offset:17408
    v_exp_f32 v60, v60
    v_mfma_f32_16x16x32_bf16 v[68:71], a[176:179], a[100:103], v[68:71]
    v_exp_f32 v61, v61
    v_mfma_f32_16x16x32_bf16 v[68:71], a[180:183], a[116:119], v[68:71]
    v_exp_f32 v62, v62
    v_mfma_f32_16x16x32_bf16 v[72:75], a[176:179], a[104:107], v[72:75]
    v_exp_f32 v63, v63
    v_fma_f32 v60, v60, v19, v19
    v_fma_f32 v61, v61, v19, v19
    v_mfma_f32_16x16x32_bf16 v[72:75], a[180:183], a[120:123], v[72:75]
    v_fma_f32 v62, v62, v19, v19
    v_fma_f32 v63, v63, v19, v19
    v_mfma_f32_16x16x32_bf16 v[76:79], a[176:179], a[108:111], v[76:79]
    v_rcp_f32 v60, v60
    v_mfma_f32_16x16x32_bf16 v[76:79], a[180:183], a[124:127], v[76:79]
    s_waitcnt vmcnt(1) lgkmcnt(0)
    s_barrier
    v_rcp_f32 v61, v61
    v_mfma_f32_16x16x32_bf16 v[188:191], a[184:187], a[108:111], v[188:191]
    ds_read_b128 a[168:171], v1 offset:10240
    v_mfma_f32_16x16x32_bf16 v[188:191], a[188:191], a[124:127], v[188:191]
    ds_read_b128 a[172:175], v1 offset:24576
    v_rcp_f32 v62, v62
    v_mfma_f32_16x16x32_bf16 v[184:187], a[184:187], a[104:107], v[184:187]
    s_mov_b64 exec, 1
    buffer_atomic_add v28, off, s[4:7], s56 offset:0 sc1
    s_mov_b64 exec, -1
    v_rcp_f32 v63, v63
    v_mfma_f32_16x16x32_bf16 v[184:187], a[188:191], a[120:123], v[184:187]
    v_mul_f32 v172, v172, v60
    v_mul_f32 v173, v173, v61
    v_mfma_f32_16x16x32_bf16 v[180:183], a[184:187], a[100:103], v[180:183]
    v_mul_f32 v174, v174, v62
    v_mul_f32 v175, v175, v63
    v_cvt_pk_bf16_f32 v58, v172, v173
    v_mfma_f32_16x16x32_bf16 v[180:183], a[188:191], a[116:119], v[180:183]
    v_cvt_pk_bf16_f32 v59, v174, v175
    v_nop
    v_mfma_f32_16x16x32_bf16 v[176:179], a[184:187], a[96:99], v[176:179]
    v_permlane16_swap_b32 v56, v58
    v_permlane16_swap_b32 v57, v59
    buffer_store_dwordx4 v[56:59], v7, s[4:7], s38 offen offset:2048 sc1
    v_mfma_f32_16x16x32_bf16 v[176:179], a[188:191], a[112:115], v[176:179]
    s_add_u32 s38, s38, 32768
    v_mfma_f32_16x16x32_bf16 v[80:83], a[160:163], a[0:3], v[80:83]
    ds_read_b128 a[176:179], v1 offset:31744
    v_mul_f32 v64, v8, v64
    v_mfma_f32_16x16x32_bf16 v[80:83], a[164:167], a[16:19], v[80:83]
    ds_read_b128 a[180:183], v1 offset:46080
    v_mul_f32 v65, v8, v65
    v_mul_f32 v66, v8, v66
    v_mfma_f32_16x16x32_bf16 v[84:87], a[160:163], a[4:7], v[84:87]
    v_mul_f32 v67, v8, v67
    v_mfma_f32_16x16x32_bf16 v[84:87], a[164:167], a[20:23], v[84:87]
    v_exp_f32 v64, v64
    v_exp_f32 v65, v65
    s_branch L_isl11_over
.p2align 12
L_isl11:
    s_setpc_b64 s[14:15]
L_isl11_over:
    v_mfma_f32_16x16x32_bf16 v[88:91], a[160:163], a[8:11], v[88:91]
    v_exp_f32 v66, v66
    v_mfma_f32_16x16x32_bf16 v[88:91], a[164:167], a[24:27], v[88:91]
    v_exp_f32 v67, v67
    v_fma_f32 v64, v64, v16, v16
    v_mfma_f32_16x16x32_bf16 v[92:95], a[160:163], a[12:15], v[92:95]
    v_fma_f32 v65, v65, v16, v16
    v_fma_f32 v66, v66, v16, v16
    v_mfma_f32_16x16x32_bf16 v[92:95], a[164:167], a[28:31], v[92:95]
    s_waitcnt lgkmcnt(2)
    v_fma_f32 v67, v67, v16, v16
    v_mfma_f32_16x16x32_bf16 v[204:207], a[168:171], a[12:15], v[204:207]
    ds_read_b128 a[184:187], v1 offset:38912
    v_rcp_f32 v64, v64
    v_mfma_f32_16x16x32_bf16 v[204:207], a[172:175], a[28:31], v[204:207]
    ds_read_b128 a[188:191], v1 offset:53248
    v_mfma_f32_16x16x32_bf16 v[200:203], a[168:171], a[8:11], v[200:203]
    v_rcp_f32 v65, v65
    v_rcp_f32 v66, v66
    v_mfma_f32_16x16x32_bf16 v[200:203], a[172:175], a[24:27], v[200:203]
    v_rcp_f32 v67, v67
    v_mfma_f32_16x16x32_bf16 v[196:199], a[168:171], a[4:7], v[196:199]
    v_mul_f32 v176, v176, v64
    v_mul_f32 v177, v177, v65
    v_mfma_f32_16x16x32_bf16 v[196:199], a[172:175], a[20:23], v[196:199]
    buffer_load_dword v30, v29, s[4:7], s32 offen
    s_add_u32 s32, s32, 131072
    v_mul_f32 v178, v178, v66
    v_mfma_f32_16x16x32_bf16 v[192:195], a[168:171], a[0:3], v[192:195]
    v_mul_f32 v179, v179, v67
    v_cvt_pk_bf16_f32 v64, v176, v177
    v_mfma_f32_16x16x32_bf16 v[192:195], a[172:175], a[16:19], v[192:195]
    s_waitcnt lgkmcnt(2)
    v_cvt_pk_bf16_f32 v65, v178, v179
    v_mul_f32 v68, v10, v68
    v_mfma_f32_16x16x32_bf16 v[80:83], a[176:179], a[32:35], v[80:83]
    ds_read_b128 a[160:163], v2 offset:3072
    v_mul_f32 v69, v10, v69
    v_mfma_f32_16x16x32_bf16 v[80:83], a[180:183], a[48:51], v[80:83]
    ds_read_b128 a[164:167], v2 offset:17408
    v_mul_f32 v70, v10, v70
    v_mul_f32 v71, v10, v71
    v_mfma_f32_16x16x32_bf16 v[84:87], a[176:179], a[36:39], v[84:87]
    v_exp_f32 v68, v68
    v_mfma_f32_16x16x32_bf16 v[84:87], a[180:183], a[52:55], v[84:87]
    v_exp_f32 v69, v69
    v_mfma_f32_16x16x32_bf16 v[88:91], a[176:179], a[40:43], v[88:91]
    v_exp_f32 v70, v70
    v_mfma_f32_16x16x32_bf16 v[88:91], a[180:183], a[56:59], v[88:91]
    v_exp_f32 v71, v71
    v_fma_f32 v68, v68, v17, v17
    v_mfma_f32_16x16x32_bf16 v[92:95], a[176:179], a[44:47], v[92:95]
    v_fma_f32 v69, v69, v17, v17
    v_fma_f32 v70, v70, v17, v17
    v_fma_f32 v71, v71, v17, v17
    v_mfma_f32_16x16x32_bf16 v[92:95], a[180:183], a[60:63], v[92:95]
    s_waitcnt lgkmcnt(2)
    v_mfma_f32_16x16x32_bf16 v[204:207], a[184:187], a[44:47], v[204:207]
    ds_read_b128 a[168:171], v2 offset:10240
    v_rcp_f32 v68, v68
    v_mfma_f32_16x16x32_bf16 v[204:207], a[188:191], a[60:63], v[204:207]
    ds_read_b128 a[172:175], v2 offset:24576
    v_rcp_f32 v69, v69
    v_mfma_f32_16x16x32_bf16 v[200:203], a[184:187], a[40:43], v[200:203]
    v_rcp_f32 v70, v70
    v_mfma_f32_16x16x32_bf16 v[200:203], a[188:191], a[56:59], v[200:203]
    v_rcp_f32 v71, v71
    v_mul_f32 v180, v180, v68
    v_mfma_f32_16x16x32_bf16 v[196:199], a[184:187], a[36:39], v[196:199]
    v_mul_f32 v181, v181, v69
    v_mul_f32 v182, v182, v70
    v_mfma_f32_16x16x32_bf16 v[196:199], a[188:191], a[52:55], v[196:199]
    v_mul_f32 v183, v183, v71
    v_cvt_pk_bf16_f32 v66, v180, v181
    v_cvt_pk_bf16_f32 v67, v182, v183
    v_mfma_f32_16x16x32_bf16 v[192:195], a[184:187], a[32:35], v[192:195]
    v_nop
    v_permlane16_swap_b32 v64, v66
    v_mfma_f32_16x16x32_bf16 v[192:195], a[188:191], a[48:51], v[192:195]
    s_waitcnt lgkmcnt(2)
    v_permlane16_swap_b32 v65, v67
    buffer_store_dwordx4 v[64:67], v7, s[4:7], s38 offen offset:0 sc1
    v_mfma_f32_16x16x32_bf16 v[80:83], a[160:163], a[64:67], v[80:83]
    ds_read_b128 a[176:179], v2 offset:31744
    v_mul_f32 v72, v12, v72
    v_mfma_f32_16x16x32_bf16 v[80:83], a[164:167], a[80:83], v[80:83]
    ds_read_b128 a[180:183], v2 offset:46080
    v_mul_f32 v73, v12, v73
    v_mfma_f32_16x16x32_bf16 v[84:87], a[160:163], a[68:71], v[84:87]
    v_mul_f32 v74, v12, v74
    v_mul_f32 v75, v12, v75
    v_mfma_f32_16x16x32_bf16 v[84:87], a[164:167], a[84:87], v[84:87]
    v_exp_f32 v72, v72
    v_mfma_f32_16x16x32_bf16 v[88:91], a[160:163], a[72:75], v[88:91]
    v_exp_f32 v73, v73
    v_exp_f32 v74, v74
    v_mfma_f32_16x16x32_bf16 v[88:91], a[164:167], a[88:91], v[88:91]
    v_exp_f32 v75, v75
    v_mfma_f32_16x16x32_bf16 v[92:95], a[160:163], a[76:79], v[92:95]
    v_fma_f32 v72, v72, v18, v18
    v_fma_f32 v73, v73, v18, v18
    v_mfma_f32_16x16x32_bf16 v[92:95], a[164:167], a[92:95], v[92:95]
    s_waitcnt lgkmcnt(2)
    v_fma_f32 v74, v74, v18, v18
    v_fma_f32 v75, v75, v18, v18
    v_mfma_f32_16x16x32_bf16 v[204:207], a[168:171], a[76:79], v[204:207]
    ds_read_b128 a[184:187], v2 offset:38912
    v_mfma_f32_16x16x32_bf16 v[204:207], a[172:175], a[92:95], v[204:207]
    ds_read_b128 a[188:191], v2 offset:53248
    v_rcp_f32 v72, v72
    v_mfma_f32_16x16x32_bf16 v[200:203], a[168:171], a[72:75], v[200:203]
    v_rcp_f32 v73, v73
    v_mfma_f32_16x16x32_bf16 v[200:203], a[172:175], a[88:91], v[200:203]
    v_rcp_f32 v74, v74
    v_rcp_f32 v75, v75
    v_mfma_f32_16x16x32_bf16 v[196:199], a[168:171], a[68:71], v[196:199]
    v_mul_f32 v184, v184, v72
    v_mul_f32 v185, v185, v73
    v_mfma_f32_16x16x32_bf16 v[196:199], a[172:175], a[84:87], v[196:199]
    v_mul_f32 v186, v186, v74
    v_mul_f32 v187, v187, v75
    v_mfma_f32_16x16x32_bf16 v[192:195], a[168:171], a[64:67], v[192:195]
    v_cvt_pk_bf16_f32 v72, v184, v185
    v_cvt_pk_bf16_f32 v73, v186, v187
    v_mul_f32 v76, v14, v76
    v_mfma_f32_16x16x32_bf16 v[192:195], a[172:175], a[80:83], v[192:195]
    s_waitcnt lgkmcnt(2)
    v_mul_f32 v77, v14, v77
    v_mfma_f32_16x16x32_bf16 v[80:83], a[176:179], a[96:99], v[80:83]
    ds_read_b128 a[160:163], v1 offset:4096
    v_mul_f32 v78, v14, v78
    v_mul_f32 v79, v14, v79
    v_mfma_f32_16x16x32_bf16 v[80:83], a[180:183], a[112:115], v[80:83]
    ds_read_b128 a[164:167], v1 offset:18432
    v_mfma_f32_16x16x32_bf16 v[84:87], a[176:179], a[100:103], v[84:87]
    v_exp_f32 v76, v76
    v_exp_f32 v77, v77
    v_mfma_f32_16x16x32_bf16 v[84:87], a[180:183], a[116:119], v[84:87]
    v_exp_f32 v78, v78
    v_mfma_f32_16x16x32_bf16 v[88:91], a[176:179], a[104:107], v[88:91]
    v_exp_f32 v79, v79
    v_mfma_f32_16x16x32_bf16 v[88:91], a[180:183], a[120:123], v[88:91]
    v_fma_f32 v76, v76, v19, v19
    v_fma_f32 v77, v77, v19, v19
    v_fma_f32 v78, v78, v19, v19
    v_mfma_f32_16x16x32_bf16 v[92:95], a[176:179], a[108:111], v[92:95]
    v_fma_f32 v79, v79, v19, v19
    v_mfma_f32_16x16x32_bf16 v[92:95], a[180:183], a[124:127], v[92:95]
    s_waitcnt lgkmcnt(2)
    v_rcp_f32 v76, v76
    v_mfma_f32_16x16x32_bf16 v[204:207], a[184:187], a[108:111], v[204:207]
    ds_read_b128 a[168:171], v1 offset:11264
    v_rcp_f32 v77, v77
    v_mfma_f32_16x16x32_bf16 v[204:207], a[188:191], a[124:127], v[204:207]
    ds_read_b128 a[172:175], v1 offset:25600
    v_mfma_f32_16x16x32_bf16 v[200:203], a[184:187], a[104:107], v[200:203]
    v_rcp_f32 v78, v78
    v_rcp_f32 v79, v79
    v_mfma_f32_16x16x32_bf16 v[200:203], a[188:191], a[120:123], v[200:203]
    v_mul_f32 v188, v188, v76
    v_mul_f32 v189, v189, v77
    v_mfma_f32_16x16x32_bf16 v[196:199], a[184:187], a[100:103], v[196:199]
    v_mul_f32 v190, v190, v78
    v_mul_f32 v191, v191, v79
    v_cvt_pk_bf16_f32 v74, v188, v189
    v_mfma_f32_16x16x32_bf16 v[196:199], a[188:191], a[116:119], v[196:199]
    v_cvt_pk_bf16_f32 v75, v190, v191
    v_nop
    v_mfma_f32_16x16x32_bf16 v[192:195], a[184:187], a[96:99], v[192:195]
    v_permlane16_swap_b32 v72, v74
    v_permlane16_swap_b32 v73, v75
    buffer_store_dwordx4 v[72:75], v7, s[4:7], s38 offen offset:2048 sc1
    v_mfma_f32_16x16x32_bf16 v[192:195], a[188:191], a[112:115], v[192:195]
    s_waitcnt lgkmcnt(2)
    s_add_u32 s38, s38, 32768
    v_mfma_f32_16x16x32_bf16 v[96:99], a[160:163], a[0:3], v[96:99]
    ds_read_b128 a[176:179], v1 offset:32768
    v_mul_f32 v80, v8, v80
    v_mul_f32 v81, v8, v81
    v_mfma_f32_16x16x32_bf16 v[96:99], a[164:167], a[16:19], v[96:99]
    ds_read_b128 a[180:183], v1 offset:47104
    v_mul_f32 v82, v8, v82
    v_mfma_f32_16x16x32_bf16 v[100:103], a[160:163], a[4:7], v[100:103]
    v_mul_f32 v83, v8, v83
    v_exp_f32 v80, v80
    v_mfma_f32_16x16x32_bf16 v[100:103], a[164:167], a[20:23], v[100:103]
    v_exp_f32 v81, v81
    v_mfma_f32_16x16x32_bf16 v[104:107], a[160:163], a[8:11], v[104:107]
    v_exp_f32 v82, v82
    v_mfma_f32_16x16x32_bf16 v[104:107], a[164:167], a[24:27], v[104:107]
    v_exp_f32 v83, v83
    v_fma_f32 v80, v80, v16, v16
    v_mfma_f32_16x16x32_bf16 v[108:111], a[160:163], a[12:15], v[108:111]
    buffer_load_dwordx4 v[64:67], v1, s[4:7], s77 offen offset:0
    v_fma_f32 v81, v81, v16, v16
    v_fma_f32 v82, v82, v16, v16
    v_mfma_f32_16x16x32_bf16 v[108:111], a[164:167], a[28:31], v[108:111]
    s_waitcnt lgkmcnt(2)
    v_fma_f32 v83, v83, v16, v16
    v_mfma_f32_16x16x32_bf16 v[220:223], a[168:171], a[12:15], v[220:223]
    ds_read_b128 a[184:187], v1 offset:39936
    v_rcp_f32 v80, v80
    v_mfma_f32_16x16x32_bf16 v[220:223], a[172:175], a[28:31], v[220:223]
    ds_read_b128 a[188:191], v1 offset:54272
    v_mfma_f32_16x16x32_bf16 v[216:219], a[168:171], a[8:11], v[216:219]
    v_rcp_f32 v81, v81
    v_rcp_f32 v82, v82
    v_mfma_f32_16x16x32_bf16 v[216:219], a[172:175], a[24:27], v[216:219]
    v_rcp_f32 v83, v83
    v_mul_f32 v192, v192, v80
    v_mfma_f32_16x16x32_bf16 v[212:215], a[168:171], a[4:7], v[212:215]
    v_mul_f32 v193, v193, v81
    v_mul_f32 v194, v194, v82
    v_mfma_f32_16x16x32_bf16 v[212:215], a[172:175], a[20:23], v[212:215]
    buffer_load_dwordx4 v[68:71], v1, s[4:7], s77 offen offset:1024
    v_mul_f32 v195, v195, v83
    v_cvt_pk_bf16_f32 v80, v192, v193
    v_mfma_f32_16x16x32_bf16 v[208:211], a[168:171], a[0:3], v[208:211]
    v_cvt_pk_bf16_f32 v81, v194, v195
    v_mul_f32 v84, v10, v84
    v_mfma_f32_16x16x32_bf16 v[208:211], a[172:175], a[16:19], v[208:211]
    s_waitcnt lgkmcnt(2)
    v_mul_f32 v85, v10, v85
    v_mul_f32 v86, v10, v86
    v_mfma_f32_16x16x32_bf16 v[96:99], a[176:179], a[32:35], v[96:99]
    ds_read_b128 a[160:163], v2 offset:4096
    v_mul_f32 v87, v10, v87
    v_mfma_f32_16x16x32_bf16 v[96:99], a[180:183], a[48:51], v[96:99]
    ds_read_b128 a[164:167], v2 offset:18432
    v_exp_f32 v84, v84
    v_mfma_f32_16x16x32_bf16 v[100:103], a[176:179], a[36:39], v[100:103]
    v_exp_f32 v85, v85
    v_mfma_f32_16x16x32_bf16 v[100:103], a[180:183], a[52:55], v[100:103]
    v_exp_f32 v86, v86
    v_mfma_f32_16x16x32_bf16 v[104:107], a[176:179], a[40:43], v[104:107]
    v_exp_f32 v87, v87
    v_fma_f32 v84, v84, v17, v17
    v_mfma_f32_16x16x32_bf16 v[104:107], a[180:183], a[56:59], v[104:107]
    buffer_load_dwordx4 v[72:75], v1, s[4:7], s77 offen offset:2048
    v_fma_f32 v85, v85, v17, v17
    v_fma_f32 v86, v86, v17, v17
    v_mfma_f32_16x16x32_bf16 v[108:111], a[176:179], a[44:47], v[108:111]
    v_fma_f32 v87, v87, v17, v17
    v_rcp_f32 v84, v84
    v_mfma_f32_16x16x32_bf16 v[108:111], a[180:183], a[60:63], v[108:111]
    s_waitcnt lgkmcnt(2)
    v_mfma_f32_16x16x32_bf16 v[220:223], a[184:187], a[44:47], v[220:223]
    ds_read_b128 a[168:171], v2 offset:11264
    v_rcp_f32 v85, v85
    v_mfma_f32_16x16x32_bf16 v[220:223], a[188:191], a[60:63], v[220:223]
    ds_read_b128 a[172:175], v2 offset:25600
    v_rcp_f32 v86, v86
    v_mfma_f32_16x16x32_bf16 v[216:219], a[184:187], a[40:43], v[216:219]
    v_rcp_f32 v87, v87
    v_mul_f32 v196, v196, v84
    v_mfma_f32_16x16x32_bf16 v[216:219], a[188:191], a[56:59], v[216:219]
    v_mul_f32 v197, v197, v85
    v_mul_f32 v198, v198, v86
    v_mfma_f32_16x16x32_bf16 v[212:215], a[184:187], a[36:39], v[212:215]
    buffer_load_dword v27, off, s[4:7], s57 offset:0 sc1
    v_mul_f32 v199, v199, v87
    v_cvt_pk_bf16_f32 v82, v196, v197
    v_mfma_f32_16x16x32_bf16 v[212:215], a[188:191], a[52:55], v[212:215]
    buffer_load_dwordx4 v[76:79], v1, s[4:7], s77 offen offset:3072
    v_cvt_pk_bf16_f32 v83, v198, v199
    v_mfma_f32_16x16x32_bf16 v[208:211], a[184:187], a[32:35], v[208:211]
    v_nop
    v_permlane16_swap_b32 v80, v82
    v_permlane16_swap_b32 v81, v83
    v_mfma_f32_16x16x32_bf16 v[208:211], a[188:191], a[48:51], v[208:211]
    s_waitcnt lgkmcnt(2)
    buffer_store_dwordx4 v[80:83], v7, s[4:7], s38 offen offset:0 sc1
    v_mul_f32 v88, v12, v88
    v_mfma_f32_16x16x32_bf16 v[96:99], a[160:163], a[64:67], v[96:99]
    ds_read_b128 a[176:179], v2 offset:32768
    v_mul_f32 v89, v12, v89
    v_mfma_f32_16x16x32_bf16 v[96:99], a[164:167], a[80:83], v[96:99]
    ds_read_b128 a[180:183], v2 offset:47104
    v_mul_f32 v90, v12, v90
    v_mul_f32 v91, v12, v91
    v_mfma_f32_16x16x32_bf16 v[100:103], a[160:163], a[68:71], v[100:103]
    v_exp_f32 v88, v88
    v_mfma_f32_16x16x32_bf16 v[100:103], a[164:167], a[84:87], v[100:103]
    v_exp_f32 v89, v89
    v_mfma_f32_16x16x32_bf16 v[104:107], a[160:163], a[72:75], v[104:107]
    v_exp_f32 v90, v90
    v_mfma_f32_16x16x32_bf16 v[104:107], a[164:167], a[88:91], v[104:107]
    buffer_load_dwordx4 v[176:179], v6, s[4:7], s77 offen offset:0
    v_exp_f32 v91, v91
    v_fma_f32 v88, v88, v18, v18
    v_mfma_f32_16x16x32_bf16 v[108:111], a[160:163], a[76:79], v[108:111]
    v_fma_f32 v89, v89, v18, v18
    v_fma_f32 v90, v90, v18, v18
    v_mfma_f32_16x16x32_bf16 v[108:111], a[164:167], a[92:95], v[108:111]
    s_waitcnt lgkmcnt(2)
    v_fma_f32 v91, v91, v18, v18
    v_mfma_f32_16x16x32_bf16 v[220:223], a[168:171], a[76:79], v[220:223]
    ds_read_b128 a[184:187], v2 offset:39936
    v_rcp_f32 v88, v88
    v_mfma_f32_16x16x32_bf16 v[220:223], a[172:175], a[92:95], v[220:223]
    ds_read_b128 a[188:191], v2 offset:54272
    v_rcp_f32 v89, v89
    v_mfma_f32_16x16x32_bf16 v[216:219], a[168:171], a[72:75], v[216:219]
    v_rcp_f32 v90, v90
    v_mfma_f32_16x16x32_bf16 v[216:219], a[172:175], a[88:91], v[216:219]
    v_rcp_f32 v91, v91
    v_mul_f32 v200, v200, v88
    v_mfma_f32_16x16x32_bf16 v[212:215], a[168:171], a[68:71], v[212:215]
    v_mul_f32 v201, v201, v89
    v_mul_f32 v202, v202, v90
    v_mul_f32 v203, v203, v91
    v_mfma_f32_16x16x32_bf16 v[212:215], a[172:175], a[84:87], v[212:215]
    buffer_load_dwordx4 v[180:183], v6, s[4:7], s77 offen offset:1024
    v_cvt_pk_bf16_f32 v88, v200, v201
    v_mfma_f32_16x16x32_bf16 v[208:211], a[168:171], a[64:67], v[208:211]
    v_cvt_pk_bf16_f32 v89, v202, v203
    v_mul_f32 v92, v14, v92
    v_mul_f32 v93, v14, v93
    v_mfma_f32_16x16x32_bf16 v[208:211], a[172:175], a[80:83], v[208:211]
    s_waitcnt lgkmcnt(2)
    v_mul_f32 v94, v14, v94
    v_mfma_f32_16x16x32_bf16 v[96:99], a[176:179], a[96:99], v[96:99]
    ds_read_b128 a[160:163], v1 offset:5120
    v_mul_f32 v95, v14, v95
    v_mfma_f32_16x16x32_bf16 v[96:99], a[180:183], a[112:115], v[96:99]
    ds_read_b128 a[164:167], v1 offset:19456
    v_exp_f32 v92, v92
    v_mfma_f32_16x16x32_bf16 v[100:103], a[176:179], a[100:103], v[100:103]
    v_exp_f32 v93, v93
    v_mfma_f32_16x16x32_bf16 v[100:103], a[180:183], a[116:119], v[100:103]
    v_exp_f32 v94, v94
    v_mfma_f32_16x16x32_bf16 v[104:107], a[176:179], a[104:107], v[104:107]
    v_exp_f32 v95, v95
    v_fma_f32 v92, v92, v19, v19
    v_fma_f32 v93, v93, v19, v19
    v_mfma_f32_16x16x32_bf16 v[104:107], a[180:183], a[120:123], v[104:107]
    buffer_load_dwordx4 v[184:187], v6, s[4:7], s77 offen offset:2048
    v_fma_f32 v94, v94, v19, v19
    v_fma_f32 v95, v95, v19, v19
    v_mfma_f32_16x16x32_bf16 v[108:111], a[176:179], a[108:111], v[108:111]
    v_rcp_f32 v92, v92
    v_mfma_f32_16x16x32_bf16 v[108:111], a[180:183], a[124:127], v[108:111]
    s_waitcnt vmcnt(9) lgkmcnt(0)
    s_barrier
    v_rcp_f32 v93, v93
    v_mfma_f32_16x16x32_bf16 v[220:223], a[184:187], a[108:111], v[220:223]
    ds_read_b128 a[168:171], v1 offset:12288
    v_mfma_f32_16x16x32_bf16 v[220:223], a[188:191], a[124:127], v[220:223]
    ds_read_b128 a[172:175], v1 offset:26624
    v_rcp_f32 v94, v94
    v_mfma_f32_16x16x32_bf16 v[216:219], a[184:187], a[104:107], v[216:219]
    s_mov_b64 exec, 1
    buffer_atomic_add v28, off, s[4:7], s56 offset:256 sc1
    s_mov_b64 exec, -1
    v_rcp_f32 v95, v95
    v_mfma_f32_16x16x32_bf16 v[216:219], a[188:191], a[120:123], v[216:219]
    v_mul_f32 v204, v204, v92
    v_mul_f32 v205, v205, v93
    v_mul_f32 v206, v206, v94
    v_mfma_f32_16x16x32_bf16 v[212:215], a[184:187], a[100:103], v[212:215]
    v_mul_f32 v207, v207, v95
    v_cvt_pk_bf16_f32 v90, v204, v205
    v_mfma_f32_16x16x32_bf16 v[212:215], a[188:191], a[116:119], v[212:215]
    buffer_load_dwordx4 v[188:191], v6, s[4:7], s77 offen offset:3072
    v_cvt_pk_bf16_f32 v91, v206, v207
    v_nop
    v_mfma_f32_16x16x32_bf16 v[208:211], a[184:187], a[96:99], v[208:211]
    v_permlane16_swap_b32 v88, v90
    v_permlane16_swap_b32 v89, v91
    v_mfma_f32_16x16x32_bf16 v[208:211], a[188:191], a[112:115], v[208:211]
    buffer_store_dwordx4 v[88:91], v7, s[4:7], s38 offen offset:2048 sc1
    s_add_u32 s38, s38, 32768
    v_mfma_f32_16x16x32_bf16 v[112:115], a[160:163], a[0:3], v[112:115]
    ds_read_b128 a[176:179], v1 offset:33792
    v_mul_f32 v96, v8, v96
    v_mfma_f32_16x16x32_bf16 v[112:115], a[164:167], a[16:19], v[112:115]
    ds_read_b128 a[180:183], v1 offset:48128
    v_mul_f32 v97, v8, v97
    v_mfma_f32_16x16x32_bf16 v[116:119], a[160:163], a[4:7], v[116:119]
    v_mul_f32 v98, v8, v98
    v_mul_f32 v99, v8, v99
    v_mfma_f32_16x16x32_bf16 v[116:119], a[164:167], a[20:23], v[116:119]
    v_exp_f32 v96, v96
    v_mfma_f32_16x16x32_bf16 v[120:123], a[160:163], a[8:11], v[120:123]
    v_exp_f32 v97, v97
    v_mfma_f32_16x16x32_bf16 v[120:123], a[164:167], a[24:27], v[120:123]
    s_waitcnt vmcnt(8)
    v_cmp_gt_u32 vcc, s70, v27
    s_nop 1
    s_cbranch_vccnz L_ffn_spin0
L_ffn_go0:
    v_mfma_f32_16x16x32_bf16 v[124:127], a[160:163], a[12:15], v[124:127]
    v_exp_f32 v98, v98
    v_mfma_f32_16x16x32_bf16 v[124:127], a[164:167], a[28:31], v[124:127]
    s_waitcnt lgkmcnt(0)
    s_barrier
    v_exp_f32 v99, v99
    v_mfma_f32_16x16x32_bf16 v[236:239], a[168:171], a[12:15], v[236:239]
    ds_read_b128 a[184:187], v1 offset:40960
    v_fma_f32 v96, v96, v16, v16
    v_mfma_f32_16x16x32_bf16 v[236:239], a[172:175], a[28:31], v[236:239]
    ds_read_b128 a[188:191], v1 offset:55296
    v_fma_f32 v97, v97, v16, v16
    v_fma_f32 v98, v98, v16, v16
    v_mfma_f32_16x16x32_bf16 v[232:235], a[168:171], a[8:11], v[232:235]
    buffer_load_dwordx4 a[192:195], v1, s[4:7], s72 offen offset:0 sc1
    v_fma_f32 v99, v99, v16, v16
    v_mfma_f32_16x16x32_bf16 v[232:235], a[172:175], a[24:27], v[232:235]
    v_rcp_f32 v96, v96
    v_mfma_f32_16x16x32_bf16 v[228:231], a[168:171], a[4:7], v[228:231]
    v_rcp_f32 v97, v97
    v_mfma_f32_16x16x32_bf16 v[228:231], a[172:175], a[20:23], v[228:231]
    v_rcp_f32 v98, v98
    v_mfma_f32_16x16x32_bf16 v[224:227], a[168:171], a[0:3], v[224:227]
    buffer_load_dwordx4 a[196:199], v1, s[4:7], s72 offen offset:1024 sc1
    v_rcp_f32 v99, v99
    v_mfma_f32_16x16x32_bf16 v[224:227], a[172:175], a[16:19], v[224:227]
    v_mul_f32 v208, v208, v96
    v_mfma_f32_16x16x32_bf16 v[112:115], a[176:179], a[32:35], v[112:115]
    ds_read_b128 a[160:163], v2 offset:5120
    v_mul_f32 v209, v209, v97
    v_mul_f32 v210, v210, v98
    v_mfma_f32_16x16x32_bf16 v[112:115], a[180:183], a[48:51], v[112:115]
    ds_read_b128 a[164:167], v2 offset:19456
    v_mul_f32 v211, v211, v99
    v_mfma_f32_16x16x32_bf16 v[116:119], a[176:179], a[36:39], v[116:119]
    v_cvt_pk_bf16_f32 v96, v208, v209
    v_cvt_pk_bf16_f32 v97, v210, v211
    v_mfma_f32_16x16x32_bf16 v[116:119], a[180:183], a[52:55], v[116:119]
    buffer_load_dwordx4 a[200:203], v1, s[4:7], s73 offen offset:0 sc1
    v_mul_f32 v100, v10, v100
    v_mul_f32 v101, v10, v101
    v_mfma_f32_16x16x32_bf16 v[120:123], a[176:179], a[40:43], v[120:123]
    v_mul_f32 v102, v10, v102
    v_mul_f32 v103, v10, v103
    v_mfma_f32_16x16x32_bf16 v[120:123], a[180:183], a[56:59], v[120:123]
    v_exp_f32 v100, v100
    v_mfma_f32_16x16x32_bf16 v[124:127], a[176:179], a[44:47], v[124:127]
    v_exp_f32 v101, v101
    v_mfma_f32_16x16x32_bf16 v[124:127], a[180:183], a[60:63], v[124:127]
    s_waitcnt lgkmcnt(2)
    v_exp_f32 v102, v102
    v_mfma_f32_16x16x32_bf16 v[236:239], a[184:187], a[44:47], v[236:239]
    ds_read_b128 a[168:171], v2 offset:12288
    buffer_load_dwordx4 a[204:207], v1, s[4:7], s73 offen offset:1024 sc1
    v_mfma_f32_16x16x32_bf16 v[236:239], a[188:191], a[60:63], v[236:239]
    ds_read_b128 a[172:175], v2 offset:26624
    v_exp_f32 v103, v103
    v_mfma_f32_16x16x32_bf16 v[232:235], a[184:187], a[40:43], v[232:235]
    v_fma_f32 v100, v100, v17, v17
    v_fma_f32 v101, v101, v17, v17
    v_mfma_f32_16x16x32_bf16 v[232:235], a[188:191], a[56:59], v[232:235]
    v_fma_f32 v102, v102, v17, v17
    v_fma_f32 v103, v103, v17, v17
    v_mfma_f32_16x16x32_bf16 v[228:231], a[184:187], a[36:39], v[228:231]
    v_rcp_f32 v100, v100
    v_mfma_f32_16x16x32_bf16 v[228:231], a[188:191], a[52:55], v[228:231]
    buffer_load_dwordx4 a[224:227], v4, s[4:7], s72 offen offset:0 sc1
    v_rcp_f32 v101, v101
    v_mfma_f32_16x16x32_bf16 v[224:227], a[184:187], a[32:35], v[224:227]
    v_rcp_f32 v102, v102
    v_mfma_f32_16x16x32_bf16 v[224:227], a[188:191], a[48:51], v[224:227]
    s_waitcnt lgkmcnt(2)
    v_rcp_f32 v103, v103
    v_mfma_f32_16x16x32_bf16 v[112:115], a[160:163], a[64:67], v[112:115]
    ds_read_b128 a[176:179], v2 offset:33792
    v_mul_f32 v212, v212, v100
    v_mfma_f32_16x16x32_bf16 v[112:115], a[164:167], a[80:83], v[112:115]
    ds_read_b128 a[180:183], v2 offset:48128
    v_mul_f32 v213, v213, v101
    v_mfma_f32_16x16x32_bf16 v[116:119], a[160:163], a[68:71], v[116:119]
    buffer_load_dwordx4 a[228:231], v4, s[4:7], s72 offen offset:1024 sc1
    v_mul_f32 v214, v214, v102
    v_mul_f32 v215, v215, v103
    v_mfma_f32_16x16x32_bf16 v[116:119], a[164:167], a[84:87], v[116:119]
    v_cvt_pk_bf16_f32 v98, v212, v213
    v_cvt_pk_bf16_f32 v99, v214, v215
    v_mfma_f32_16x16x32_bf16 v[120:123], a[160:163], a[72:75], v[120:123]
    v_nop
    v_permlane16_swap_b32 v96, v98
    v_permlane16_swap_b32 v97, v99
    v_mfma_f32_16x16x32_bf16 v[120:123], a[164:167], a[88:91], v[120:123]
    buffer_store_dwordx4 v[96:99], v7, s[4:7], s38 offen offset:0 sc1
    v_mul_f32 v104, v12, v104
    v_mfma_f32_16x16x32_bf16 v[124:127], a[160:163], a[76:79], v[124:127]
    v_mul_f32 v105, v12, v105
    v_mul_f32 v106, v12, v106
    v_mfma_f32_16x16x32_bf16 v[124:127], a[164:167], a[92:95], v[124:127]
    s_waitcnt lgkmcnt(2)
    buffer_load_dwordx4 a[232:235], v4, s[4:7], s73 offen offset:0 sc1
    v_mul_f32 v107, v12, v107
    v_mfma_f32_16x16x32_bf16 v[236:239], a[168:171], a[76:79], v[236:239]
    ds_read_b128 a[184:187], v2 offset:40960
    v_mfma_f32_16x16x32_bf16 v[236:239], a[172:175], a[92:95], v[236:239]
    ds_read_b128 a[188:191], v2 offset:55296
    v_exp_f32 v104, v104
    v_mfma_f32_16x16x32_bf16 v[232:235], a[168:171], a[72:75], v[232:235]
    v_exp_f32 v105, v105
    v_mfma_f32_16x16x32_bf16 v[232:235], a[172:175], a[88:91], v[232:235]
    v_exp_f32 v106, v106
    v_mfma_f32_16x16x32_bf16 v[228:231], a[168:171], a[68:71], v[228:231]
    buffer_load_dwordx4 a[236:239], v4, s[4:7], s73 offen offset:1024 sc1
    v_exp_f32 v107, v107
    v_mfma_f32_16x16x32_bf16 v[228:231], a[172:175], a[84:87], v[228:231]
    v_fma_f32 v104, v104, v18, v18
    v_fma_f32 v105, v105, v18, v18
    v_mfma_f32_16x16x32_bf16 v[224:227], a[168:171], a[64:67], v[224:227]
    v_fma_f32 v106, v106, v18, v18
    v_fma_f32 v107, v107, v18, v18
    v_mfma_f32_16x16x32_bf16 v[224:227], a[172:175], a[80:83], v[224:227]
    s_waitcnt lgkmcnt(2)
    v_rcp_f32 v104, v104
    v_mfma_f32_16x16x32_bf16 v[112:115], a[176:179], a[96:99], v[112:115]
    ds_read_b128 a[160:163], v1 offset:6144
    v_mfma_f32_16x16x32_bf16 v[112:115], a[180:183], a[112:115], v[112:115]
    ds_read_b128 a[164:167], v1 offset:20480
    buffer_load_dwordx4 v[80:83], v1, s[4:7], s75 offen offset:0 sc1
    v_mfma_f32_16x16x32_bf16 v[116:119], a[176:179], a[100:103], v[116:119]
    v_rcp_f32 v105, v105
    v_mfma_f32_16x16x32_bf16 v[116:119], a[180:183], a[116:119], v[116:119]
    v_rcp_f32 v106, v106
    v_mfma_f32_16x16x32_bf16 v[120:123], a[176:179], a[104:107], v[120:123]
    v_rcp_f32 v107, v107
    v_mul_f32 v216, v216, v104
    v_mfma_f32_16x16x32_bf16 v[120:123], a[180:183], a[120:123], v[120:123]
    v_mul_f32 v217, v217, v105
    v_mul_f32 v218, v218, v106
    v_mfma_f32_16x16x32_bf16 v[124:127], a[176:179], a[108:111], v[124:127]
    buffer_load_dwordx4 v[84:87], v1, s[4:7], s75 offen offset:1024 sc1
    v_mul_f32 v219, v219, v107
    v_cvt_pk_bf16_f32 v104, v216, v217
    v_mfma_f32_16x16x32_bf16 v[124:127], a[180:183], a[124:127], v[124:127]
    s_waitcnt lgkmcnt(2)
    v_cvt_pk_bf16_f32 v105, v218, v219
    v_mfma_f32_16x16x32_bf16 v[236:239], a[184:187], a[108:111], v[236:239]
    ds_read_b128 a[168:171], v1 offset:13312
    v_mul_f32 v108, v14, v108
    v_mfma_f32_16x16x32_bf16 v[236:239], a[188:191], a[124:127], v[236:239]
    ds_read_b128 a[172:175], v1 offset:27648
    v_mul_f32 v109, v14, v109
    v_mul_f32 v110, v14, v110
    v_mfma_f32_16x16x32_bf16 v[232:235], a[184:187], a[104:107], v[232:235]
    v_mul_f32 v111, v14, v111
    v_mfma_f32_16x16x32_bf16 v[232:235], a[188:191], a[120:123], v[232:235]
    buffer_load_dwordx4 v[88:91], v1, s[4:7], s76 offen offset:0 sc1
    v_exp_f32 v108, v108
    v_mfma_f32_16x16x32_bf16 v[228:231], a[184:187], a[100:103], v[228:231]
    v_exp_f32 v109, v109
    v_mfma_f32_16x16x32_bf16 v[228:231], a[188:191], a[116:119], v[228:231]
    v_exp_f32 v110, v110
    v_mfma_f32_16x16x32_bf16 v[224:227], a[184:187], a[96:99], v[224:227]
    v_exp_f32 v111, v111
    v_fma_f32 v108, v108, v19, v19
    v_mfma_f32_16x16x32_bf16 v[224:227], a[188:191], a[112:115], v[224:227]
    s_waitcnt lgkmcnt(2)
    buffer_load_dwordx4 v[92:95], v1, s[4:7], s76 offen offset:1024 sc1
    v_mfma_f32_16x16x32_bf16 v[128:131], a[160:163], a[0:3], v[128:131]
    ds_read_b128 a[176:179], v1 offset:34816
    v_fma_f32 v109, v109, v19, v19
    v_fma_f32 v110, v110, v19, v19
    v_mfma_f32_16x16x32_bf16 v[128:131], a[164:167], a[16:19], v[128:131]
    ds_read_b128 a[180:183], v1 offset:49152
    v_fma_f32 v111, v111, v19, v19
    v_mfma_f32_16x16x32_bf16 v[132:135], a[160:163], a[4:7], v[132:135]
    v_rcp_f32 v108, v108
    v_mfma_f32_16x16x32_bf16 v[132:135], a[164:167], a[20:23], v[132:135]
    v_rcp_f32 v109, v109
    v_mfma_f32_16x16x32_bf16 v[136:139], a[160:163], a[8:11], v[136:139]
    buffer_load_dwordx4 v[192:195], v4, s[4:7], s75 offen offset:0 sc1
    v_rcp_f32 v110, v110
    v_mfma_f32_16x16x32_bf16 v[136:139], a[164:167], a[24:27], v[136:139]
    v_rcp_f32 v111, v111
    v_mfma_f32_16x16x32_bf16 v[140:143], a[160:163], a[12:15], v[140:143]
    v_mul_f32 v220, v220, v108
    v_mul_f32 v221, v221, v109
    v_mul_f32 v222, v222, v110
    v_mfma_f32_16x16x32_bf16 v[140:143], a[164:167], a[28:31], v[140:143]
    s_waitcnt lgkmcnt(2)
    v_mul_f32 v223, v223, v111
    v_mfma_f32_16x16x32_bf16 v[252:255], a[168:171], a[12:15], v[252:255]
    ds_read_b128 a[184:187], v1 offset:41984
    v_cvt_pk_bf16_f32 v106, v220, v221
    v_mfma_f32_16x16x32_bf16 v[252:255], a[172:175], a[28:31], v[252:255]
    ds_read_b128 a[188:191], v1 offset:56320
    buffer_load_dwordx4 v[196:199], v4, s[4:7], s75 offen offset:1024 sc1
    v_cvt_pk_bf16_f32 v107, v222, v223
    v_mfma_f32_16x16x32_bf16 v[248:251], a[168:171], a[8:11], v[248:251]
    v_nop
    v_permlane16_swap_b32 v104, v106
    v_mfma_f32_16x16x32_bf16 v[248:251], a[172:175], a[24:27], v[248:251]
    v_permlane16_swap_b32 v105, v107
    buffer_store_dwordx4 v[104:107], v7, s[4:7], s38 offen offset:2048 sc1
    s_add_u32 s38, s38, 32768
    v_mfma_f32_16x16x32_bf16 v[244:247], a[168:171], a[4:7], v[244:247]
    v_mul_f32 v112, v8, v112
    v_mul_f32 v113, v8, v113
    v_mfma_f32_16x16x32_bf16 v[244:247], a[172:175], a[20:23], v[244:247]
    v_mul_f32 v114, v8, v114
    v_mul_f32 v115, v8, v115
    s_branch L_isl12_over
.p2align 12
L_isl12:
    s_setpc_b64 s[14:15]
L_isl12_over:
    v_mfma_f32_16x16x32_bf16 v[240:243], a[168:171], a[0:3], v[240:243]
    buffer_load_dwordx4 v[200:203], v4, s[4:7], s76 offen offset:0 sc1
    v_exp_f32 v112, v112
    v_mfma_f32_16x16x32_bf16 v[240:243], a[172:175], a[16:19], v[240:243]
    s_waitcnt lgkmcnt(2)
    v_mfma_f32_16x16x32_bf16 v[128:131], a[176:179], a[32:35], v[128:131]
    ds_read_b128 a[160:163], v2 offset:6144
    v_exp_f32 v113, v113
    v_mfma_f32_16x16x32_bf16 v[128:131], a[180:183], a[48:51], v[128:131]
    ds_read_b128 a[164:167], v2 offset:20480
    v_mfma_f32_16x16x32_bf16 v[132:135], a[176:179], a[36:39], v[132:135]
    v_exp_f32 v114, v114
    v_mfma_f32_16x16x32_bf16 v[132:135], a[180:183], a[52:55], v[132:135]
    buffer_load_dwordx4 v[204:207], v4, s[4:7], s76 offen offset:1024 sc1
    v_exp_f32 v115, v115
    v_mfma_f32_16x16x32_bf16 v[136:139], a[176:179], a[40:43], v[136:139]
    v_fma_f32 v112, v112, v16, v16
    v_fma_f32 v113, v113, v16, v16
    v_mfma_f32_16x16x32_bf16 v[136:139], a[180:183], a[56:59], v[136:139]
    v_fma_f32 v114, v114, v16, v16
    v_fma_f32 v115, v115, v16, v16
    v_mfma_f32_16x16x32_bf16 v[140:143], a[176:179], a[44:47], v[140:143]
    v_rcp_f32 v112, v112
    v_mfma_f32_16x16x32_bf16 v[140:143], a[180:183], a[60:63], v[140:143]
    s_waitcnt lgkmcnt(2)
    s_add_u32 m0, s49, 131072
    v_mfma_f32_16x16x32_bf16 v[252:255], a[184:187], a[44:47], v[252:255]
    ds_read_b128 a[168:171], v2 offset:13312
    buffer_load_dwordx4 v1, s[4:7], s46 offen offset:0 sc1 lds
    v_mfma_f32_16x16x32_bf16 v[252:255], a[188:191], a[60:63], v[252:255]
    ds_read_b128 a[172:175], v2 offset:27648
    v_rcp_f32 v113, v113
    v_mfma_f32_16x16x32_bf16 v[248:251], a[184:187], a[40:43], v[248:251]
    v_rcp_f32 v114, v114
    v_mfma_f32_16x16x32_bf16 v[248:251], a[188:191], a[56:59], v[248:251]
    v_rcp_f32 v115, v115
    v_mul_f32 v224, v224, v112
    v_mfma_f32_16x16x32_bf16 v[244:247], a[184:187], a[36:39], v[244:247]
    v_mul_f32 v225, v225, v113
    v_mul_f32 v226, v226, v114
    v_mfma_f32_16x16x32_bf16 v[244:247], a[188:191], a[52:55], v[244:247]
    buffer_load_dwordx4 v1, s[4:7], s46 offen offset:1024 sc1 lds
    s_add_u32 s46, s46, s64
    v_mfma_f32_16x16x32_bf16 v[240:243], a[184:187], a[32:35], v[240:243]
    v_mul_f32 v227, v227, v115
    v_cvt_pk_bf16_f32 v112, v224, v225
    v_cvt_pk_bf16_f32 v113, v226, v227
    v_mfma_f32_16x16x32_bf16 v[240:243], a[188:191], a[48:51], v[240:243]
    s_waitcnt lgkmcnt(2)
    v_mul_f32 v116, v10, v116
    v_mfma_f32_16x16x32_bf16 v[128:131], a[160:163], a[64:67], v[128:131]
    ds_read_b128 a[176:179], v2 offset:34816
    v_mul_f32 v117, v10, v117
    v_mul_f32 v118, v10, v118
    v_mfma_f32_16x16x32_bf16 v[128:131], a[164:167], a[80:83], v[128:131]
    ds_read_b128 a[180:183], v2 offset:49152
    s_add_u32 m0, s49, 139264
    v_mfma_f32_16x16x32_bf16 v[132:135], a[160:163], a[68:71], v[132:135]
    buffer_load_dwordx4 v1, s[4:7], s47 offen offset:0 sc1 lds
    v_mul_f32 v119, v10, v119
    v_mfma_f32_16x16x32_bf16 v[132:135], a[164:167], a[84:87], v[132:135]
    v_exp_f32 v116, v116
    v_mfma_f32_16x16x32_bf16 v[136:139], a[160:163], a[72:75], v[136:139]
    v_exp_f32 v117, v117
    v_mfma_f32_16x16x32_bf16 v[136:139], a[164:167], a[88:91], v[136:139]
    v_exp_f32 v118, v118
    v_mfma_f32_16x16x32_bf16 v[140:143], a[160:163], a[76:79], v[140:143]
    v_exp_f32 v119, v119
    v_fma_f32 v116, v116, v17, v17
    v_mfma_f32_16x16x32_bf16 v[140:143], a[164:167], a[92:95], v[140:143]
    s_waitcnt lgkmcnt(2)
    buffer_load_dwordx4 v1, s[4:7], s47 offen offset:1024 sc1 lds
    s_add_u32 s47, s47, s64
    v_mfma_f32_16x16x32_bf16 v[252:255], a[168:171], a[76:79], v[252:255]
    ds_read_b128 a[184:187], v2 offset:41984
    v_fma_f32 v117, v117, v17, v17
    v_mfma_f32_16x16x32_bf16 v[252:255], a[172:175], a[92:95], v[252:255]
    ds_read_b128 a[188:191], v2 offset:56320
    v_fma_f32 v118, v118, v17, v17
    v_mfma_f32_16x16x32_bf16 v[248:251], a[168:171], a[72:75], v[248:251]
    v_fma_f32 v119, v119, v17, v17
    v_mfma_f32_16x16x32_bf16 v[248:251], a[172:175], a[88:91], v[248:251]
    v_rcp_f32 v116, v116
    v_mfma_f32_16x16x32_bf16 v[244:247], a[168:171], a[68:71], v[244:247]
    v_rcp_f32 v117, v117
    v_mfma_f32_16x16x32_bf16 v[244:247], a[172:175], a[84:87], v[244:247]
    v_rcp_f32 v118, v118
    v_mfma_f32_16x16x32_bf16 v[240:243], a[168:171], a[64:67], v[240:243]
    buffer_load_dword v27, off, s[4:7], s57 offset:256 sc1
    v_rcp_f32 v119, v119
    v_mfma_f32_16x16x32_bf16 v[240:243], a[172:175], a[80:83], v[240:243]
    s_waitcnt lgkmcnt(0)
    s_barrier
    v_mul_f32 v228, v228, v116
    v_mfma_f32_16x16x32_bf16 v[128:131], a[176:179], a[96:99], v[128:131]
    s_add_u32 m0, s49, 98304
    v_mul_f32 v229, v229, v117
    v_mul_f32 v230, v230, v118
    v_mfma_f32_16x16x32_bf16 v[128:131], a[180:183], a[112:115], v[128:131]
    buffer_load_dwordx4 v1, s[4:7], s46 offen offset:0 sc1 lds
    v_mul_f32 v231, v231, v119
    v_mfma_f32_16x16x32_bf16 v[132:135], a[176:179], a[100:103], v[132:135]
    v_cvt_pk_bf16_f32 v114, v228, v229
    v_cvt_pk_bf16_f32 v115, v230, v231
    v_mfma_f32_16x16x32_bf16 v[132:135], a[180:183], a[116:119], v[132:135]
    buffer_load_dwordx4 v1, s[4:7], s46 offen offset:1024 sc1 lds
    s_add_u32 s46, s46, s65
    v_nop
    v_mfma_f32_16x16x32_bf16 v[136:139], a[176:179], a[104:107], v[136:139]
    s_add_u32 m0, s49, 106496
    v_permlane16_swap_b32 v112, v114
    v_mfma_f32_16x16x32_bf16 v[136:139], a[180:183], a[120:123], v[136:139]
    buffer_load_dwordx4 v1, s[4:7], s47 offen offset:0 sc1 lds
    v_permlane16_swap_b32 v113, v115
    buffer_store_dwordx4 v[112:115], v7, s[4:7], s38 offen offset:0 sc1
    v_mfma_f32_16x16x32_bf16 v[140:143], a[176:179], a[108:111], v[140:143]
    v_mul_f32 v120, v12, v120
    v_mul_f32 v121, v12, v121
    v_mfma_f32_16x16x32_bf16 v[140:143], a[180:183], a[124:127], v[140:143]
    buffer_load_dwordx4 v1, s[4:7], s47 offen offset:1024 sc1 lds
    s_add_u32 s47, s47, s65
    v_mfma_f32_16x16x32_bf16 v[252:255], a[184:187], a[108:111], v[252:255]
    s_add_u32 m0, s50, 81920
    v_mul_f32 v122, v12, v122
    v_mfma_f32_16x16x32_bf16 v[252:255], a[188:191], a[124:127], v[252:255]
    buffer_load_dwordx4 v1, s[4:7], s48 offen offset:0 lds
    v_mul_f32 v123, v12, v123
    v_mfma_f32_16x16x32_bf16 v[248:251], a[184:187], a[104:107], v[248:251]
    v_exp_f32 v120, v120
    v_mfma_f32_16x16x32_bf16 v[248:251], a[188:191], a[120:123], v[248:251]
    buffer_load_dwordx4 v1, s[4:7], s48 offen offset:1024 lds
    v_exp_f32 v121, v121
    v_mfma_f32_16x16x32_bf16 v[244:247], a[184:187], a[100:103], v[244:247]
    v_exp_f32 v122, v122
    v_mfma_f32_16x16x32_bf16 v[244:247], a[188:191], a[116:119], v[244:247]
    buffer_load_dwordx4 v1, s[4:7], s48 offen offset:2048 lds
    v_exp_f32 v123, v123
    v_mfma_f32_16x16x32_bf16 v[240:243], a[184:187], a[96:99], v[240:243]
    buffer_load_dwordx4 v1, s[4:7], s48 offen offset:3072 lds
    s_add_u32 s48, s48, s66
    v_mfma_f32_16x16x32_bf16 v[240:243], a[188:191], a[112:115], v[240:243]
    v_fma_f32 v120, v120, v18, v18
    v_fma_f32 v121, v121, v18, v18
    s_waitcnt vmcnt(23)
    v_mfma_f32_16x16x32_bf16 v[32:35], a[208:211], a[192:195], 0
    s_add_u32 m0, s50, 49152
    v_fma_f32 v122, v122, v18, v18
    v_mfma_f32_16x16x32_bf16 v[32:35], a[240:243], a[224:227], v[32:35]
    buffer_load_dwordx4 v1, s[4:7], s48 offen offset:0 lds
    v_fma_f32 v123, v123, v18, v18
    v_mfma_f32_16x16x32_bf16 v[36:39], a[208:211], a[196:199], 0
    v_rcp_f32 v120, v120
    v_mfma_f32_16x16x32_bf16 v[36:39], a[240:243], a[228:231], v[36:39]
    v_rcp_f32 v121, v121
    v_mfma_f32_16x16x32_bf16 v[40:43], a[208:211], a[200:203], 0
    v_rcp_f32 v122, v122
    v_mfma_f32_16x16x32_bf16 v[40:43], a[240:243], a[232:235], v[40:43]
    buffer_load_dwordx4 v1, s[4:7], s48 offen offset:1024 lds
    v_rcp_f32 v123, v123
    v_mfma_f32_16x16x32_bf16 v[44:47], a[208:211], a[204:207], 0
    v_mul_f32 v232, v232, v120
    v_mul_f32 v233, v233, v121
    v_mfma_f32_16x16x32_bf16 v[44:47], a[240:243], a[236:239], v[44:47]
    v_mul_f32 v234, v234, v122
    v_mul_f32 v235, v235, v123
    v_mfma_f32_16x16x32_bf16 v[60:63], a[212:215], a[204:207], 0
    v_cvt_pk_bf16_f32 v120, v232, v233
    v_cvt_pk_bf16_f32 v121, v234, v235
    v_mul_f32 v124, v14, v124
    v_mfma_f32_16x16x32_bf16 v[60:63], a[244:247], a[236:239], v[60:63]
    buffer_load_dwordx4 v1, s[4:7], s48 offen offset:2048 lds
    v_mul_f32 v125, v14, v125
    v_mfma_f32_16x16x32_bf16 v[56:59], a[212:215], a[200:203], 0
    v_mul_f32 v126, v14, v126
    v_mul_f32 v127, v14, v127
    v_mfma_f32_16x16x32_bf16 v[56:59], a[244:247], a[232:235], v[56:59]
    v_exp_f32 v124, v124
    v_mfma_f32_16x16x32_bf16 v[52:55], a[212:215], a[196:199], 0
    v_exp_f32 v125, v125
    v_mfma_f32_16x16x32_bf16 v[52:55], a[244:247], a[228:231], v[52:55]
    buffer_load_dwordx4 v1, s[4:7], s48 offen offset:3072 lds
    s_add_u32 s48, s48, s67
    v_mfma_f32_16x16x32_bf16 v[48:51], a[212:215], a[192:195], 0
    v_exp_f32 v126, v126
    v_mfma_f32_16x16x32_bf16 v[48:51], a[244:247], a[224:227], v[48:51]
    v_exp_f32 v127, v127
    v_fma_f32 v124, v124, v19, v19
    v_mfma_f32_16x16x32_bf16 v[144:147], a[216:219], a[192:195], 0
    v_fma_f32 v125, v125, v19, v19
    v_fma_f32 v126, v126, v19, v19
    v_mfma_f32_16x16x32_bf16 v[144:147], a[248:251], a[224:227], v[144:147]
    s_waitcnt vmcnt(13)
    v_cmp_gt_u32 vcc, s70, v27
    s_nop 1
    s_cbranch_vccnz L_ffn_spin1
L_ffn_go1:
    v_mfma_f32_16x16x32_bf16 v[148:151], a[216:219], a[196:199], 0
    v_fma_f32 v127, v127, v19, v19
    v_rcp_f32 v124, v124
    v_mfma_f32_16x16x32_bf16 v[148:151], a[248:251], a[228:231], v[148:151]
    v_rcp_f32 v125, v125
    v_mfma_f32_16x16x32_bf16 v[152:155], a[216:219], a[200:203], 0
    v_rcp_f32 v126, v126
    v_mfma_f32_16x16x32_bf16 v[152:155], a[248:251], a[232:235], v[152:155]
    v_rcp_f32 v127, v127
    v_mfma_f32_16x16x32_bf16 v[156:159], a[216:219], a[204:207], 0
    v_mul_f32 v236, v236, v124
    v_mul_f32 v237, v237, v125
    v_mul_f32 v238, v238, v126
    v_mfma_f32_16x16x32_bf16 v[156:159], a[248:251], a[236:239], v[156:159]
    v_mul_f32 v239, v239, v127
    v_cvt_pk_bf16_f32 v122, v236, v237
    v_mfma_f32_16x16x32_bf16 v[172:175], a[220:223], a[204:207], 0
    v_cvt_pk_bf16_f32 v123, v238, v239
    v_nop
    v_mfma_f32_16x16x32_bf16 v[172:175], a[252:255], a[236:239], v[172:175]
    v_permlane16_swap_b32 v120, v122
    v_permlane16_swap_b32 v121, v123
    v_mfma_f32_16x16x32_bf16 v[168:171], a[220:223], a[200:203], 0
    buffer_store_dwordx4 v[120:123], v7, s[4:7], s38 offen offset:2048 sc1
    s_add_u32 s38, s38, 32768
    v_mul_f32 v128, v8, v128
    v_mfma_f32_16x16x32_bf16 v[168:171], a[252:255], a[232:235], v[168:171]
    v_mul_f32 v129, v8, v129
    v_mul_f32 v130, v8, v130
    v_mfma_f32_16x16x32_bf16 v[164:167], a[220:223], a[196:199], 0
    v_mul_f32 v131, v8, v131
    v_mfma_f32_16x16x32_bf16 v[164:167], a[252:255], a[228:231], v[164:167]
    v_exp_f32 v128, v128
    v_mfma_f32_16x16x32_bf16 v[160:163], a[220:223], a[192:195], 0
    v_exp_f32 v129, v129
    v_mfma_f32_16x16x32_bf16 v[160:163], a[252:255], a[224:227], v[160:163]
    v_exp_f32 v130, v130
    s_barrier
    v_mfma_f32_16x16x32_bf16 v[32:35], v[64:67], v[80:83], v[32:35]
    ds_read_b128 a[192:195], v22 offset:0
    s_add_u32 m0, s49, 65536
    v_mfma_f32_16x16x32_bf16 v[32:35], v[176:179], v[192:195], v[32:35]
    buffer_load_dwordx4 v1, s[4:7], s46 offen offset:0 sc1 lds
    v_mfma_f32_16x16x32_bf16 v[36:39], v[64:67], v[84:87], v[36:39]
    ds_read_b128 a[196:199], v22 offset:1024
    v_exp_f32 v131, v131
    v_mfma_f32_16x16x32_bf16 v[36:39], v[176:179], v[196:199], v[36:39]
    ds_read_b128 a[200:203], v22 offset:8192
    v_fma_f32 v128, v128, v16, v16
    v_mfma_f32_16x16x32_bf16 v[40:43], v[64:67], v[88:91], v[40:43]
    ds_read_b128 a[204:207], v22 offset:9216
    v_fma_f32 v129, v129, v16, v16
    v_mfma_f32_16x16x32_bf16 v[40:43], v[176:179], v[200:203], v[40:43]
    buffer_load_dwordx4 v1, s[4:7], s46 offen offset:1024 sc1 lds
    s_add_u32 s46, s46, s62
    v_fma_f32 v130, v130, v16, v16
    v_mfma_f32_16x16x32_bf16 v[44:47], v[64:67], v[92:95], v[44:47]
    ds_read_b128 a[208:211], v26 offset:0
    v_fma_f32 v131, v131, v16, v16
    v_mfma_f32_16x16x32_bf16 v[44:47], v[176:179], v[204:207], v[44:47]
    ds_read_b128 a[212:215], v26 offset:1024
    v_mfma_f32_16x16x32_bf16 v[60:63], v[68:71], v[92:95], v[60:63]
    ds_read_b128 a[216:219], v26 offset:2048
    s_add_u32 m0, s49, 73728
    v_mfma_f32_16x16x32_bf16 v[60:63], v[180:183], v[204:207], v[60:63]
    buffer_load_dwordx4 v1, s[4:7], s47 offen offset:0 sc1 lds
    v_rcp_f32 v128, v128
    v_mfma_f32_16x16x32_bf16 v[56:59], v[68:71], v[88:91], v[56:59]
    ds_read_b128 a[220:223], v26 offset:3072
    v_mfma_f32_16x16x32_bf16 v[56:59], v[180:183], v[200:203], v[56:59]
    ds_read_b128 a[224:227], v22 offset:4096
    v_rcp_f32 v129, v129
    v_mfma_f32_16x16x32_bf16 v[52:55], v[68:71], v[84:87], v[52:55]
    ds_read_b128 a[228:231], v22 offset:5120
    v_mfma_f32_16x16x32_bf16 v[52:55], v[180:183], v[196:199], v[52:55]
    buffer_load_dwordx4 v1, s[4:7], s47 offen offset:1024 sc1 lds
    s_add_u32 s47, s47, s62
    v_mfma_f32_16x16x32_bf16 v[48:51], v[68:71], v[80:83], v[48:51]
    ds_read_b128 a[232:235], v22 offset:12288
    v_rcp_f32 v130, v130
    v_mfma_f32_16x16x32_bf16 v[48:51], v[180:183], v[192:195], v[48:51]
    ds_read_b128 a[236:239], v22 offset:13312
    v_mfma_f32_16x16x32_bf16 v[144:147], v[72:75], v[80:83], v[144:147]
    ds_read_b128 a[240:243], v26 offset:8192
    s_add_u32 m0, s49, 32768
    v_mfma_f32_16x16x32_bf16 v[144:147], v[184:187], v[192:195], v[144:147]
    buffer_load_dwordx4 v1, s[4:7], s46 offen offset:0 sc1 lds
    v_rcp_f32 v131, v131
    v_mfma_f32_16x16x32_bf16 v[148:151], v[72:75], v[84:87], v[148:151]
    ds_read_b128 a[244:247], v26 offset:9216
    v_mul_f32 v240, v240, v128
    v_mfma_f32_16x16x32_bf16 v[148:151], v[184:187], v[196:199], v[148:151]
    ds_read_b128 a[248:251], v26 offset:10240
    v_mul_f32 v241, v241, v129
    v_mfma_f32_16x16x32_bf16 v[152:155], v[72:75], v[88:91], v[152:155]
    ds_read_b128 a[252:255], v26 offset:11264
    v_mul_f32 v242, v242, v130
    v_mul_f32 v243, v243, v131
    v_mfma_f32_16x16x32_bf16 v[152:155], v[184:187], v[200:203], v[152:155]
    buffer_load_dwordx4 v1, s[4:7], s46 offen offset:1024 sc1 lds
    s_add_u32 s46, s46, s63
    v_mfma_f32_16x16x32_bf16 v[156:159], v[72:75], v[92:95], v[156:159]
    v_cvt_pk_bf16_f32 v128, v240, v241
    v_cvt_pk_bf16_f32 v129, v242, v243
    v_mfma_f32_16x16x32_bf16 v[156:159], v[184:187], v[204:207], v[156:159]
    v_mul_f32 v132, v10, v132
    v_mul_f32 v133, v10, v133
    v_mfma_f32_16x16x32_bf16 v[172:175], v[76:79], v[92:95], v[172:175]
    s_add_u32 m0, s49, 40960
    v_mul_f32 v134, v10, v134
    v_mul_f32 v135, v10, v135
    v_mfma_f32_16x16x32_bf16 v[172:175], v[188:191], v[204:207], v[172:175]
    buffer_load_dwordx4 v1, s[4:7], s47 offen offset:0 sc1 lds
    v_mfma_f32_16x16x32_bf16 v[168:171], v[76:79], v[88:91], v[168:171]
    v_exp_f32 v132, v132
    v_mfma_f32_16x16x32_bf16 v[168:171], v[188:191], v[200:203], v[168:171]
    v_exp_f32 v133, v133
    v_mfma_f32_16x16x32_bf16 v[164:167], v[76:79], v[84:87], v[164:167]
    v_exp_f32 v134, v134
    v_mfma_f32_16x16x32_bf16 v[164:167], v[188:191], v[196:199], v[164:167]
    v_exp_f32 v135, v135
    v_fma_f32 v132, v132, v17, v17
    v_mfma_f32_16x16x32_bf16 v[160:163], v[76:79], v[80:83], v[160:163]
    v_fma_f32 v133, v133, v17, v17
    v_fma_f32 v134, v134, v17, v17
    v_mfma_f32_16x16x32_bf16 v[160:163], v[188:191], v[192:195], v[160:163]
    v_fma_f32 v135, v135, v17, v17
    s_waitcnt vmcnt(16) lgkmcnt(0)
    s_barrier
    v_mfma_f32_16x16x32_bf16 v[32:35], a[208:211], a[192:195], v[32:35]
    ds_read_b128 a[0:3], v21 offset:32768
    buffer_load_dwordx4 v1, s[4:7], s47 offen offset:1024 sc1 lds
    s_add_u32 s47, s47, s63
    v_mfma_f32_16x16x32_bf16 v[32:35], a[240:243], a[224:227], v[32:35]
    v_mfma_f32_16x16x32_bf16 v[36:39], a[208:211], a[196:199], v[36:39]
    ds_read_b128 a[4:7], v21 offset:33792
    s_add_u32 m0, s49, 0
    v_mfma_f32_16x16x32_bf16 v[36:39], a[240:243], a[228:231], v[36:39]
    ds_read_b128 a[8:11], v21 offset:40960
    buffer_load_dwordx4 v1, s[4:7], s46 offen offset:0 sc1 lds
    v_mfma_f32_16x16x32_bf16 v[40:43], a[208:211], a[200:203], v[40:43]
    ds_read_b128 a[12:15], v21 offset:41984
    v_rcp_f32 v132, v132
    v_mfma_f32_16x16x32_bf16 v[40:43], a[240:243], a[232:235], v[40:43]
    v_rcp_f32 v133, v133
    v_mfma_f32_16x16x32_bf16 v[44:47], a[208:211], a[204:207], v[44:47]
    ds_read_b128 a[16:19], v25 offset:32768
    v_mfma_f32_16x16x32_bf16 v[44:47], a[240:243], a[236:239], v[44:47]
    ds_read_b128 a[20:23], v25 offset:33792
    s_mov_b64 exec, 1
    buffer_atomic_add v28, off, s[4:7], s56 offset:512 sc1
    s_mov_b64 exec, -1
    v_mfma_f32_16x16x32_bf16 v[60:63], a[212:215], a[204:207], v[60:63]
    ds_read_b128 a[24:27], v25 offset:34816
    v_rcp_f32 v134, v134
    v_mfma_f32_16x16x32_bf16 v[60:63], a[244:247], a[236:239], v[60:63]
    v_rcp_f32 v135, v135
    v_mfma_f32_16x16x32_bf16 v[56:59], a[212:215], a[200:203], v[56:59]
    ds_read_b128 a[28:31], v25 offset:35840
    buffer_load_dwordx4 v1, s[4:7], s46 offen offset:1024 sc1 lds
    s_add_u32 s46, s46, s64
    v_mfma_f32_16x16x32_bf16 v[56:59], a[244:247], a[232:235], v[56:59]
    ds_read_b128 a[32:35], v21 offset:36864
    v_mul_f32 v244, v244, v132
    v_mfma_f32_16x16x32_bf16 v[52:55], a[212:215], a[196:199], v[52:55]
    ds_read_b128 a[36:39], v21 offset:37888
    v_mul_f32 v245, v245, v133
    v_mfma_f32_16x16x32_bf16 v[52:55], a[244:247], a[228:231], v[52:55]
    s_add_u32 m0, s49, 8192
    v_mul_f32 v246, v246, v134
    v_mfma_f32_16x16x32_bf16 v[48:51], a[212:215], a[192:195], v[48:51]
    ds_read_b128 a[40:43], v21 offset:45056
    buffer_load_dwordx4 v1, s[4:7], s47 offen offset:0 sc1 lds
    v_mfma_f32_16x16x32_bf16 v[48:51], a[244:247], a[224:227], v[48:51]
    ds_read_b128 a[44:47], v21 offset:46080
    v_mul_f32 v247, v247, v135
    v_cvt_pk_bf16_f32 v130, v244, v245
    v_mfma_f32_16x16x32_bf16 v[144:147], a[216:219], a[192:195], v[144:147]
    ds_read_b128 a[48:51], v25 offset:40960
    v_cvt_pk_bf16_f32 v131, v246, v247
    v_mfma_f32_16x16x32_bf16 v[144:147], a[248:251], a[224:227], v[144:147]
    buffer_load_dwordx4 v1, s[4:7], s47 offen offset:1024 sc1 lds
    s_add_u32 s47, s47, s64
    v_mfma_f32_16x16x32_bf16 v[148:151], a[216:219], a[196:199], v[148:151]
    ds_read_b128 a[52:55], v25 offset:41984
    v_nop
    v_mfma_f32_16x16x32_bf16 v[148:151], a[248:251], a[228:231], v[148:151]
    ds_read_b128 a[56:59], v25 offset:43008
    v_permlane16_swap_b32 v128, v130
    v_permlane16_swap_b32 v129, v131
    v_mfma_f32_16x16x32_bf16 v[152:155], a[216:219], a[200:203], v[152:155]
    ds_read_b128 a[60:63], v25 offset:44032
    s_add_u32 m0, s50, 16384
    v_mfma_f32_16x16x32_bf16 v[152:155], a[248:251], a[232:235], v[152:155]
    buffer_load_dwordx4 v1, s[4:7], s48 offen offset:0 lds
    buffer_store_dwordx4 v[128:131], v7, s[4:7], s39 offen offset:0 sc1
    v_mfma_f32_16x16x32_bf16 v[156:159], a[216:219], a[204:207], v[156:159]
    v_mul_f32 v136, v12, v136
    v_mul_f32 v137, v12, v137
    v_mfma_f32_16x16x32_bf16 v[156:159], a[248:251], a[236:239], v[156:159]
    v_mul_f32 v138, v12, v138
    v_mul_f32 v139, v12, v139
    v_mfma_f32_16x16x32_bf16 v[172:175], a[220:223], a[204:207], v[172:175]
    buffer_load_dwordx4 v1, s[4:7], s48 offen offset:1024 lds
    v_exp_f32 v136, v136
    v_mfma_f32_16x16x32_bf16 v[172:175], a[252:255], a[236:239], v[172:175]
    v_exp_f32 v137, v137
    v_mfma_f32_16x16x32_bf16 v[168:171], a[220:223], a[200:203], v[168:171]
    v_exp_f32 v138, v138
    v_mfma_f32_16x16x32_bf16 v[168:171], a[252:255], a[232:235], v[168:171]
    v_exp_f32 v139, v139
    v_fma_f32 v136, v136, v18, v18
    v_mfma_f32_16x16x32_bf16 v[164:167], a[220:223], a[196:199], v[164:167]
    buffer_load_dwordx4 v1, s[4:7], s48 offen offset:2048 lds
    v_fma_f32 v137, v137, v18, v18
    v_mfma_f32_16x16x32_bf16 v[164:167], a[252:255], a[228:231], v[164:167]
    v_fma_f32 v138, v138, v18, v18
    v_fma_f32 v139, v139, v18, v18
    v_mfma_f32_16x16x32_bf16 v[160:163], a[220:223], a[192:195], v[160:163]
    v_rcp_f32 v136, v136
    v_mfma_f32_16x16x32_bf16 v[160:163], a[252:255], a[224:227], v[160:163]
    v_rcp_f32 v137, v137
    s_waitcnt vmcnt(13) lgkmcnt(0)
    s_barrier
    v_mfma_f32_16x16x32_bf16 v[32:35], a[16:19], a[0:3], v[32:35]
    ds_read_b128 a[192:195], v21 offset:0
    v_mfma_f32_16x16x32_bf16 v[32:35], a[48:51], a[32:35], v[32:35]
    buffer_load_dwordx4 v1, s[4:7], s48 offen offset:3072 lds
    s_add_u32 s48, s48, s68
    v_mfma_f32_16x16x32_bf16 v[36:39], a[16:19], a[4:7], v[36:39]
    ds_read_b128 a[196:199], v21 offset:1024
    v_rcp_f32 v138, v138
    v_mfma_f32_16x16x32_bf16 v[36:39], a[48:51], a[36:39], v[36:39]
    ds_read_b128 a[200:203], v21 offset:8192
    v_mfma_f32_16x16x32_bf16 v[40:43], a[16:19], a[8:11], v[40:43]
    ds_read_b128 a[204:207], v21 offset:9216
    s_add_u32 m0, s49, 131072
    v_mfma_f32_16x16x32_bf16 v[40:43], a[48:51], a[40:43], v[40:43]
    buffer_load_dwordx4 v1, s[4:7], s46 offen offset:0 sc1 lds
    v_rcp_f32 v139, v139
    v_mfma_f32_16x16x32_bf16 v[44:47], a[16:19], a[12:15], v[44:47]
    ds_read_b128 a[208:211], v25 offset:0
    v_mul_f32 v248, v248, v136
    v_mfma_f32_16x16x32_bf16 v[44:47], a[48:51], a[44:47], v[44:47]
    ds_read_b128 a[212:215], v25 offset:1024
    v_mul_f32 v249, v249, v137
    v_mfma_f32_16x16x32_bf16 v[60:63], a[20:23], a[12:15], v[60:63]
    ds_read_b128 a[216:219], v25 offset:2048
    v_mul_f32 v250, v250, v138
    v_mul_f32 v251, v251, v139
    v_mfma_f32_16x16x32_bf16 v[60:63], a[52:55], a[44:47], v[60:63]
    buffer_load_dwordx4 v1, s[4:7], s46 offen offset:1024 sc1 lds
    s_add_u32 s46, s46, s65
    v_mfma_f32_16x16x32_bf16 v[56:59], a[20:23], a[8:11], v[56:59]
    ds_read_b128 a[220:223], v25 offset:3072
    v_cvt_pk_bf16_f32 v136, v248, v249
    v_mfma_f32_16x16x32_bf16 v[56:59], a[52:55], a[40:43], v[56:59]
    ds_read_b128 a[224:227], v21 offset:4096
    v_cvt_pk_bf16_f32 v137, v250, v251
    v_mfma_f32_16x16x32_bf16 v[52:55], a[20:23], a[4:7], v[52:55]
    ds_read_b128 a[228:231], v21 offset:5120
    s_add_u32 m0, s49, 139264
    v_mul_f32 v140, v14, v140
    v_mfma_f32_16x16x32_bf16 v[52:55], a[52:55], a[36:39], v[52:55]
    buffer_load_dwordx4 v1, s[4:7], s47 offen offset:0 sc1 lds
    v_mul_f32 v141, v14, v141
    v_mfma_f32_16x16x32_bf16 v[48:51], a[20:23], a[0:3], v[48:51]
    ds_read_b128 a[232:235], v21 offset:12288
    v_mul_f32 v142, v14, v142
    v_mfma_f32_16x16x32_bf16 v[48:51], a[52:55], a[32:35], v[48:51]
    ds_read_b128 a[236:239], v21 offset:13312
    v_mul_f32 v143, v14, v143
    v_mfma_f32_16x16x32_bf16 v[144:147], a[24:27], a[0:3], v[144:147]
    ds_read_b128 a[240:243], v25 offset:8192
    v_exp_f32 v140, v140
    v_mfma_f32_16x16x32_bf16 v[144:147], a[56:59], a[32:35], v[144:147]
    buffer_load_dwordx4 v1, s[4:7], s47 offen offset:1024 sc1 lds
    s_add_u32 s47, s47, s65
    v_mfma_f32_16x16x32_bf16 v[148:151], a[24:27], a[4:7], v[148:151]
    ds_read_b128 a[244:247], v25 offset:9216
    v_mfma_f32_16x16x32_bf16 v[148:151], a[56:59], a[36:39], v[148:151]
    ds_read_b128 a[248:251], v25 offset:10240
    v_exp_f32 v141, v141
    v_mfma_f32_16x16x32_bf16 v[152:155], a[24:27], a[8:11], v[152:155]
    ds_read_b128 a[252:255], v25 offset:11264
    s_add_u32 m0, s50, 147456
    v_mfma_f32_16x16x32_bf16 v[152:155], a[56:59], a[40:43], v[152:155]
    buffer_load_dwordx4 v1, s[4:7], s48 offen offset:0 lds
    v_mfma_f32_16x16x32_bf16 v[156:159], a[24:27], a[12:15], v[156:159]
    v_exp_f32 v142, v142
    v_mfma_f32_16x16x32_bf16 v[156:159], a[56:59], a[44:47], v[156:159]
    v_exp_f32 v143, v143
    v_fma_f32 v140, v140, v19, v19
    v_mfma_f32_16x16x32_bf16 v[172:175], a[28:31], a[12:15], v[172:175]
    v_fma_f32 v141, v141, v19, v19
    v_fma_f32 v142, v142, v19, v19
    v_mfma_f32_16x16x32_bf16 v[172:175], a[60:63], a[44:47], v[172:175]
    buffer_load_dwordx4 v1, s[4:7], s48 offen offset:1024 lds
    v_fma_f32 v143, v143, v19, v19
    v_mfma_f32_16x16x32_bf16 v[168:171], a[28:31], a[8:11], v[168:171]
    v_rcp_f32 v140, v140
    v_mfma_f32_16x16x32_bf16 v[168:171], a[60:63], a[40:43], v[168:171]
    v_rcp_f32 v141, v141
    v_mfma_f32_16x16x32_bf16 v[164:167], a[28:31], a[4:7], v[164:167]
    v_rcp_f32 v142, v142
    v_mfma_f32_16x16x32_bf16 v[164:167], a[60:63], a[36:39], v[164:167]
    buffer_load_dwordx4 v1, s[4:7], s48 offen offset:2048 lds
    v_rcp_f32 v143, v143
    v_mfma_f32_16x16x32_bf16 v[160:163], a[28:31], a[0:3], v[160:163]
    v_mul_f32 v252, v252, v140
    v_mul_f32 v253, v253, v141
    v_mfma_f32_16x16x32_bf16 v[160:163], a[60:63], a[32:35], v[160:163]
    v_mul_f32 v254, v254, v142
    v_mul_f32 v255, v255, v143
    s_branch L_isl13_over
.p2align 12
L_isl13:
    s_setpc_b64 s[14:15]
L_isl13_over:
    s_waitcnt vmcnt(17) lgkmcnt(0)
    s_barrier
    v_mfma_f32_16x16x32_bf16 v[32:35], a[208:211], a[192:195], v[32:35]
    ds_read_b128 a[0:3], v20 offset:32768
    v_cvt_pk_bf16_f32 v138, v252, v253
    v_mfma_f32_16x16x32_bf16 v[32:35], a[240:243], a[224:227], v[32:35]
    buffer_load_dwordx4 v1, s[4:7], s48 offen offset:3072 lds
    s_add_u32 s48, s48, s69
    v_mfma_f32_16x16x32_bf16 v[36:39], a[208:211], a[196:199], v[36:39]
    ds_read_b128 a[4:7], v20 offset:33792
    v_cvt_pk_bf16_f32 v139, v254, v255
    v_mfma_f32_16x16x32_bf16 v[36:39], a[240:243], a[228:231], v[36:39]
    ds_read_b128 a[8:11], v20 offset:40960
    v_nop
    v_permlane16_swap_b32 v136, v138
    v_mfma_f32_16x16x32_bf16 v[40:43], a[208:211], a[200:203], v[40:43]
    ds_read_b128 a[12:15], v20 offset:41984
    s_add_u32 m0, s49, 98304
    v_mfma_f32_16x16x32_bf16 v[40:43], a[240:243], a[232:235], v[40:43]
    buffer_load_dwordx4 v1, s[4:7], s46 offen offset:0 sc1 lds
    v_permlane16_swap_b32 v137, v139
    v_mfma_f32_16x16x32_bf16 v[44:47], a[208:211], a[204:207], v[44:47]
    ds_read_b128 a[16:19], v24 offset:32768
    buffer_store_dwordx4 v[136:139], v7, s[4:7], s39 offen offset:2048 sc1
    v_mfma_f32_16x16x32_bf16 v[44:47], a[240:243], a[236:239], v[44:47]
    ds_read_b128 a[20:23], v24 offset:33792
    s_add_u32 s39, s39, 32768
    v_mfma_f32_16x16x32_bf16 v[60:63], a[212:215], a[204:207], v[60:63]
    ds_read_b128 a[24:27], v24 offset:34816
    v_mfma_f32_16x16x32_bf16 v[60:63], a[244:247], a[236:239], v[60:63]
    buffer_load_dwordx4 v1, s[4:7], s46 offen offset:1024 sc1 lds
    s_add_u32 s46, s46, s62
    v_mfma_f32_16x16x32_bf16 v[56:59], a[212:215], a[200:203], v[56:59]
    ds_read_b128 a[28:31], v24 offset:35840
    v_mfma_f32_16x16x32_bf16 v[56:59], a[244:247], a[232:235], v[56:59]
    ds_read_b128 a[32:35], v20 offset:36864
    v_mfma_f32_16x16x32_bf16 v[52:55], a[212:215], a[196:199], v[52:55]
    ds_read_b128 a[36:39], v20 offset:37888
    s_add_u32 m0, s49, 106496
    v_mfma_f32_16x16x32_bf16 v[52:55], a[244:247], a[228:231], v[52:55]
    buffer_load_dwordx4 v1, s[4:7], s47 offen offset:0 sc1 lds
    v_mfma_f32_16x16x32_bf16 v[48:51], a[212:215], a[192:195], v[48:51]
    ds_read_b128 a[40:43], v20 offset:45056
    v_mfma_f32_16x16x32_bf16 v[48:51], a[244:247], a[224:227], v[48:51]
    ds_read_b128 a[44:47], v20 offset:46080
    v_mfma_f32_16x16x32_bf16 v[144:147], a[216:219], a[192:195], v[144:147]
    ds_read_b128 a[48:51], v24 offset:40960
    v_mfma_f32_16x16x32_bf16 v[144:147], a[248:251], a[224:227], v[144:147]
    buffer_load_dwordx4 v1, s[4:7], s47 offen offset:1024 sc1 lds
    s_add_u32 s47, s47, s62
    v_mfma_f32_16x16x32_bf16 v[148:151], a[216:219], a[196:199], v[148:151]
    ds_read_b128 a[52:55], v24 offset:41984
    v_mfma_f32_16x16x32_bf16 v[148:151], a[248:251], a[228:231], v[148:151]
    ds_read_b128 a[56:59], v24 offset:43008
    v_mfma_f32_16x16x32_bf16 v[152:155], a[216:219], a[200:203], v[152:155]
    ds_read_b128 a[60:63], v24 offset:44032
    s_add_u32 m0, s50, 114688
    v_mfma_f32_16x16x32_bf16 v[152:155], a[248:251], a[232:235], v[152:155]
    buffer_load_dwordx4 v1, s[4:7], s48 offen offset:0 lds
    v_mfma_f32_16x16x32_bf16 v[156:159], a[216:219], a[204:207], v[156:159]
    v_mfma_f32_16x16x32_bf16 v[156:159], a[248:251], a[236:239], v[156:159]
    v_mfma_f32_16x16x32_bf16 v[172:175], a[220:223], a[204:207], v[172:175]
    v_mfma_f32_16x16x32_bf16 v[172:175], a[252:255], a[236:239], v[172:175]
    buffer_load_dwordx4 v1, s[4:7], s48 offen offset:1024 lds
    v_mfma_f32_16x16x32_bf16 v[168:171], a[220:223], a[200:203], v[168:171]
    v_mfma_f32_16x16x32_bf16 v[168:171], a[252:255], a[232:235], v[168:171]
    v_mfma_f32_16x16x32_bf16 v[164:167], a[220:223], a[196:199], v[164:167]
    v_mfma_f32_16x16x32_bf16 v[164:167], a[252:255], a[228:231], v[164:167]
    v_mfma_f32_16x16x32_bf16 v[160:163], a[220:223], a[192:195], v[160:163]
    v_mfma_f32_16x16x32_bf16 v[160:163], a[252:255], a[224:227], v[160:163]
    s_waitcnt vmcnt(15) lgkmcnt(0)
    s_barrier
    v_mfma_f32_16x16x32_bf16 v[32:35], a[16:19], a[0:3], v[32:35]
    ds_read_b128 a[192:195], v20 offset:0
    v_mfma_f32_16x16x32_bf16 v[32:35], a[48:51], a[32:35], v[32:35]
    buffer_load_dwordx4 v1, s[4:7], s48 offen offset:2048 lds
    v_mfma_f32_16x16x32_bf16 v[36:39], a[16:19], a[4:7], v[36:39]
    ds_read_b128 a[196:199], v20 offset:1024
    v_mfma_f32_16x16x32_bf16 v[36:39], a[48:51], a[36:39], v[36:39]
    ds_read_b128 a[200:203], v20 offset:8192
    v_mfma_f32_16x16x32_bf16 v[40:43], a[16:19], a[8:11], v[40:43]
    ds_read_b128 a[204:207], v20 offset:9216
    v_mfma_f32_16x16x32_bf16 v[40:43], a[48:51], a[40:43], v[40:43]
    buffer_load_dwordx4 v1, s[4:7], s48 offen offset:3072 lds
    s_add_u32 s48, s48, s66
    v_mfma_f32_16x16x32_bf16 v[44:47], a[16:19], a[12:15], v[44:47]
    ds_read_b128 a[208:211], v24 offset:0
    v_mfma_f32_16x16x32_bf16 v[44:47], a[48:51], a[44:47], v[44:47]
    ds_read_b128 a[212:215], v24 offset:1024
    v_mfma_f32_16x16x32_bf16 v[60:63], a[20:23], a[12:15], v[60:63]
    ds_read_b128 a[216:219], v24 offset:2048
    s_add_u32 m0, s49, 65536
    v_mfma_f32_16x16x32_bf16 v[60:63], a[52:55], a[44:47], v[60:63]
    buffer_load_dwordx4 v1, s[4:7], s46 offen offset:0 sc1 lds
    v_mfma_f32_16x16x32_bf16 v[56:59], a[20:23], a[8:11], v[56:59]
    ds_read_b128 a[220:223], v24 offset:3072
    v_mfma_f32_16x16x32_bf16 v[56:59], a[52:55], a[40:43], v[56:59]
    ds_read_b128 a[224:227], v20 offset:4096
    v_mfma_f32_16x16x32_bf16 v[52:55], a[20:23], a[4:7], v[52:55]
    ds_read_b128 a[228:231], v20 offset:5120
    v_mfma_f32_16x16x32_bf16 v[52:55], a[52:55], a[36:39], v[52:55]
    buffer_load_dwordx4 v1, s[4:7], s46 offen offset:1024 sc1 lds
    s_add_u32 s46, s46, s63
    v_mfma_f32_16x16x32_bf16 v[48:51], a[20:23], a[0:3], v[48:51]
    ds_read_b128 a[232:235], v20 offset:12288
    v_mfma_f32_16x16x32_bf16 v[48:51], a[52:55], a[32:35], v[48:51]
    ds_read_b128 a[236:239], v20 offset:13312
    v_mfma_f32_16x16x32_bf16 v[144:147], a[24:27], a[0:3], v[144:147]
    ds_read_b128 a[240:243], v24 offset:8192
    s_add_u32 m0, s49, 73728
    v_mfma_f32_16x16x32_bf16 v[144:147], a[56:59], a[32:35], v[144:147]
    buffer_load_dwordx4 v1, s[4:7], s47 offen offset:0 sc1 lds
    v_mfma_f32_16x16x32_bf16 v[148:151], a[24:27], a[4:7], v[148:151]
    ds_read_b128 a[244:247], v24 offset:9216
    v_mfma_f32_16x16x32_bf16 v[148:151], a[56:59], a[36:39], v[148:151]
    ds_read_b128 a[248:251], v24 offset:10240
    v_mfma_f32_16x16x32_bf16 v[152:155], a[24:27], a[8:11], v[152:155]
    ds_read_b128 a[252:255], v24 offset:11264
    v_mfma_f32_16x16x32_bf16 v[152:155], a[56:59], a[40:43], v[152:155]
    buffer_load_dwordx4 v1, s[4:7], s47 offen offset:1024 sc1 lds
    s_add_u32 s47, s47, s63
    v_mfma_f32_16x16x32_bf16 v[156:159], a[24:27], a[12:15], v[156:159]
    v_mfma_f32_16x16x32_bf16 v[156:159], a[56:59], a[44:47], v[156:159]
    v_mfma_f32_16x16x32_bf16 v[172:175], a[28:31], a[12:15], v[172:175]
    s_add_u32 m0, s50, 81920
    v_mfma_f32_16x16x32_bf16 v[172:175], a[60:63], a[44:47], v[172:175]
    buffer_load_dwordx4 v1, s[4:7], s48 offen offset:0 lds
    v_mfma_f32_16x16x32_bf16 v[168:171], a[28:31], a[8:11], v[168:171]
    v_mfma_f32_16x16x32_bf16 v[168:171], a[60:63], a[40:43], v[168:171]
    v_mfma_f32_16x16x32_bf16 v[164:167], a[28:31], a[4:7], v[164:167]
    v_mfma_f32_16x16x32_bf16 v[164:167], a[60:63], a[36:39], v[164:167]
    buffer_load_dwordx4 v1, s[4:7], s48 offen offset:1024 lds
    v_mfma_f32_16x16x32_bf16 v[160:163], a[28:31], a[0:3], v[160:163]
    v_mfma_f32_16x16x32_bf16 v[160:163], a[60:63], a[32:35], v[160:163]
    s_waitcnt vmcnt(15) lgkmcnt(0)
    s_barrier
    v_mfma_f32_16x16x32_bf16 v[32:35], a[208:211], a[192:195], v[32:35]
    ds_read_b128 a[0:3], v22 offset:0
    v_mfma_f32_16x16x32_bf16 v[32:35], a[240:243], a[224:227], v[32:35]
    buffer_load_dwordx4 v1, s[4:7], s48 offen offset:2048 lds
    v_mfma_f32_16x16x32_bf16 v[36:39], a[208:211], a[196:199], v[36:39]
    ds_read_b128 a[4:7], v22 offset:1024
    v_mfma_f32_16x16x32_bf16 v[36:39], a[240:243], a[228:231], v[36:39]
    ds_read_b128 a[8:11], v22 offset:8192
    v_mfma_f32_16x16x32_bf16 v[40:43], a[208:211], a[200:203], v[40:43]
    ds_read_b128 a[12:15], v22 offset:9216
    v_mfma_f32_16x16x32_bf16 v[40:43], a[240:243], a[232:235], v[40:43]
    buffer_load_dwordx4 v1, s[4:7], s48 offen offset:3072 lds
    s_add_u32 s48, s48, s67
    v_mfma_f32_16x16x32_bf16 v[44:47], a[208:211], a[204:207], v[44:47]
    ds_read_b128 a[16:19], v26 offset:0
    v_mfma_f32_16x16x32_bf16 v[44:47], a[240:243], a[236:239], v[44:47]
    ds_read_b128 a[20:23], v26 offset:1024
    v_mfma_f32_16x16x32_bf16 v[60:63], a[212:215], a[204:207], v[60:63]
    ds_read_b128 a[24:27], v26 offset:2048
    s_add_u32 m0, s49, 32768
    v_mfma_f32_16x16x32_bf16 v[60:63], a[244:247], a[236:239], v[60:63]
    buffer_load_dwordx4 v1, s[4:7], s46 offen offset:0 sc1 lds
    v_mfma_f32_16x16x32_bf16 v[56:59], a[212:215], a[200:203], v[56:59]
    ds_read_b128 a[28:31], v26 offset:3072
    v_mfma_f32_16x16x32_bf16 v[56:59], a[244:247], a[232:235], v[56:59]
    ds_read_b128 a[32:35], v22 offset:4096
    v_mfma_f32_16x16x32_bf16 v[52:55], a[212:215], a[196:199], v[52:55]
    ds_read_b128 a[36:39], v22 offset:5120
    v_mfma_f32_16x16x32_bf16 v[52:55], a[244:247], a[228:231], v[52:55]
    buffer_load_dwordx4 v1, s[4:7], s46 offen offset:1024 sc1 lds
    s_add_u32 s46, s46, s64
    v_mfma_f32_16x16x32_bf16 v[48:51], a[212:215], a[192:195], v[48:51]
    ds_read_b128 a[40:43], v22 offset:12288
    v_mfma_f32_16x16x32_bf16 v[48:51], a[244:247], a[224:227], v[48:51]
    ds_read_b128 a[44:47], v22 offset:13312
    v_mfma_f32_16x16x32_bf16 v[144:147], a[216:219], a[192:195], v[144:147]
    ds_read_b128 a[48:51], v26 offset:8192
    s_add_u32 m0, s49, 40960
    v_mfma_f32_16x16x32_bf16 v[144:147], a[248:251], a[224:227], v[144:147]
    buffer_load_dwordx4 v1, s[4:7], s47 offen offset:0 sc1 lds
    v_mfma_f32_16x16x32_bf16 v[148:151], a[216:219], a[196:199], v[148:151]
    ds_read_b128 a[52:55], v26 offset:9216
    v_mfma_f32_16x16x32_bf16 v[148:151], a[248:251], a[228:231], v[148:151]
    ds_read_b128 a[56:59], v26 offset:10240
    v_mfma_f32_16x16x32_bf16 v[152:155], a[216:219], a[200:203], v[152:155]
    ds_read_b128 a[60:63], v26 offset:11264
    v_mfma_f32_16x16x32_bf16 v[152:155], a[248:251], a[232:235], v[152:155]
    buffer_load_dwordx4 v1, s[4:7], s47 offen offset:1024 sc1 lds
    s_add_u32 s47, s47, s64
    v_mfma_f32_16x16x32_bf16 v[156:159], a[216:219], a[204:207], v[156:159]
    v_mfma_f32_16x16x32_bf16 v[156:159], a[248:251], a[236:239], v[156:159]
    v_mfma_f32_16x16x32_bf16 v[172:175], a[220:223], a[204:207], v[172:175]
    s_add_u32 m0, s50, 49152
    v_mfma_f32_16x16x32_bf16 v[172:175], a[252:255], a[236:239], v[172:175]
    buffer_load_dwordx4 v1, s[4:7], s48 offen offset:0 lds
    v_mfma_f32_16x16x32_bf16 v[168:171], a[220:223], a[200:203], v[168:171]
    v_mfma_f32_16x16x32_bf16 v[168:171], a[252:255], a[232:235], v[168:171]
    v_mfma_f32_16x16x32_bf16 v[164:167], a[220:223], a[196:199], v[164:167]
    v_mfma_f32_16x16x32_bf16 v[164:167], a[252:255], a[228:231], v[164:167]
    buffer_load_dwordx4 v1, s[4:7], s48 offen offset:1024 lds
    v_mfma_f32_16x16x32_bf16 v[160:163], a[220:223], a[192:195], v[160:163]
    v_mfma_f32_16x16x32_bf16 v[160:163], a[252:255], a[224:227], v[160:163]
    s_waitcnt vmcnt(14) lgkmcnt(0)
    s_barrier
    v_mfma_f32_16x16x32_bf16 v[32:35], a[16:19], a[0:3], v[32:35]
    ds_read_b128 a[192:195], v21 offset:32768
    buffer_load_dword v27, off, s[4:7], s57 offset:512 sc1
    v_mfma_f32_16x16x32_bf16 v[32:35], a[48:51], a[32:35], v[32:35]
    v_mfma_f32_16x16x32_bf16 v[36:39], a[16:19], a[4:7], v[36:39]
    ds_read_b128 a[196:199], v21 offset:33792
    v_mfma_f32_16x16x32_bf16 v[36:39], a[48:51], a[36:39], v[36:39]
    ds_read_b128 a[200:203], v21 offset:40960
    buffer_load_dwordx4 v1, s[4:7], s48 offen offset:2048 lds
    v_mfma_f32_16x16x32_bf16 v[40:43], a[16:19], a[8:11], v[40:43]
    ds_read_b128 a[204:207], v21 offset:41984
    v_mfma_f32_16x16x32_bf16 v[40:43], a[48:51], a[40:43], v[40:43]
    v_mfma_f32_16x16x32_bf16 v[44:47], a[16:19], a[12:15], v[44:47]
    ds_read_b128 a[208:211], v25 offset:32768
    v_mfma_f32_16x16x32_bf16 v[44:47], a[48:51], a[44:47], v[44:47]
    ds_read_b128 a[212:215], v25 offset:33792
    buffer_load_dwordx4 v1, s[4:7], s48 offen offset:3072 lds
    s_add_u32 s48, s48, s68
    v_mfma_f32_16x16x32_bf16 v[60:63], a[20:23], a[12:15], v[60:63]
    ds_read_b128 a[216:219], v25 offset:34816
    v_mfma_f32_16x16x32_bf16 v[60:63], a[52:55], a[44:47], v[60:63]
    s_add_u32 m0, s49, 0
    v_mfma_f32_16x16x32_bf16 v[56:59], a[20:23], a[8:11], v[56:59]
    ds_read_b128 a[220:223], v25 offset:35840
    buffer_load_dwordx4 v1, s[4:7], s46 offen offset:0 sc1 lds
    v_mfma_f32_16x16x32_bf16 v[56:59], a[52:55], a[40:43], v[56:59]
    ds_read_b128 a[224:227], v21 offset:36864
    v_mfma_f32_16x16x32_bf16 v[52:55], a[20:23], a[4:7], v[52:55]
    ds_read_b128 a[228:231], v21 offset:37888
    v_mfma_f32_16x16x32_bf16 v[52:55], a[52:55], a[36:39], v[52:55]
    v_mfma_f32_16x16x32_bf16 v[48:51], a[20:23], a[0:3], v[48:51]
    ds_read_b128 a[232:235], v21 offset:45056
    buffer_load_dwordx4 v1, s[4:7], s46 offen offset:1024 sc1 lds
    s_add_u32 s46, s46, s65
    v_mfma_f32_16x16x32_bf16 v[48:51], a[52:55], a[32:35], v[48:51]
    ds_read_b128 a[236:239], v21 offset:46080
    v_mfma_f32_16x16x32_bf16 v[144:147], a[24:27], a[0:3], v[144:147]
    ds_read_b128 a[240:243], v25 offset:40960
    s_add_u32 m0, s49, 8192
    v_mfma_f32_16x16x32_bf16 v[144:147], a[56:59], a[32:35], v[144:147]
    buffer_load_dwordx4 v1, s[4:7], s47 offen offset:0 sc1 lds
    v_mfma_f32_16x16x32_bf16 v[148:151], a[24:27], a[4:7], v[148:151]
    ds_read_b128 a[244:247], v25 offset:41984
    v_mfma_f32_16x16x32_bf16 v[148:151], a[56:59], a[36:39], v[148:151]
    ds_read_b128 a[248:251], v25 offset:43008
    v_mfma_f32_16x16x32_bf16 v[152:155], a[24:27], a[8:11], v[152:155]
    ds_read_b128 a[252:255], v25 offset:44032
    v_mfma_f32_16x16x32_bf16 v[152:155], a[56:59], a[40:43], v[152:155]
    buffer_load_dwordx4 v1, s[4:7], s47 offen offset:1024 sc1 lds
    s_add_u32 s47, s47, s65
    v_mfma_f32_16x16x32_bf16 v[156:159], a[24:27], a[12:15], v[156:159]
    v_mfma_f32_16x16x32_bf16 v[156:159], a[56:59], a[44:47], v[156:159]
    s_add_u32 m0, s50, 16384
    v_mfma_f32_16x16x32_bf16 v[172:175], a[28:31], a[12:15], v[172:175]
    buffer_load_dwordx4 v1, s[4:7], s48 offen offset:0 lds
    v_mfma_f32_16x16x32_bf16 v[172:175], a[60:63], a[44:47], v[172:175]
    v_mfma_f32_16x16x32_bf16 v[168:171], a[28:31], a[8:11], v[168:171]
    v_mfma_f32_16x16x32_bf16 v[168:171], a[60:63], a[40:43], v[168:171]
    v_mfma_f32_16x16x32_bf16 v[164:167], a[28:31], a[4:7], v[164:167]
    s_waitcnt vmcnt(7)
    v_cmp_gt_u32 vcc, s70, v27
    s_nop 1
    s_cbranch_vccnz L_ffn_spin2
L_ffn_go2:
    v_mfma_f32_16x16x32_bf16 v[164:167], a[60:63], a[36:39], v[164:167]
    v_mfma_f32_16x16x32_bf16 v[160:163], a[28:31], a[0:3], v[160:163]
    v_mfma_f32_16x16x32_bf16 v[160:163], a[60:63], a[32:35], v[160:163]
    s_waitcnt lgkmcnt(0)
    s_barrier
    v_mfma_f32_16x16x32_bf16 v[32:35], a[208:211], a[192:195], v[32:35]
    ds_read_b128 a[0:3], v21 offset:0
    s_mov_b64 exec, 1
    buffer_atomic_add v28, off, s[4:7], s54 offset:768 sc1
    s_mov_b64 exec, -1
    v_mfma_f32_16x16x32_bf16 v[32:35], a[240:243], a[224:227], v[32:35]
    v_mfma_f32_16x16x32_bf16 v[36:39], a[208:211], a[196:199], v[36:39]
    ds_read_b128 a[4:7], v21 offset:1024
    v_mfma_f32_16x16x32_bf16 v[36:39], a[240:243], a[228:231], v[36:39]
    ds_read_b128 a[8:11], v21 offset:8192
    buffer_load_dwordx4 v1, s[4:7], s48 offen offset:1024 lds
    v_mfma_f32_16x16x32_bf16 v[40:43], a[208:211], a[200:203], v[40:43]
    ds_read_b128 a[12:15], v21 offset:9216
    v_mfma_f32_16x16x32_bf16 v[40:43], a[240:243], a[232:235], v[40:43]
    v_mfma_f32_16x16x32_bf16 v[44:47], a[208:211], a[204:207], v[44:47]
    ds_read_b128 a[16:19], v25 offset:0
    v_mfma_f32_16x16x32_bf16 v[44:47], a[240:243], a[236:239], v[44:47]
    ds_read_b128 a[20:23], v25 offset:1024
    buffer_load_dwordx4 v1, s[4:7], s48 offen offset:2048 lds
    v_mfma_f32_16x16x32_bf16 v[60:63], a[212:215], a[204:207], v[60:63]
    ds_read_b128 a[24:27], v25 offset:2048
    v_mfma_f32_16x16x32_bf16 v[60:63], a[244:247], a[236:239], v[60:63]
    v_mfma_f32_16x16x32_bf16 v[56:59], a[212:215], a[200:203], v[56:59]
    ds_read_b128 a[28:31], v25 offset:3072
    buffer_load_dwordx4 v1, s[4:7], s48 offen offset:3072 lds
    s_add_u32 s48, s48, s69
    v_mfma_f32_16x16x32_bf16 v[56:59], a[244:247], a[232:235], v[56:59]
    ds_read_b128 a[32:35], v21 offset:4096
    v_mfma_f32_16x16x32_bf16 v[52:55], a[212:215], a[196:199], v[52:55]
    ds_read_b128 a[36:39], v21 offset:5120
    v_mfma_f32_16x16x32_bf16 v[52:55], a[244:247], a[228:231], v[52:55]
    s_add_u32 m0, s49, 131072
    v_mfma_f32_16x16x32_bf16 v[48:51], a[212:215], a[192:195], v[48:51]
    ds_read_b128 a[40:43], v21 offset:12288
    buffer_load_dwordx4 v1, s[4:7], s46 offen offset:0 sc1 lds
    v_mfma_f32_16x16x32_bf16 v[48:51], a[244:247], a[224:227], v[48:51]
    ds_read_b128 a[44:47], v21 offset:13312
    v_mfma_f32_16x16x32_bf16 v[144:147], a[216:219], a[192:195], v[144:147]
    ds_read_b128 a[48:51], v25 offset:8192
    v_mfma_f32_16x16x32_bf16 v[144:147], a[248:251], a[224:227], v[144:147]
    buffer_load_dwordx4 v1, s[4:7], s46 offen offset:1024 sc1 lds
    s_add_u32 s46, s46, s62
    v_mfma_f32_16x16x32_bf16 v[148:151], a[216:219], a[196:199], v[148:151]
    ds_read_b128 a[52:55], v25 offset:9216
    v_mfma_f32_16x16x32_bf16 v[148:151], a[248:251], a[228:231], v[148:151]
    ds_read_b128 a[56:59], v25 offset:10240
    v_mfma_f32_16x16x32_bf16 v[152:155], a[216:219], a[200:203], v[152:155]
    ds_read_b128 a[60:63], v25 offset:11264
    s_add_u32 m0, s49, 139264
    v_mfma_f32_16x16x32_bf16 v[152:155], a[248:251], a[232:235], v[152:155]
    buffer_load_dwordx4 v1, s[4:7], s47 offen offset:0 sc1 lds
    v_mfma_f32_16x16x32_bf16 v[156:159], a[216:219], a[204:207], v[156:159]
    v_mfma_f32_16x16x32_bf16 v[156:159], a[248:251], a[236:239], v[156:159]
    v_mfma_f32_16x16x32_bf16 v[172:175], a[220:223], a[204:207], v[172:175]
    buffer_load_dwordx4 v1, s[4:7], s47 offen offset:1024 sc1 lds
    s_add_u32 s47, s47, s62
    v_mfma_f32_16x16x32_bf16 v[172:175], a[252:255], a[236:239], v[172:175]
    v_mfma_f32_16x16x32_bf16 v[168:171], a[220:223], a[200:203], v[168:171]
    v_mfma_f32_16x16x32_bf16 v[168:171], a[252:255], a[232:235], v[168:171]
    s_add_u32 m0, s50, 147456
    v_mfma_f32_16x16x32_bf16 v[164:167], a[220:223], a[196:199], v[164:167]
    buffer_load_dwordx4 v1, s[4:7], s48 offen offset:0 lds
    v_mfma_f32_16x16x32_bf16 v[164:167], a[252:255], a[228:231], v[164:167]
    v_mfma_f32_16x16x32_bf16 v[160:163], a[220:223], a[192:195], v[160:163]
    v_mfma_f32_16x16x32_bf16 v[160:163], a[252:255], a[224:227], v[160:163]
    s_waitcnt vmcnt(14) lgkmcnt(0)
    s_barrier
    v_mfma_f32_16x16x32_bf16 v[32:35], a[16:19], a[0:3], v[32:35]
    ds_read_b128 a[192:195], v20 offset:32768
    v_mfma_f32_16x16x32_bf16 v[32:35], a[48:51], a[32:35], v[32:35]
    buffer_load_dwordx4 v1, s[4:7], s48 offen offset:1024 lds
    v_accvgpr_read_b32 v97, a128
    v_mfma_f32_16x16x32_bf16 v[36:39], a[16:19], a[4:7], v[36:39]
    ds_read_b128 a[196:199], v20 offset:33792
    v_lshlrev_b32 v96, 16, v97
    v_mfma_f32_16x16x32_bf16 v[36:39], a[48:51], a[36:39], v[36:39]
    ds_read_b128 a[200:203], v20 offset:40960
    v_and_b32 v97, 0xffff0000, v97
    v_accvgpr_read_b32 v99, a129
    v_mfma_f32_16x16x32_bf16 v[40:43], a[16:19], a[8:11], v[40:43]
    ds_read_b128 a[204:207], v20 offset:41984
    v_lshlrev_b32 v98, 16, v99
    v_mfma_f32_16x16x32_bf16 v[40:43], a[48:51], a[40:43], v[40:43]
    buffer_load_dwordx4 v1, s[4:7], s48 offen offset:2048 lds
    v_and_b32 v99, 0xffff0000, v99
    v_mfma_f32_16x16x32_bf16 v[44:47], a[16:19], a[12:15], v[44:47]
    ds_read_b128 a[208:211], v24 offset:32768
    v_accvgpr_read_b32 v105, a130
    v_mfma_f32_16x16x32_bf16 v[44:47], a[48:51], a[44:47], v[44:47]
    ds_read_b128 a[212:215], v24 offset:33792
    v_lshlrev_b32 v104, 16, v105
    v_and_b32 v105, 0xffff0000, v105
    v_mfma_f32_16x16x32_bf16 v[60:63], a[20:23], a[12:15], v[60:63]
    ds_read_b128 a[216:219], v24 offset:34816
    v_accvgpr_read_b32 v107, a131
    v_mfma_f32_16x16x32_bf16 v[60:63], a[52:55], a[44:47], v[60:63]
    buffer_load_dwordx4 v1, s[4:7], s48 offen offset:3072 lds
    s_add_u32 s48, s48, s66
    v_mfma_f32_16x16x32_bf16 v[56:59], a[20:23], a[8:11], v[56:59]
    ds_read_b128 a[220:223], v24 offset:35840
    v_lshlrev_b32 v106, 16, v107
    v_mfma_f32_16x16x32_bf16 v[56:59], a[52:55], a[40:43], v[56:59]
    ds_read_b128 a[224:227], v20 offset:36864
    v_and_b32 v107, 0xffff0000, v107
    v_accvgpr_read_b32 v209, a132
    v_mfma_f32_16x16x32_bf16 v[52:55], a[20:23], a[4:7], v[52:55]
    ds_read_b128 a[228:231], v20 offset:37888
    s_add_u32 m0, s49, 98304
    v_mfma_f32_16x16x32_bf16 v[52:55], a[52:55], a[36:39], v[52:55]
    buffer_load_dwordx4 v1, s[4:7], s46 offen offset:0 sc1 lds
    v_lshlrev_b32 v208, 16, v209
    v_mfma_f32_16x16x32_bf16 v[48:51], a[20:23], a[0:3], v[48:51]
    ds_read_b128 a[232:235], v20 offset:45056
    v_and_b32 v209, 0xffff0000, v209
    v_mfma_f32_16x16x32_bf16 v[48:51], a[52:55], a[32:35], v[48:51]
    ds_read_b128 a[236:239], v20 offset:46080
    v_accvgpr_read_b32 v211, a133
    v_lshlrev_b32 v210, 16, v211
    v_mfma_f32_16x16x32_bf16 v[144:147], a[24:27], a[0:3], v[144:147]
    ds_read_b128 a[240:243], v24 offset:40960
    v_and_b32 v211, 0xffff0000, v211
    v_mfma_f32_16x16x32_bf16 v[144:147], a[56:59], a[32:35], v[144:147]
    buffer_load_dwordx4 v1, s[4:7], s46 offen offset:1024 sc1 lds
    s_add_u32 s46, s46, s63
    v_mfma_f32_16x16x32_bf16 v[148:151], a[24:27], a[4:7], v[148:151]
    ds_read_b128 a[244:247], v24 offset:41984
    v_accvgpr_read_b32 v217, a134
    v_mfma_f32_16x16x32_bf16 v[148:151], a[56:59], a[36:39], v[148:151]
    ds_read_b128 a[248:251], v24 offset:43008
    v_lshlrev_b32 v216, 16, v217
    v_and_b32 v217, 0xffff0000, v217
    v_mfma_f32_16x16x32_bf16 v[152:155], a[24:27], a[8:11], v[152:155]
    ds_read_b128 a[252:255], v24 offset:44032
    s_add_u32 m0, s49, 106496
    v_mfma_f32_16x16x32_bf16 v[152:155], a[56:59], a[40:43], v[152:155]
    buffer_load_dwordx4 v1, s[4:7], s47 offen offset:0 sc1 lds
    v_accvgpr_read_b32 v219, a135
    v_mfma_f32_16x16x32_bf16 v[156:159], a[24:27], a[12:15], v[156:159]
    v_lshlrev_b32 v218, 16, v219
    v_and_b32 v219, 0xffff0000, v219
    v_mfma_f32_16x16x32_bf16 v[156:159], a[56:59], a[44:47], v[156:159]
    v_accvgpr_read_b32 v101, a136
    v_lshlrev_b32 v100, 16, v101
    v_and_b32 v101, 0xffff0000, v101
    v_mfma_f32_16x16x32_bf16 v[172:175], a[28:31], a[12:15], v[172:175]
    v_accvgpr_read_b32 v103, a137
    v_lshlrev_b32 v102, 16, v103
    v_mfma_f32_16x16x32_bf16 v[172:175], a[60:63], a[44:47], v[172:175]
    buffer_load_dwordx4 v1, s[4:7], s47 offen offset:1024 sc1 lds
    s_add_u32 s47, s47, s63
    v_mfma_f32_16x16x32_bf16 v[168:171], a[28:31], a[8:11], v[168:171]
    v_and_b32 v103, 0xffff0000, v103
    v_accvgpr_read_b32 v109, a138
    v_mfma_f32_16x16x32_bf16 v[168:171], a[60:63], a[40:43], v[168:171]
    v_lshlrev_b32 v108, 16, v109
    v_and_b32 v109, 0xffff0000, v109
    v_accvgpr_read_b32 v111, a139
    v_mfma_f32_16x16x32_bf16 v[164:167], a[28:31], a[4:7], v[164:167]
    s_add_u32 m0, s50, 114688
    v_lshlrev_b32 v110, 16, v111
    v_mfma_f32_16x16x32_bf16 v[164:167], a[60:63], a[36:39], v[164:167]
    buffer_load_dwordx4 v1, s[4:7], s48 offen offset:0 lds
    v_and_b32 v111, 0xffff0000, v111
    v_mfma_f32_16x16x32_bf16 v[160:163], a[28:31], a[0:3], v[160:163]
    v_accvgpr_read_b32 v213, a140
    v_lshlrev_b32 v212, 16, v213
    v_mfma_f32_16x16x32_bf16 v[160:163], a[60:63], a[32:35], v[160:163]
    v_and_b32 v213, 0xffff0000, v213
    v_accvgpr_read_b32 v215, a141
    v_lshlrev_b32 v214, 16, v215
    s_branch L_isl14_over
.p2align 12
L_isl14:
    s_setpc_b64 s[14:15]
L_isl14_over:
    s_waitcnt vmcnt(13) lgkmcnt(0)
    s_barrier
    v_mfma_f32_16x16x32_bf16 v[32:35], a[208:211], a[192:195], v[32:35]
    ds_read_b128 a[0:3], v20 offset:0
    v_and_b32 v215, 0xffff0000, v215
    v_mfma_f32_16x16x32_bf16 v[32:35], a[240:243], a[224:227], v[32:35]
    buffer_load_dwordx4 v1, s[4:7], s48 offen offset:1024 lds
    v_accvgpr_read_b32 v221, a142
    v_mfma_f32_16x16x32_bf16 v[36:39], a[208:211], a[196:199], v[36:39]
    ds_read_b128 a[4:7], v20 offset:1024
    v_lshlrev_b32 v220, 16, v221
    v_mfma_f32_16x16x32_bf16 v[36:39], a[240:243], a[228:231], v[36:39]
    ds_read_b128 a[8:11], v20 offset:8192
    v_and_b32 v221, 0xffff0000, v221
    v_accvgpr_read_b32 v223, a143
    v_mfma_f32_16x16x32_bf16 v[40:43], a[208:211], a[200:203], v[40:43]
    ds_read_b128 a[12:15], v20 offset:9216
    v_lshlrev_b32 v222, 16, v223
    v_mfma_f32_16x16x32_bf16 v[40:43], a[240:243], a[232:235], v[40:43]
    buffer_load_dwordx4 v1, s[4:7], s48 offen offset:2048 lds
    v_and_b32 v223, 0xffff0000, v223
    v_mfma_f32_16x16x32_bf16 v[44:47], a[208:211], a[204:207], v[44:47]
    ds_read_b128 a[16:19], v24 offset:0
    s_xor_b32 s52, s51, 131072
    v_mfma_f32_16x16x32_bf16 v[44:47], a[240:243], a[236:239], v[44:47]
    ds_read_b128 a[20:23], v24 offset:1024
    s_add_u32 s53, s52, 4096
    s_add_u32 s52, s52, 0
    v_mfma_f32_16x16x32_bf16 v[60:63], a[212:215], a[204:207], v[60:63]
    ds_read_b128 a[24:27], v24 offset:2048
    v_mfma_f32_16x16x32_bf16 v[60:63], a[244:247], a[236:239], v[60:63]
    buffer_load_dwordx4 v1, s[4:7], s48 offen offset:3072 lds
    s_add_u32 s48, s48, s67
    v_mfma_f32_16x16x32_bf16 v[56:59], a[212:215], a[200:203], v[56:59]
    ds_read_b128 a[28:31], v24 offset:3072
    v_mfma_f32_16x16x32_bf16 v[56:59], a[244:247], a[232:235], v[56:59]
    ds_read_b128 a[32:35], v20 offset:4096
    v_mfma_f32_16x16x32_bf16 v[52:55], a[212:215], a[196:199], v[52:55]
    ds_read_b128 a[36:39], v20 offset:5120
    s_add_u32 m0, s49, 65536
    v_mfma_f32_16x16x32_bf16 v[52:55], a[244:247], a[228:231], v[52:55]
    buffer_load_dwordx4 v1, s[4:7], s46 offen offset:0 sc1 lds
    v_mfma_f32_16x16x32_bf16 v[48:51], a[212:215], a[192:195], v[48:51]
    ds_read_b128 a[40:43], v20 offset:12288
    v_mfma_f32_16x16x32_bf16 v[48:51], a[244:247], a[224:227], v[48:51]
    ds_read_b128 a[44:47], v20 offset:13312
    v_mfma_f32_16x16x32_bf16 v[144:147], a[216:219], a[192:195], v[144:147]
    ds_read_b128 a[48:51], v24 offset:8192
    v_mfma_f32_16x16x32_bf16 v[144:147], a[248:251], a[224:227], v[144:147]
    buffer_load_dwordx4 v1, s[4:7], s46 offen offset:1024 sc1 lds
    s_add_u32 s46, s46, s64
    v_mfma_f32_16x16x32_bf16 v[148:151], a[216:219], a[196:199], v[148:151]
    ds_read_b128 a[52:55], v24 offset:9216
    v_mfma_f32_16x16x32_bf16 v[148:151], a[248:251], a[228:231], v[148:151]
    ds_read_b128 a[56:59], v24 offset:10240
    v_mfma_f32_16x16x32_bf16 v[152:155], a[216:219], a[200:203], v[152:155]
    ds_read_b128 a[60:63], v24 offset:11264
    s_add_u32 m0, s49, 73728
    v_mfma_f32_16x16x32_bf16 v[152:155], a[248:251], a[232:235], v[152:155]
    buffer_load_dwordx4 v1, s[4:7], s47 offen offset:0 sc1 lds
    v_mfma_f32_16x16x32_bf16 v[156:159], a[216:219], a[204:207], v[156:159]
    v_mfma_f32_16x16x32_bf16 v[156:159], a[248:251], a[236:239], v[156:159]
    v_mfma_f32_16x16x32_bf16 v[172:175], a[220:223], a[204:207], v[172:175]
    v_mfma_f32_16x16x32_bf16 v[172:175], a[252:255], a[236:239], v[172:175]
    buffer_load_dwordx4 v1, s[4:7], s47 offen offset:1024 sc1 lds
    s_add_u32 s47, s47, s64
    v_mfma_f32_16x16x32_bf16 v[168:171], a[220:223], a[200:203], v[168:171]
    v_mfma_f32_16x16x32_bf16 v[168:171], a[252:255], a[232:235], v[168:171]
    v_mfma_f32_16x16x32_bf16 v[164:167], a[220:223], a[196:199], v[164:167]
    v_mfma_f32_16x16x32_bf16 v[164:167], a[252:255], a[228:231], v[164:167]
    v_mfma_f32_16x16x32_bf16 v[160:163], a[220:223], a[192:195], v[160:163]
    v_mfma_f32_16x16x32_bf16 v[160:163], a[252:255], a[224:227], v[160:163]
    s_waitcnt vmcnt(12) lgkmcnt(0)
    s_barrier
    v_mfma_f32_16x16x32_bf16 v[32:35], a[16:19], a[0:3], v[32:35]
    ds_read_b128 a[192:195], v22 offset:0
    s_add_u32 m0, s50, 81920
    v_mfma_f32_16x16x32_bf16 v[32:35], a[48:51], a[32:35], v[32:35]
    buffer_load_dwordx4 v1, s[4:7], s48 offen offset:0 lds
    v_mfma_f32_16x16x32_bf16 v[36:39], a[16:19], a[4:7], v[36:39]
    ds_read_b128 a[196:199], v22 offset:1024
    v_mfma_f32_16x16x32_bf16 v[36:39], a[48:51], a[36:39], v[36:39]
    ds_read_b128 a[200:203], v22 offset:8192
    v_mfma_f32_16x16x32_bf16 v[40:43], a[16:19], a[8:11], v[40:43]
    ds_read_b128 a[204:207], v22 offset:9216
    v_mfma_f32_16x16x32_bf16 v[40:43], a[48:51], a[40:43], v[40:43]
    buffer_load_dwordx4 v1, s[4:7], s48 offen offset:1024 lds
    v_mfma_f32_16x16x32_bf16 v[44:47], a[16:19], a[12:15], v[44:47]
    ds_read_b128 a[208:211], v26 offset:0
    v_mfma_f32_16x16x32_bf16 v[44:47], a[48:51], a[44:47], v[44:47]
    ds_read_b128 a[212:215], v26 offset:1024
    v_mfma_f32_16x16x32_bf16 v[60:63], a[20:23], a[12:15], v[60:63]
    ds_read_b128 a[216:219], v26 offset:2048
    v_mfma_f32_16x16x32_bf16 v[60:63], a[52:55], a[44:47], v[60:63]
    buffer_load_dwordx4 v1, s[4:7], s48 offen offset:2048 lds
    v_mfma_f32_16x16x32_bf16 v[56:59], a[20:23], a[8:11], v[56:59]
    ds_read_b128 a[220:223], v26 offset:3072
    v_mfma_f32_16x16x32_bf16 v[56:59], a[52:55], a[40:43], v[56:59]
    ds_read_b128 a[224:227], v22 offset:4096
    v_mfma_f32_16x16x32_bf16 v[52:55], a[20:23], a[4:7], v[52:55]
    ds_read_b128 a[228:231], v22 offset:5120
    v_mfma_f32_16x16x32_bf16 v[52:55], a[52:55], a[36:39], v[52:55]
    buffer_load_dwordx4 v1, s[4:7], s48 offen offset:3072 lds
    s_add_u32 s48, s48, s68
    v_mfma_f32_16x16x32_bf16 v[48:51], a[20:23], a[0:3], v[48:51]
    ds_read_b128 a[232:235], v22 offset:12288
    v_mfma_f32_16x16x32_bf16 v[48:51], a[52:55], a[32:35], v[48:51]
    ds_read_b128 a[236:239], v22 offset:13312
    v_mfma_f32_16x16x32_bf16 v[144:147], a[24:27], a[0:3], v[144:147]
    ds_read_b128 a[240:243], v26 offset:8192
    s_add_u32 m0, s49, 32768
    v_mfma_f32_16x16x32_bf16 v[144:147], a[56:59], a[32:35], v[144:147]
    buffer_load_dwordx4 v1, s[4:7], s46 offen offset:0 sc1 lds
    v_mfma_f32_16x16x32_bf16 v[148:151], a[24:27], a[4:7], v[148:151]
    ds_read_b128 a[244:247], v26 offset:9216
    v_mfma_f32_16x16x32_bf16 v[148:151], a[56:59], a[36:39], v[148:151]
    ds_read_b128 a[248:251], v26 offset:10240
    v_mfma_f32_16x16x32_bf16 v[152:155], a[24:27], a[8:11], v[152:155]
    ds_read_b128 a[252:255], v26 offset:11264
    v_mfma_f32_16x16x32_bf16 v[152:155], a[56:59], a[40:43], v[152:155]
    buffer_load_dwordx4 v1, s[4:7], s46 offen offset:1024 sc1 lds
    s_add_u32 s46, s46, s65
    v_mfma_f32_16x16x32_bf16 v[156:159], a[24:27], a[12:15], v[156:159]
    v_mfma_f32_16x16x32_bf16 v[156:159], a[56:59], a[44:47], v[156:159]
    v_mfma_f32_16x16x32_bf16 v[172:175], a[28:31], a[12:15], v[172:175]
    s_add_u32 m0, s49, 40960
    v_mfma_f32_16x16x32_bf16 v[172:175], a[60:63], a[44:47], v[172:175]
    buffer_load_dwordx4 v1, s[4:7], s47 offen offset:0 sc1 lds
    v_mfma_f32_16x16x32_bf16 v[168:171], a[28:31], a[8:11], v[168:171]
    v_mfma_f32_16x16x32_bf16 v[168:171], a[60:63], a[40:43], v[168:171]
    v_mfma_f32_16x16x32_bf16 v[164:167], a[28:31], a[4:7], v[164:167]
    v_mfma_f32_16x16x32_bf16 v[164:167], a[60:63], a[36:39], v[164:167]
    buffer_load_dwordx4 v1, s[4:7], s47 offen offset:1024 sc1 lds
    s_add_u32 s47, s47, s65
    v_mfma_f32_16x16x32_bf16 v[160:163], a[28:31], a[0:3], v[160:163]
    v_mfma_f32_16x16x32_bf16 v[160:163], a[60:63], a[32:35], v[160:163]
    s_waitcnt vmcnt(12) lgkmcnt(0)
    s_barrier
    v_mfma_f32_16x16x32_bf16 v[32:35], a[208:211], a[192:195], v[32:35]
    ds_read_b128 a[0:3], v21 offset:32768
    s_add_u32 m0, s50, 49152
    v_mfma_f32_16x16x32_bf16 v[32:35], a[240:243], a[224:227], v[32:35]
    buffer_load_dwordx4 v1, s[4:7], s48 offen offset:0 lds
    v_mfma_f32_16x16x32_bf16 v[36:39], a[208:211], a[196:199], v[36:39]
    ds_read_b128 a[4:7], v21 offset:33792
    v_add_f32 v144, v144, v208
    v_mfma_f32_16x16x32_bf16 v[36:39], a[240:243], a[228:231], v[36:39]
    ds_read_b128 a[8:11], v21 offset:40960
    v_add_f32 v145, v145, v209
    v_mfma_f32_16x16x32_bf16 v[40:43], a[208:211], a[200:203], v[40:43]
    ds_read_b128 a[12:15], v21 offset:41984
    v_add_f32 v146, v146, v210
    v_mfma_f32_16x16x32_bf16 v[40:43], a[240:243], a[232:235], v[40:43]
    buffer_load_dwordx4 v1, s[4:7], s48 offen offset:1024 lds
    v_mfma_f32_16x16x32_bf16 v[44:47], a[208:211], a[204:207], v[44:47]
    ds_read_b128 a[16:19], v25 offset:32768
    v_add_f32 v147, v147, v211
    v_mfma_f32_16x16x32_bf16 v[44:47], a[240:243], a[236:239], v[44:47]
    ds_read_b128 a[20:23], v25 offset:33792
    v_mfma_f32_16x16x32_bf16 v[60:63], a[212:215], a[204:207], v[60:63]
    ds_read_b128 a[24:27], v25 offset:34816
    v_mfma_f32_16x16x32_bf16 v[60:63], a[244:247], a[236:239], v[60:63]
    buffer_load_dwordx4 v1, s[4:7], s48 offen offset:2048 lds
    v_mfma_f32_16x16x32_bf16 v[56:59], a[212:215], a[200:203], v[56:59]
    ds_read_b128 a[28:31], v25 offset:35840
    v_add_f32 v160, v160, v216
    v_mfma_f32_16x16x32_bf16 v[56:59], a[244:247], a[232:235], v[56:59]
    ds_read_b128 a[32:35], v21 offset:36864
    v_add_f32 v161, v161, v217
    v_mfma_f32_16x16x32_bf16 v[52:55], a[212:215], a[196:199], v[52:55]
    ds_read_b128 a[36:39], v21 offset:37888
    v_add_f32 v162, v162, v218
    v_mfma_f32_16x16x32_bf16 v[52:55], a[244:247], a[228:231], v[52:55]
    buffer_load_dwordx4 v1, s[4:7], s48 offen offset:3072 lds
    s_add_u32 s48, s48, s69
    v_mfma_f32_16x16x32_bf16 v[48:51], a[212:215], a[192:195], v[48:51]
    ds_read_b128 a[40:43], v21 offset:45056
    v_add_f32 v163, v163, v219
    v_mfma_f32_16x16x32_bf16 v[48:51], a[244:247], a[224:227], v[48:51]
    ds_read_b128 a[44:47], v21 offset:46080
    v_mfma_f32_16x16x32_bf16 v[144:147], a[216:219], a[192:195], v[144:147]
    ds_read_b128 a[48:51], v25 offset:40960
    s_add_u32 m0, s49, 0
    v_mfma_f32_16x16x32_bf16 v[144:147], a[248:251], a[224:227], v[144:147]
    buffer_load_dwordx4 v1, s[4:7], s46 offen offset:0 sc1 lds
    v_mfma_f32_16x16x32_bf16 v[148:151], a[216:219], a[196:199], v[148:151]
    ds_read_b128 a[52:55], v25 offset:41984
    v_add_f32 v32, v32, v96
    v_mfma_f32_16x16x32_bf16 v[148:151], a[248:251], a[228:231], v[148:151]
    ds_read_b128 a[56:59], v25 offset:43008
    v_add_f32 v33, v33, v97
    v_mfma_f32_16x16x32_bf16 v[152:155], a[216:219], a[200:203], v[152:155]
    ds_read_b128 a[60:63], v25 offset:44032
    v_add_f32 v34, v34, v98
    v_mfma_f32_16x16x32_bf16 v[152:155], a[248:251], a[232:235], v[152:155]
    buffer_load_dwordx4 v1, s[4:7], s46 offen offset:1024 sc1 lds
    s_add_u32 s46, s46, s62
    v_mfma_f32_16x16x32_bf16 v[156:159], a[216:219], a[204:207], v[156:159]
    v_add_f32 v35, v35, v99
    v_mfma_f32_16x16x32_bf16 v[156:159], a[248:251], a[236:239], v[156:159]
    v_mfma_f32_16x16x32_bf16 v[172:175], a[220:223], a[204:207], v[172:175]
    s_add_u32 m0, s49, 8192
    v_mfma_f32_16x16x32_bf16 v[172:175], a[252:255], a[236:239], v[172:175]
    buffer_load_dwordx4 v1, s[4:7], s47 offen offset:0 sc1 lds
    v_mfma_f32_16x16x32_bf16 v[168:171], a[220:223], a[200:203], v[168:171]
    v_add_f32 v48, v48, v104
    v_mfma_f32_16x16x32_bf16 v[168:171], a[252:255], a[232:235], v[168:171]
    v_add_f32 v49, v49, v105
    v_mfma_f32_16x16x32_bf16 v[164:167], a[220:223], a[196:199], v[164:167]
    v_add_f32 v50, v50, v106
    v_mfma_f32_16x16x32_bf16 v[164:167], a[252:255], a[228:231], v[164:167]
    buffer_load_dwordx4 v1, s[4:7], s47 offen offset:1024 sc1 lds
    s_add_u32 s47, s47, s62
    v_mfma_f32_16x16x32_bf16 v[160:163], a[220:223], a[192:195], v[160:163]
    v_add_f32 v51, v51, v107
    v_mfma_f32_16x16x32_bf16 v[160:163], a[252:255], a[224:227], v[160:163]
    s_waitcnt vmcnt(12) lgkmcnt(0)
    s_barrier
    v_mfma_f32_16x16x32_bf16 v[32:35], a[16:19], a[0:3], v[32:35]
    ds_read_b128 a[192:195], v21 offset:0
    s_add_u32 m0, s50, 16384
    v_mfma_f32_16x16x32_bf16 v[32:35], a[48:51], a[32:35], v[32:35]
    buffer_load_dwordx4 v1, s[4:7], s48 offen offset:0 lds
    v_mfma_f32_16x16x32_bf16 v[36:39], a[16:19], a[4:7], v[36:39]
    ds_read_b128 a[196:199], v21 offset:1024
    v_add_f32 v148, v148, v212
    v_mfma_f32_16x16x32_bf16 v[36:39], a[48:51], a[36:39], v[36:39]
    ds_read_b128 a[200:203], v21 offset:8192
    v_add_f32 v149, v149, v213
    v_mfma_f32_16x16x32_bf16 v[40:43], a[16:19], a[8:11], v[40:43]
    ds_read_b128 a[204:207], v21 offset:9216
    v_add_f32 v150, v150, v214
    v_mfma_f32_16x16x32_bf16 v[40:43], a[48:51], a[40:43], v[40:43]
    buffer_load_dwordx4 v1, s[4:7], s48 offen offset:1024 lds
    v_mfma_f32_16x16x32_bf16 v[44:47], a[16:19], a[12:15], v[44:47]
    ds_read_b128 a[208:211], v25 offset:0
    v_add_f32 v151, v151, v215
    v_mfma_f32_16x16x32_bf16 v[44:47], a[48:51], a[44:47], v[44:47]
    ds_read_b128 a[212:215], v25 offset:1024
    v_mfma_f32_16x16x32_bf16 v[60:63], a[20:23], a[12:15], v[60:63]
    ds_read_b128 a[216:219], v25 offset:2048
    v_mfma_f32_16x16x32_bf16 v[60:63], a[52:55], a[44:47], v[60:63]
    buffer_load_dwordx4 v1, s[4:7], s48 offen offset:2048 lds
    v_mfma_f32_16x16x32_bf16 v[56:59], a[20:23], a[8:11], v[56:59]
    ds_read_b128 a[220:223], v25 offset:3072
    v_add_f32 v164, v164, v220
    v_mfma_f32_16x16x32_bf16 v[56:59], a[52:55], a[40:43], v[56:59]
    ds_read_b128 a[224:227], v21 offset:4096
    v_add_f32 v165, v165, v221
    v_mfma_f32_16x16x32_bf16 v[52:55], a[20:23], a[4:7], v[52:55]
    ds_read_b128 a[228:231], v21 offset:5120
    v_add_f32 v166, v166, v222
    v_mfma_f32_16x16x32_bf16 v[52:55], a[52:55], a[36:39], v[52:55]
    buffer_load_dwordx4 v1, s[4:7], s48 offen offset:3072 lds
    s_add_u32 s48, s48, s66
    v_mfma_f32_16x16x32_bf16 v[48:51], a[20:23], a[0:3], v[48:51]
    ds_read_b128 a[232:235], v21 offset:12288
    v_add_f32 v167, v167, v223
    v_mfma_f32_16x16x32_bf16 v[48:51], a[52:55], a[32:35], v[48:51]
    ds_read_b128 a[236:239], v21 offset:13312
    v_mfma_f32_16x16x32_bf16 v[144:147], a[24:27], a[0:3], v[144:147]
    ds_read_b128 a[240:243], v25 offset:8192
    s_add_u32 m0, s49, 131072
    v_mfma_f32_16x16x32_bf16 v[144:147], a[56:59], a[32:35], v[144:147]
    buffer_load_dwordx4 v1, s[4:7], s46 offen offset:0 sc1 lds
    v_mfma_f32_16x16x32_bf16 v[148:151], a[24:27], a[4:7], v[148:151]
    ds_read_b128 a[244:247], v25 offset:9216
    v_add_f32 v36, v36, v100
    v_mfma_f32_16x16x32_bf16 v[148:151], a[56:59], a[36:39], v[148:151]
    ds_read_b128 a[248:251], v25 offset:10240
    v_add_f32 v37, v37, v101
    v_mfma_f32_16x16x32_bf16 v[152:155], a[24:27], a[8:11], v[152:155]
    ds_read_b128 a[252:255], v25 offset:11264
    v_add_f32 v38, v38, v102
    v_mfma_f32_16x16x32_bf16 v[152:155], a[56:59], a[40:43], v[152:155]
    buffer_load_dwordx4 v1, s[4:7], s46 offen offset:1024 sc1 lds
    s_add_u32 s46, s46, s63
    v_mfma_f32_16x16x32_bf16 v[156:159], a[24:27], a[12:15], v[156:159]
    v_add_f32 v39, v39, v103
    v_mfma_f32_16x16x32_bf16 v[156:159], a[56:59], a[44:47], v[156:159]
    v_mfma_f32_16x16x32_bf16 v[172:175], a[28:31], a[12:15], v[172:175]
    s_add_u32 m0, s49, 139264
    v_mfma_f32_16x16x32_bf16 v[172:175], a[60:63], a[44:47], v[172:175]
    buffer_load_dwordx4 v1, s[4:7], s47 offen offset:0 sc1 lds
    v_mfma_f32_16x16x32_bf16 v[168:171], a[28:31], a[8:11], v[168:171]
    v_add_f32 v52, v52, v108
    v_mfma_f32_16x16x32_bf16 v[168:171], a[60:63], a[40:43], v[168:171]
    v_add_f32 v53, v53, v109
    v_mfma_f32_16x16x32_bf16 v[164:167], a[28:31], a[4:7], v[164:167]
    v_add_f32 v54, v54, v110
    v_mfma_f32_16x16x32_bf16 v[164:167], a[60:63], a[36:39], v[164:167]
    v_mfma_f32_16x16x32_bf16 v[160:163], a[28:31], a[0:3], v[160:163]
    v_add_f32 v55, v55, v111
    v_mfma_f32_16x16x32_bf16 v[160:163], a[60:63], a[32:35], v[160:163]
    s_waitcnt vmcnt(11) lgkmcnt(0)
    s_barrier
    v_mfma_f32_16x16x32_bf16 v[32:35], a[208:211], a[192:195], v[32:35]
    ds_read_b128 a[0:3], v20 offset:32768
    v_mfma_f32_16x16x32_bf16 v[32:35], a[240:243], a[224:227], v[32:35]
    buffer_load_dwordx4 v1, s[4:7], s47 offen offset:1024 sc1 lds
    s_add_u32 s47, s47, s63
    v_mfma_f32_16x16x32_bf16 v[36:39], a[208:211], a[196:199], v[36:39]
    ds_read_b128 a[4:7], v20 offset:33792
    v_mfma_f32_16x16x32_bf16 v[36:39], a[240:243], a[228:231], v[36:39]
    ds_read_b128 a[8:11], v20 offset:40960
    v_mfma_f32_16x16x32_bf16 v[40:43], a[208:211], a[200:203], v[40:43]
    ds_read_b128 a[12:15], v20 offset:41984
    s_add_u32 m0, s50, 147456
    v_mfma_f32_16x16x32_bf16 v[40:43], a[240:243], a[232:235], v[40:43]
    buffer_load_dwordx4 v1, s[4:7], s48 offen offset:0 lds
    v_mfma_f32_16x16x32_bf16 v[44:47], a[208:211], a[204:207], v[44:47]
    ds_read_b128 a[16:19], v24 offset:32768
    v_mfma_f32_16x16x32_bf16 v[44:47], a[240:243], a[236:239], v[44:47]
    ds_read_b128 a[20:23], v24 offset:33792
    v_mfma_f32_16x16x32_bf16 v[60:63], a[212:215], a[204:207], v[60:63]
    ds_read_b128 a[24:27], v24 offset:34816
    v_mfma_f32_16x16x32_bf16 v[60:63], a[244:247], a[236:239], v[60:63]
    buffer_load_dwordx4 v1, s[4:7], s48 offen offset:1024 lds
    v_mfma_f32_16x16x32_bf16 v[56:59], a[212:215], a[200:203], v[56:59]
    ds_read_b128 a[28:31], v24 offset:35840
    v_mfma_f32_16x16x32_bf16 v[56:59], a[244:247], a[232:235], v[56:59]
    ds_read_b128 a[32:35], v20 offset:36864
    v_mfma_f32_16x16x32_bf16 v[52:55], a[212:215], a[196:199], v[52:55]
    ds_read_b128 a[36:39], v20 offset:37888
    v_mfma_f32_16x16x32_bf16 v[52:55], a[244:247], a[228:231], v[52:55]
    buffer_load_dwordx4 v1, s[4:7], s48 offen offset:2048 lds
    v_mfma_f32_16x16x32_bf16 v[48:51], a[212:215], a[192:195], v[48:51]
    ds_read_b128 a[40:43], v20 offset:45056
    v_mfma_f32_16x16x32_bf16 v[48:51], a[244:247], a[224:227], v[48:51]
    ds_read_b128 a[44:47], v20 offset:46080
    v_mfma_f32_16x16x32_bf16 v[144:147], a[216:219], a[192:195], v[144:147]
    ds_read_b128 a[48:51], v24 offset:40960
    v_mfma_f32_16x16x32_bf16 v[144:147], a[248:251], a[224:227], v[144:147]
    buffer_load_dwordx4 v1, s[4:7], s48 offen offset:3072 lds
    s_add_u32 s48, s48, s67
    v_mfma_f32_16x16x32_bf16 v[148:151], a[216:219], a[196:199], v[148:151]
    ds_read_b128 a[52:55], v24 offset:41984
    v_mfma_f32_16x16x32_bf16 v[148:151], a[248:251], a[228:231], v[148:151]
    ds_read_b128 a[56:59], v24 offset:43008
    v_mfma_f32_16x16x32_bf16 v[152:155], a[216:219], a[200:203], v[152:155]
    ds_read_b128 a[60:63], v24 offset:44032
    s_add_u32 m0, s49, 98304
    v_mfma_f32_16x16x32_bf16 v[152:155], a[248:251], a[232:235], v[152:155]
    buffer_load_dwordx4 v1, s[4:7], s46 offen offset:0 sc1 lds
    v_mfma_f32_16x16x32_bf16 v[156:159], a[216:219], a[204:207], v[156:159]
    v_mfma_f32_16x16x32_bf16 v[156:159], a[248:251], a[236:239], v[156:159]
    v_mfma_f32_16x16x32_bf16 v[172:175], a[220:223], a[204:207], v[172:175]
    v_mfma_f32_16x16x32_bf16 v[172:175], a[252:255], a[236:239], v[172:175]
    buffer_load_dwordx4 v1, s[4:7], s46 offen offset:1024 sc1 lds
    s_add_u32 s46, s46, s64
    v_mfma_f32_16x16x32_bf16 v[168:171], a[220:223], a[200:203], v[168:171]
    v_mfma_f32_16x16x32_bf16 v[168:171], a[252:255], a[232:235], v[168:171]
    v_mfma_f32_16x16x32_bf16 v[164:167], a[220:223], a[196:199], v[164:167]
    s_add_u32 m0, s49, 106496
    v_mfma_f32_16x16x32_bf16 v[164:167], a[252:255], a[228:231], v[164:167]
    buffer_load_dwordx4 v1, s[4:7], s47 offen offset:0 sc1 lds
    v_mfma_f32_16x16x32_bf16 v[160:163], a[220:223], a[192:195], v[160:163]
    v_mfma_f32_16x16x32_bf16 v[160:163], a[252:255], a[224:227], v[160:163]
    s_waitcnt vmcnt(11) lgkmcnt(0)
    s_barrier
    v_mfma_f32_16x16x32_bf16 v[32:35], a[16:19], a[0:3], v[32:35]
    ds_read_b128 a[192:195], v20 offset:0
    buffer_load_dword v27, off, s[4:7], s55 offset:768 sc1
    v_mfma_f32_16x16x32_bf16 v[32:35], a[48:51], a[32:35], v[32:35]
    v_mfma_f32_16x16x32_bf16 v[36:39], a[16:19], a[4:7], v[36:39]
    ds_read_b128 a[196:199], v20 offset:1024
    v_mfma_f32_16x16x32_bf16 v[36:39], a[48:51], a[36:39], v[36:39]
    ds_read_b128 a[200:203], v20 offset:8192
    buffer_load_dwordx4 v1, s[4:7], s47 offen offset:1024 sc1 lds
    s_add_u32 s47, s47, s64
    v_mfma_f32_16x16x32_bf16 v[40:43], a[16:19], a[8:11], v[40:43]
    ds_read_b128 a[204:207], v20 offset:9216
    v_mfma_f32_16x16x32_bf16 v[40:43], a[48:51], a[40:43], v[40:43]
    s_add_u32 m0, s50, 114688
    v_mfma_f32_16x16x32_bf16 v[44:47], a[16:19], a[12:15], v[44:47]
    ds_read_b128 a[208:211], v24 offset:0
    buffer_load_dwordx4 v1, s[4:7], s48 offen offset:0 lds
    v_mfma_f32_16x16x32_bf16 v[44:47], a[48:51], a[44:47], v[44:47]
    ds_read_b128 a[212:215], v24 offset:1024
    v_mfma_f32_16x16x32_bf16 v[60:63], a[20:23], a[12:15], v[60:63]
    ds_read_b128 a[216:219], v24 offset:2048
    v_mfma_f32_16x16x32_bf16 v[60:63], a[52:55], a[44:47], v[60:63]
    buffer_load_dwordx4 v1, s[4:7], s48 offen offset:1024 lds
    v_mfma_f32_16x16x32_bf16 v[56:59], a[20:23], a[8:11], v[56:59]
    ds_read_b128 a[220:223], v24 offset:3072
    v_mfma_f32_16x16x32_bf16 v[56:59], a[52:55], a[40:43], v[56:59]
    ds_read_b128 a[224:227], v20 offset:4096
    v_mfma_f32_16x16x32_bf16 v[52:55], a[20:23], a[4:7], v[52:55]
    ds_read_b128 a[228:231], v20 offset:5120
    buffer_load_dwordx4 v1, s[4:7], s48 offen offset:2048 lds
    v_mfma_f32_16x16x32_bf16 v[52:55], a[52:55], a[36:39], v[52:55]
    v_mfma_f32_16x16x32_bf16 v[48:51], a[20:23], a[0:3], v[48:51]
    ds_read_b128 a[232:235], v20 offset:12288
    v_mfma_f32_16x16x32_bf16 v[48:51], a[52:55], a[32:35], v[48:51]
    ds_read_b128 a[236:239], v20 offset:13312
    v_mfma_f32_16x16x32_bf16 v[144:147], a[24:27], a[0:3], v[144:147]
    ds_read_b128 a[240:243], v24 offset:8192
    buffer_load_dwordx4 v1, s[4:7], s48 offen offset:3072 lds
    s_add_u32 s48, s48, s68
    v_mfma_f32_16x16x32_bf16 v[144:147], a[56:59], a[32:35], v[144:147]
    v_mfma_f32_16x16x32_bf16 v[148:151], a[24:27], a[4:7], v[148:151]
    ds_read_b128 a[244:247], v24 offset:9216
    s_add_u32 m0, s49, 65536
    v_mfma_f32_16x16x32_bf16 v[148:151], a[56:59], a[36:39], v[148:151]
    ds_read_b128 a[248:251], v24 offset:10240
    buffer_load_dwordx4 v1, s[4:7], s46 offen offset:0 sc1 lds
    v_mfma_f32_16x16x32_bf16 v[152:155], a[24:27], a[8:11], v[152:155]
    ds_read_b128 a[252:255], v24 offset:11264
    v_mfma_f32_16x16x32_bf16 v[152:155], a[56:59], a[40:43], v[152:155]
    v_mfma_f32_16x16x32_bf16 v[156:159], a[24:27], a[12:15], v[156:159]
    buffer_load_dwordx4 v1, s[4:7], s46 offen offset:1024 sc1 lds
    s_add_u32 s46, s46, s65
    v_mfma_f32_16x16x32_bf16 v[156:159], a[56:59], a[44:47], v[156:159]
    v_mfma_f32_16x16x32_bf16 v[172:175], a[28:31], a[12:15], v[172:175]
    s_add_u32 m0, s49, 73728
    v_mfma_f32_16x16x32_bf16 v[172:175], a[60:63], a[44:47], v[172:175]
    buffer_load_dwordx4 v1, s[4:7], s47 offen offset:0 sc1 lds
    v_mfma_f32_16x16x32_bf16 v[168:171], a[28:31], a[8:11], v[168:171]
    v_mfma_f32_16x16x32_bf16 v[168:171], a[60:63], a[40:43], v[168:171]
    v_mfma_f32_16x16x32_bf16 v[164:167], a[28:31], a[4:7], v[164:167]
    s_waitcnt vmcnt(8)
    v_cmp_gt_u32 vcc, s71, v27
    s_nop 1
    s_cbranch_vccnz L_ffn_spin3
L_ffn_go3:
    v_mfma_f32_16x16x32_bf16 v[164:167], a[60:63], a[36:39], v[164:167]
    v_mfma_f32_16x16x32_bf16 v[160:163], a[28:31], a[0:3], v[160:163]
    v_mfma_f32_16x16x32_bf16 v[160:163], a[60:63], a[32:35], v[160:163]
    s_waitcnt lgkmcnt(0)
    s_barrier
    v_mfma_f32_16x16x32_bf16 v[32:35], a[208:211], a[192:195], v[32:35]
    ds_read_b128 a[0:3], v22 offset:0
    v_mfma_f32_16x16x32_bf16 v[32:35], a[240:243], a[224:227], v[32:35]
    buffer_load_dwordx4 v1, s[4:7], s47 offen offset:1024 sc1 lds
    s_add_u32 s47, s47, s65
    v_mfma_f32_16x16x32_bf16 v[36:39], a[208:211], a[196:199], v[36:39]
    ds_read_b128 a[4:7], v22 offset:1024
    v_mfma_f32_16x16x32_bf16 v[36:39], a[240:243], a[228:231], v[36:39]
    ds_read_b128 a[8:11], v22 offset:8192
    v_mfma_f32_16x16x32_bf16 v[40:43], a[208:211], a[200:203], v[40:43]
    ds_read_b128 a[12:15], v22 offset:9216
    s_add_u32 m0, s50, 81920
    v_mfma_f32_16x16x32_bf16 v[40:43], a[240:243], a[232:235], v[40:43]
    buffer_load_dwordx4 v1, s[4:7], s48 offen offset:0 lds
    v_mfma_f32_16x16x32_bf16 v[44:47], a[208:211], a[204:207], v[44:47]
    ds_read_b128 a[16:19], v26 offset:0
    v_mfma_f32_16x16x32_bf16 v[44:47], a[240:243], a[236:239], v[44:47]
    ds_read_b128 a[20:23], v26 offset:1024
    v_mfma_f32_16x16x32_bf16 v[60:63], a[212:215], a[204:207], v[60:63]
    ds_read_b128 a[24:27], v26 offset:2048
    v_mfma_f32_16x16x32_bf16 v[60:63], a[244:247], a[236:239], v[60:63]
    buffer_load_dwordx4 v1, s[4:7], s48 offen offset:1024 lds
    v_mfma_f32_16x16x32_bf16 v[56:59], a[212:215], a[200:203], v[56:59]
    ds_read_b128 a[28:31], v26 offset:3072
    v_mfma_f32_16x16x32_bf16 v[56:59], a[244:247], a[232:235], v[56:59]
    ds_read_b128 a[32:35], v22 offset:4096
    v_mfma_f32_16x16x32_bf16 v[52:55], a[212:215], a[196:199], v[52:55]
    ds_read_b128 a[36:39], v22 offset:5120
    v_mfma_f32_16x16x32_bf16 v[52:55], a[244:247], a[228:231], v[52:55]
    buffer_load_dwordx4 v1, s[4:7], s48 offen offset:2048 lds
    v_mfma_f32_16x16x32_bf16 v[48:51], a[212:215], a[192:195], v[48:51]
    ds_read_b128 a[40:43], v22 offset:12288
    v_mfma_f32_16x16x32_bf16 v[48:51], a[244:247], a[224:227], v[48:51]
    ds_read_b128 a[44:47], v22 offset:13312
    v_mfma_f32_16x16x32_bf16 v[144:147], a[216:219], a[192:195], v[144:147]
    ds_read_b128 a[48:51], v26 offset:8192
    v_mfma_f32_16x16x32_bf16 v[144:147], a[248:251], a[224:227], v[144:147]
    buffer_load_dwordx4 v1, s[4:7], s48 offen offset:3072 lds
    s_add_u32 s48, s48, s69
    v_mfma_f32_16x16x32_bf16 v[148:151], a[216:219], a[196:199], v[148:151]
    ds_read_b128 a[52:55], v26 offset:9216
    v_mfma_f32_16x16x32_bf16 v[148:151], a[248:251], a[228:231], v[148:151]
    ds_read_b128 a[56:59], v26 offset:10240
    v_mfma_f32_16x16x32_bf16 v[152:155], a[216:219], a[200:203], v[152:155]
    ds_read_b128 a[60:63], v26 offset:11264
    s_add_u32 m0, s49, 32768
    v_mfma_f32_16x16x32_bf16 v[152:155], a[248:251], a[232:235], v[152:155]
    buffer_load_dwordx4 v1, s[4:7], s46 offen offset:0 sc1 lds
    v_mfma_f32_16x16x32_bf16 v[156:159], a[216:219], a[204:207], v[156:159]
    v_mfma_f32_16x16x32_bf16 v[156:159], a[248:251], a[236:239], v[156:159]
    v_mfma_f32_16x16x32_bf16 v[172:175], a[220:223], a[204:207], v[172:175]
    v_mfma_f32_16x16x32_bf16 v[172:175], a[252:255], a[236:239], v[172:175]
    buffer_load_dwordx4 v1, s[4:7], s46 offen offset:1024 sc1 lds
    s_add_u32 s46, s46, s62
    v_mfma_f32_16x16x32_bf16 v[168:171], a[220:223], a[200:203], v[168:171]
    v_mfma_f32_16x16x32_bf16 v[168:171], a[252:255], a[232:235], v[168:171]
    v_mfma_f32_16x16x32_bf16 v[164:167], a[220:223], a[196:199], v[164:167]
    v_mfma_f32_16x16x32_bf16 v[164:167], a[252:255], a[228:231], v[164:167]
    v_mfma_f32_16x16x32_bf16 v[160:163], a[220:223], a[192:195], v[160:163]
    v_mfma_f32_16x16x32_bf16 v[160:163], a[252:255], a[224:227], v[160:163]
    s_branch L_isl15_over
.p2align 12
L_isl15:
    s_setpc_b64 s[14:15]
L_isl15_over:
    s_waitcnt vmcnt(10) lgkmcnt(0)
    s_barrier
    v_mfma_f32_16x16x32_bf16 v[32:35], a[16:19], a[0:3], v[32:35]
    ds_read_b128 a[192:195], v21 offset:32768
    s_add_u32 m0, s49, 40960
    v_mfma_f32_16x16x32_bf16 v[32:35], a[48:51], a[32:35], v[32:35]
    buffer_load_dwordx4 v1, s[4:7], s47 offen offset:0 sc1 lds
    v_mfma_f32_16x16x32_bf16 v[36:39], a[16:19], a[4:7], v[36:39]
    ds_read_b128 a[196:199], v21 offset:33792
    v_mfma_f32_16x16x32_bf16 v[36:39], a[48:51], a[36:39], v[36:39]
    ds_read_b128 a[200:203], v21 offset:40960
    v_mfma_f32_16x16x32_bf16 v[40:43], a[16:19], a[8:11], v[40:43]
    ds_read_b128 a[204:207], v21 offset:41984
    v_mfma_f32_16x16x32_bf16 v[40:43], a[48:51], a[40:43], v[40:43]
    buffer_load_dwordx4 v1, s[4:7], s47 offen offset:1024 sc1 lds
    s_add_u32 s47, s47, s62
    v_mfma_f32_16x16x32_bf16 v[44:47], a[16:19], a[12:15], v[44:47]
    ds_read_b128 a[208:211], v25 offset:32768
    v_mfma_f32_16x16x32_bf16 v[44:47], a[48:51], a[44:47], v[44:47]
    ds_read_b128 a[212:215], v25 offset:33792
    v_mfma_f32_16x16x32_bf16 v[60:63], a[20:23], a[12:15], v[60:63]
    ds_read_b128 a[216:219], v25 offset:34816
    s_add_u32 m0, s50, 49152
    v_mfma_f32_16x16x32_bf16 v[60:63], a[52:55], a[44:47], v[60:63]
    buffer_load_dwordx4 v1, s[4:7], s48 offen offset:0 lds
    v_mfma_f32_16x16x32_bf16 v[56:59], a[20:23], a[8:11], v[56:59]
    ds_read_b128 a[220:223], v25 offset:35840
    v_mfma_f32_16x16x32_bf16 v[56:59], a[52:55], a[40:43], v[56:59]
    ds_read_b128 a[224:227], v21 offset:36864
    v_mfma_f32_16x16x32_bf16 v[52:55], a[20:23], a[4:7], v[52:55]
    ds_read_b128 a[228:231], v21 offset:37888
    v_mfma_f32_16x16x32_bf16 v[52:55], a[52:55], a[36:39], v[52:55]
    buffer_load_dwordx4 v1, s[4:7], s48 offen offset:1024 lds
    v_mfma_f32_16x16x32_bf16 v[48:51], a[20:23], a[0:3], v[48:51]
    ds_read_b128 a[232:235], v21 offset:45056
    v_mfma_f32_16x16x32_bf16 v[48:51], a[52:55], a[32:35], v[48:51]
    ds_read_b128 a[236:239], v21 offset:46080
    v_mfma_f32_16x16x32_bf16 v[144:147], a[24:27], a[0:3], v[144:147]
    ds_read_b128 a[240:243], v25 offset:40960
    v_mfma_f32_16x16x32_bf16 v[144:147], a[56:59], a[32:35], v[144:147]
    buffer_load_dwordx4 v1, s[4:7], s48 offen offset:2048 lds
    v_mfma_f32_16x16x32_bf16 v[148:151], a[24:27], a[4:7], v[148:151]
    ds_read_b128 a[244:247], v25 offset:41984
    v_mfma_f32_16x16x32_bf16 v[148:151], a[56:59], a[36:39], v[148:151]
    ds_read_b128 a[248:251], v25 offset:43008
    v_mfma_f32_16x16x32_bf16 v[152:155], a[24:27], a[8:11], v[152:155]
    ds_read_b128 a[252:255], v25 offset:44032
    v_mfma_f32_16x16x32_bf16 v[152:155], a[56:59], a[40:43], v[152:155]
    buffer_load_dwordx4 v1, s[4:7], s48 offen offset:3072 lds
    s_add_u32 s48, s48, s66
    v_mfma_f32_16x16x32_bf16 v[156:159], a[24:27], a[12:15], v[156:159]
    v_mfma_f32_16x16x32_bf16 v[156:159], a[56:59], a[44:47], v[156:159]
    v_mfma_f32_16x16x32_bf16 v[172:175], a[28:31], a[12:15], v[172:175]
    s_add_u32 m0, s49, 0
    v_mfma_f32_16x16x32_bf16 v[172:175], a[60:63], a[44:47], v[172:175]
    buffer_load_dwordx4 v1, s[4:7], s46 offen offset:0 sc1 lds
    v_mfma_f32_16x16x32_bf16 v[168:171], a[28:31], a[8:11], v[168:171]
    v_mfma_f32_16x16x32_bf16 v[168:171], a[60:63], a[40:43], v[168:171]
    v_mfma_f32_16x16x32_bf16 v[164:167], a[28:31], a[4:7], v[164:167]
    v_mfma_f32_16x16x32_bf16 v[164:167], a[60:63], a[36:39], v[164:167]
    buffer_load_dwordx4 v1, s[4:7], s46 offen offset:1024 sc1 lds
    s_add_u32 s46, s46, s63
    v_mfma_f32_16x16x32_bf16 v[160:163], a[28:31], a[0:3], v[160:163]
    v_mfma_f32_16x16x32_bf16 v[160:163], a[60:63], a[32:35], v[160:163]
    s_waitcnt vmcnt(10) lgkmcnt(0)
    s_barrier
    v_mfma_f32_16x16x32_bf16 v[32:35], a[208:211], a[192:195], v[32:35]
    ds_read_b128 a[0:3], v21 offset:0
    s_add_u32 m0, s49, 8192
    v_mfma_f32_16x16x32_bf16 v[32:35], a[240:243], a[224:227], v[32:35]
    buffer_load_dwordx4 v1, s[4:7], s47 offen offset:0 sc1 lds
    v_mfma_f32_16x16x32_bf16 v[36:39], a[208:211], a[196:199], v[36:39]
    ds_read_b128 a[4:7], v21 offset:1024
    v_mfma_f32_16x16x32_bf16 v[36:39], a[240:243], a[228:231], v[36:39]
    ds_read_b128 a[8:11], v21 offset:8192
    v_mfma_f32_16x16x32_bf16 v[40:43], a[208:211], a[200:203], v[40:43]
    ds_read_b128 a[12:15], v21 offset:9216
    v_mfma_f32_16x16x32_bf16 v[40:43], a[240:243], a[232:235], v[40:43]
    buffer_load_dwordx4 v1, s[4:7], s47 offen offset:1024 sc1 lds
    s_add_u32 s47, s47, s63
    v_mfma_f32_16x16x32_bf16 v[44:47], a[208:211], a[204:207], v[44:47]
    ds_read_b128 a[16:19], v25 offset:0
    v_mfma_f32_16x16x32_bf16 v[44:47], a[240:243], a[236:239], v[44:47]
    ds_read_b128 a[20:23], v25 offset:1024
    v_mfma_f32_16x16x32_bf16 v[60:63], a[212:215], a[204:207], v[60:63]
    ds_read_b128 a[24:27], v25 offset:2048
    s_add_u32 m0, s50, 16384
    v_mfma_f32_16x16x32_bf16 v[60:63], a[244:247], a[236:239], v[60:63]
    buffer_load_dwordx4 v1, s[4:7], s48 offen offset:0 lds
    v_mfma_f32_16x16x32_bf16 v[56:59], a[212:215], a[200:203], v[56:59]
    ds_read_b128 a[28:31], v25 offset:3072
    v_mfma_f32_16x16x32_bf16 v[56:59], a[244:247], a[232:235], v[56:59]
    ds_read_b128 a[32:35], v21 offset:4096
    v_mfma_f32_16x16x32_bf16 v[52:55], a[212:215], a[196:199], v[52:55]
    ds_read_b128 a[36:39], v21 offset:5120
    v_mfma_f32_16x16x32_bf16 v[52:55], a[244:247], a[228:231], v[52:55]
    buffer_load_dwordx4 v1, s[4:7], s48 offen offset:1024 lds
    v_mfma_f32_16x16x32_bf16 v[48:51], a[212:215], a[192:195], v[48:51]
    ds_read_b128 a[40:43], v21 offset:12288
    v_mfma_f32_16x16x32_bf16 v[48:51], a[244:247], a[224:227], v[48:51]
    ds_read_b128 a[44:47], v21 offset:13312
    v_mfma_f32_16x16x32_bf16 v[144:147], a[216:219], a[192:195], v[144:147]
    ds_read_b128 a[48:51], v25 offset:8192
    v_mfma_f32_16x16x32_bf16 v[144:147], a[248:251], a[224:227], v[144:147]
    buffer_load_dwordx4 v1, s[4:7], s48 offen offset:2048 lds
    v_mfma_f32_16x16x32_bf16 v[148:151], a[216:219], a[196:199], v[148:151]
    ds_read_b128 a[52:55], v25 offset:9216
    v_mfma_f32_16x16x32_bf16 v[148:151], a[248:251], a[228:231], v[148:151]
    ds_read_b128 a[56:59], v25 offset:10240
    v_mfma_f32_16x16x32_bf16 v[152:155], a[216:219], a[200:203], v[152:155]
    ds_read_b128 a[60:63], v25 offset:11264
    v_mfma_f32_16x16x32_bf16 v[152:155], a[248:251], a[232:235], v[152:155]
    buffer_load_dwordx4 v1, s[4:7], s48 offen offset:3072 lds
    s_add_u32 s48, s48, s67
    v_mfma_f32_16x16x32_bf16 v[156:159], a[216:219], a[204:207], v[156:159]
    v_mfma_f32_16x16x32_bf16 v[156:159], a[248:251], a[236:239], v[156:159]
    v_mfma_f32_16x16x32_bf16 v[172:175], a[220:223], a[204:207], v[172:175]
    s_add_u32 m0, s49, 131072
    v_mfma_f32_16x16x32_bf16 v[172:175], a[252:255], a[236:239], v[172:175]
    buffer_load_dwordx4 v1, s[4:7], s46 offen offset:0 sc1 lds
    v_mfma_f32_16x16x32_bf16 v[168:171], a[220:223], a[200:203], v[168:171]
    v_mfma_f32_16x16x32_bf16 v[168:171], a[252:255], a[232:235], v[168:171]
    v_mfma_f32_16x16x32_bf16 v[164:167], a[220:223], a[196:199], v[164:167]
    v_mfma_f32_16x16x32_bf16 v[164:167], a[252:255], a[228:231], v[164:167]
    buffer_load_dwordx4 v1, s[4:7], s46 offen offset:1024 sc1 lds
    s_add_u32 s46, s46, s64
    v_mfma_f32_16x16x32_bf16 v[160:163], a[220:223], a[192:195], v[160:163]
    v_mfma_f32_16x16x32_bf16 v[160:163], a[252:255], a[224:227], v[160:163]
    s_waitcnt vmcnt(10) lgkmcnt(0)
    s_barrier
    v_mfma_f32_16x16x32_bf16 v[32:35], a[16:19], a[0:3], v[32:35]
    ds_read_b128 a[192:195], v20 offset:32768
    s_add_u32 m0, s49, 139264
    v_mfma_f32_16x16x32_bf16 v[32:35], a[48:51], a[32:35], v[32:35]
    buffer_load_dwordx4 v1, s[4:7], s47 offen offset:0 sc1 lds
    v_mfma_f32_16x16x32_bf16 v[36:39], a[16:19], a[4:7], v[36:39]
    ds_read_b128 a[196:199], v20 offset:33792
    v_mfma_f32_16x16x32_bf16 v[36:39], a[48:51], a[36:39], v[36:39]
    ds_read_b128 a[200:203], v20 offset:40960
    v_mfma_f32_16x16x32_bf16 v[40:43], a[16:19], a[8:11], v[40:43]
    ds_read_b128 a[204:207], v20 offset:41984
    v_mfma_f32_16x16x32_bf16 v[40:43], a[48:51], a[40:43], v[40:43]
    buffer_load_dwordx4 v1, s[4:7], s47 offen offset:1024 sc1 lds
    s_add_u32 s47, s47, s64
    v_mfma_f32_16x16x32_bf16 v[44:47], a[16:19], a[12:15], v[44:47]
    ds_read_b128 a[208:211], v24 offset:32768
    v_mfma_f32_16x16x32_bf16 v[44:47], a[48:51], a[44:47], v[44:47]
    ds_read_b128 a[212:215], v24 offset:33792
    v_mfma_f32_16x16x32_bf16 v[60:63], a[20:23], a[12:15], v[60:63]
    ds_read_b128 a[216:219], v24 offset:34816
    s_add_u32 m0, s50, 147456
    v_mfma_f32_16x16x32_bf16 v[60:63], a[52:55], a[44:47], v[60:63]
    buffer_load_dwordx4 v1, s[4:7], s48 offen offset:0 lds
    v_mfma_f32_16x16x32_bf16 v[56:59], a[20:23], a[8:11], v[56:59]
    ds_read_b128 a[220:223], v24 offset:35840
    v_mfma_f32_16x16x32_bf16 v[56:59], a[52:55], a[40:43], v[56:59]
    ds_read_b128 a[224:227], v20 offset:36864
    v_mfma_f32_16x16x32_bf16 v[52:55], a[20:23], a[4:7], v[52:55]
    ds_read_b128 a[228:231], v20 offset:37888
    v_mfma_f32_16x16x32_bf16 v[52:55], a[52:55], a[36:39], v[52:55]
    buffer_load_dwordx4 v1, s[4:7], s48 offen offset:1024 lds
    v_mfma_f32_16x16x32_bf16 v[48:51], a[20:23], a[0:3], v[48:51]
    ds_read_b128 a[232:235], v20 offset:45056
    v_mfma_f32_16x16x32_bf16 v[48:51], a[52:55], a[32:35], v[48:51]
    ds_read_b128 a[236:239], v20 offset:46080
    v_mfma_f32_16x16x32_bf16 v[144:147], a[24:27], a[0:3], v[144:147]
    ds_read_b128 a[240:243], v24 offset:40960
    v_mfma_f32_16x16x32_bf16 v[144:147], a[56:59], a[32:35], v[144:147]
    buffer_load_dwordx4 v1, s[4:7], s48 offen offset:2048 lds
    v_mfma_f32_16x16x32_bf16 v[148:151], a[24:27], a[4:7], v[148:151]
    ds_read_b128 a[244:247], v24 offset:41984
    v_mfma_f32_16x16x32_bf16 v[148:151], a[56:59], a[36:39], v[148:151]
    ds_read_b128 a[248:251], v24 offset:43008
    v_mfma_f32_16x16x32_bf16 v[152:155], a[24:27], a[8:11], v[152:155]
    ds_read_b128 a[252:255], v24 offset:44032
    v_mfma_f32_16x16x32_bf16 v[152:155], a[56:59], a[40:43], v[152:155]
    buffer_load_dwordx4 v1, s[4:7], s48 offen offset:3072 lds
    s_add_u32 s48, s48, s68
    v_mfma_f32_16x16x32_bf16 v[156:159], a[24:27], a[12:15], v[156:159]
    v_mfma_f32_16x16x32_bf16 v[156:159], a[56:59], a[44:47], v[156:159]
    v_mfma_f32_16x16x32_bf16 v[172:175], a[28:31], a[12:15], v[172:175]
    s_add_u32 m0, s49, 98304
    v_mfma_f32_16x16x32_bf16 v[172:175], a[60:63], a[44:47], v[172:175]
    buffer_load_dwordx4 v1, s[4:7], s46 offen offset:0 sc1 lds
    v_mfma_f32_16x16x32_bf16 v[168:171], a[28:31], a[8:11], v[168:171]
    v_mfma_f32_16x16x32_bf16 v[168:171], a[60:63], a[40:43], v[168:171]
    v_mfma_f32_16x16x32_bf16 v[164:167], a[28:31], a[4:7], v[164:167]
    v_mfma_f32_16x16x32_bf16 v[164:167], a[60:63], a[36:39], v[164:167]
    v_mfma_f32_16x16x32_bf16 v[160:163], a[28:31], a[0:3], v[160:163]
    v_mfma_f32_16x16x32_bf16 v[160:163], a[60:63], a[32:35], v[160:163]
    s_waitcnt vmcnt(9) lgkmcnt(0)
    s_barrier
    v_mfma_f32_16x16x32_bf16 v[32:35], a[208:211], a[192:195], v[32:35]
    ds_read_b128 a[0:3], v20 offset:0
    v_mfma_f32_16x16x32_bf16 v[32:35], a[240:243], a[224:227], v[32:35]
    buffer_load_dwordx4 v1, s[4:7], s46 offen offset:1024 sc1 lds
    s_add_u32 s46, s46, s65
    v_mfma_f32_16x16x32_bf16 v[36:39], a[208:211], a[196:199], v[36:39]
    ds_read_b128 a[4:7], v20 offset:1024
    v_mfma_f32_16x16x32_bf16 v[36:39], a[240:243], a[228:231], v[36:39]
    ds_read_b128 a[8:11], v20 offset:8192
    v_mfma_f32_16x16x32_bf16 v[40:43], a[208:211], a[200:203], v[40:43]
    ds_read_b128 a[12:15], v20 offset:9216
    s_add_u32 m0, s49, 106496
    v_mfma_f32_16x16x32_bf16 v[40:43], a[240:243], a[232:235], v[40:43]
    buffer_load_dwordx4 v1, s[4:7], s47 offen offset:0 sc1 lds
    v_mfma_f32_16x16x32_bf16 v[44:47], a[208:211], a[204:207], v[44:47]
    ds_read_b128 a[16:19], v24 offset:0
    v_mfma_f32_16x16x32_bf16 v[44:47], a[240:243], a[236:239], v[44:47]
    ds_read_b128 a[20:23], v24 offset:1024
    v_mfma_f32_16x16x32_bf16 v[60:63], a[212:215], a[204:207], v[60:63]
    ds_read_b128 a[24:27], v24 offset:2048
    v_mfma_f32_16x16x32_bf16 v[60:63], a[244:247], a[236:239], v[60:63]
    buffer_load_dwordx4 v1, s[4:7], s47 offen offset:1024 sc1 lds
    s_add_u32 s47, s47, s65
    v_mfma_f32_16x16x32_bf16 v[56:59], a[212:215], a[200:203], v[56:59]
    ds_read_b128 a[28:31], v24 offset:3072
    v_mfma_f32_16x16x32_bf16 v[56:59], a[244:247], a[232:235], v[56:59]
    ds_read_b128 a[32:35], v20 offset:4096
    v_mfma_f32_16x16x32_bf16 v[52:55], a[212:215], a[196:199], v[52:55]
    ds_read_b128 a[36:39], v20 offset:5120
    s_add_u32 m0, s50, 114688
    v_mfma_f32_16x16x32_bf16 v[52:55], a[244:247], a[228:231], v[52:55]
    buffer_load_dwordx4 v1, s[4:7], s48 offen offset:0 lds
    v_mfma_f32_16x16x32_bf16 v[48:51], a[212:215], a[192:195], v[48:51]
    ds_read_b128 a[40:43], v20 offset:12288
    v_mfma_f32_16x16x32_bf16 v[48:51], a[244:247], a[224:227], v[48:51]
    ds_read_b128 a[44:47], v20 offset:13312
    v_mfma_f32_16x16x32_bf16 v[144:147], a[216:219], a[192:195], v[144:147]
    ds_read_b128 a[48:51], v24 offset:8192
    v_mfma_f32_16x16x32_bf16 v[144:147], a[248:251], a[224:227], v[144:147]
    buffer_load_dwordx4 v1, s[4:7], s48 offen offset:1024 lds
    v_mfma_f32_16x16x32_bf16 v[148:151], a[216:219], a[196:199], v[148:151]
    ds_read_b128 a[52:55], v24 offset:9216
    v_mfma_f32_16x16x32_bf16 v[148:151], a[248:251], a[228:231], v[148:151]
    ds_read_b128 a[56:59], v24 offset:10240
    v_mfma_f32_16x16x32_bf16 v[152:155], a[216:219], a[200:203], v[152:155]
    ds_read_b128 a[60:63], v24 offset:11264
    v_mfma_f32_16x16x32_bf16 v[152:155], a[248:251], a[232:235], v[152:155]
    buffer_load_dwordx4 v1, s[4:7], s48 offen offset:2048 lds
    v_mfma_f32_16x16x32_bf16 v[156:159], a[216:219], a[204:207], v[156:159]
    v_mfma_f32_16x16x32_bf16 v[156:159], a[248:251], a[236:239], v[156:159]
    v_mfma_f32_16x16x32_bf16 v[172:175], a[220:223], a[204:207], v[172:175]
    v_mfma_f32_16x16x32_bf16 v[172:175], a[252:255], a[236:239], v[172:175]
    buffer_load_dwordx4 v1, s[4:7], s48 offen offset:3072 lds
    s_add_u32 s48, s48, s69
    v_mfma_f32_16x16x32_bf16 v[168:171], a[220:223], a[200:203], v[168:171]
    v_mfma_f32_16x16x32_bf16 v[168:171], a[252:255], a[232:235], v[168:171]
    v_mfma_f32_16x16x32_bf16 v[164:167], a[220:223], a[196:199], v[164:167]
    v_mfma_f32_16x16x32_bf16 v[164:167], a[252:255], a[228:231], v[164:167]
    s_add_u32 s46, s46, s58
    s_add_u32 s47, s47, s58
    s_add_u32 m0, s49, 65536
    s_nop 0
    buffer_load_dwordx4 v1, s[4:7], s46 offen offset:0 sc1 lds
    v_mfma_f32_16x16x32_bf16 v[160:163], a[220:223], a[192:195], v[160:163]
    v_mfma_f32_16x16x32_bf16 v[160:163], a[252:255], a[224:227], v[160:163]
    s_waitcnt vmcnt(9) lgkmcnt(0)
    s_barrier
    v_mfma_f32_16x16x32_bf16 v[32:35], a[16:19], a[0:3], v[32:35]
    ds_read_b128 a[192:195], v22 offset:0
    v_mfma_f32_16x16x32_bf16 v[32:35], a[48:51], a[32:35], v[32:35]
    buffer_load_dwordx4 v1, s[4:7], s46 offen offset:1024 sc1 lds
    s_add_u32 s46, s46, 8192
    v_mfma_f32_16x16x32_bf16 v[36:39], a[16:19], a[4:7], v[36:39]
    ds_read_b128 a[196:199], v22 offset:1024
    v_mfma_f32_16x16x32_bf16 v[36:39], a[48:51], a[36:39], v[36:39]
    ds_read_b128 a[200:203], v22 offset:8192
    v_mfma_f32_16x16x32_bf16 v[40:43], a[16:19], a[8:11], v[40:43]
    ds_read_b128 a[204:207], v22 offset:9216
    s_add_u32 m0, s49, 73728
    v_mfma_f32_16x16x32_bf16 v[40:43], a[48:51], a[40:43], v[40:43]
    buffer_load_dwordx4 v1, s[4:7], s47 offen offset:0 sc1 lds
    v_mfma_f32_16x16x32_bf16 v[44:47], a[16:19], a[12:15], v[44:47]
    ds_read_b128 a[208:211], v26 offset:0
    v_mfma_f32_16x16x32_bf16 v[44:47], a[48:51], a[44:47], v[44:47]
    ds_read_b128 a[212:215], v26 offset:1024
    v_mfma_f32_16x16x32_bf16 v[60:63], a[20:23], a[12:15], v[60:63]
    ds_read_b128 a[216:219], v26 offset:2048
    v_mfma_f32_16x16x32_bf16 v[60:63], a[52:55], a[44:47], v[60:63]
    buffer_load_dwordx4 v1, s[4:7], s47 offen offset:1024 sc1 lds
    s_add_u32 s47, s47, 8192
    v_mfma_f32_16x16x32_bf16 v[56:59], a[20:23], a[8:11], v[56:59]
    ds_read_b128 a[220:223], v26 offset:3072
    v_mfma_f32_16x16x32_bf16 v[56:59], a[52:55], a[40:43], v[56:59]
    ds_read_b128 a[224:227], v22 offset:4096
    v_mfma_f32_16x16x32_bf16 v[52:55], a[20:23], a[4:7], v[52:55]
    ds_read_b128 a[228:231], v22 offset:5120
    v_mfma_f32_16x16x32_bf16 v[52:55], a[52:55], a[36:39], v[52:55]
    s_add_u32 s48, s48, s58
    s_add_u32 s48, s48, s58
    s_add_u32 m0, s50, 81920
    s_nop 0
    buffer_load_dwordx4 v1, s[4:7], s48 offen offset:0 lds
    v_mfma_f32_16x16x32_bf16 v[48:51], a[20:23], a[0:3], v[48:51]
    ds_read_b128 a[232:235], v22 offset:12288
    v_mfma_f32_16x16x32_bf16 v[48:51], a[52:55], a[32:35], v[48:51]
    ds_read_b128 a[236:239], v22 offset:13312
    v_mfma_f32_16x16x32_bf16 v[144:147], a[24:27], a[0:3], v[144:147]
    ds_read_b128 a[240:243], v26 offset:8192
    v_mfma_f32_16x16x32_bf16 v[144:147], a[56:59], a[32:35], v[144:147]
    buffer_load_dwordx4 v1, s[4:7], s48 offen offset:1024 lds
    v_mfma_f32_16x16x32_bf16 v[148:151], a[24:27], a[4:7], v[148:151]
    ds_read_b128 a[244:247], v26 offset:9216
    v_mfma_f32_16x16x32_bf16 v[148:151], a[56:59], a[36:39], v[148:151]
    ds_read_b128 a[248:251], v26 offset:10240
    v_mfma_f32_16x16x32_bf16 v[152:155], a[24:27], a[8:11], v[152:155]
    ds_read_b128 a[252:255], v26 offset:11264
    v_mfma_f32_16x16x32_bf16 v[152:155], a[56:59], a[40:43], v[152:155]
    buffer_load_dwordx4 v1, s[4:7], s48 offen offset:2048 lds
    v_mfma_f32_16x16x32_bf16 v[156:159], a[24:27], a[12:15], v[156:159]
    v_mfma_f32_16x16x32_bf16 v[156:159], a[56:59], a[44:47], v[156:159]
    v_mfma_f32_16x16x32_bf16 v[172:175], a[28:31], a[12:15], v[172:175]
    v_mfma_f32_16x16x32_bf16 v[172:175], a[60:63], a[44:47], v[172:175]
    buffer_load_dwordx4 v1, s[4:7], s48 offen offset:3072 lds
    s_add_u32 s48, s48, 16384
    v_mfma_f32_16x16x32_bf16 v[168:171], a[28:31], a[8:11], v[168:171]
    v_mfma_f32_16x16x32_bf16 v[168:171], a[60:63], a[40:43], v[168:171]
    v_mfma_f32_16x16x32_bf16 v[164:167], a[28:31], a[4:7], v[164:167]
    s_add_u32 m0, s49, 32768
    v_mfma_f32_16x16x32_bf16 v[164:167], a[60:63], a[36:39], v[164:167]
    buffer_load_dwordx4 v1, s[4:7], s46 offen offset:0 sc1 lds
    v_mfma_f32_16x16x32_bf16 v[160:163], a[28:31], a[0:3], v[160:163]
    v_mfma_f32_16x16x32_bf16 v[160:163], a[60:63], a[32:35], v[160:163]
    s_waitcnt vmcnt(9) lgkmcnt(0)
    s_barrier
    v_mfma_f32_16x16x32_bf16 v[32:35], a[208:211], a[192:195], v[32:35]
    ds_read_b128 a[0:3], v21 offset:32768
    v_mfma_f32_16x16x32_bf16 v[32:35], a[240:243], a[224:227], v[32:35]
    buffer_load_dwordx4 v1, s[4:7], s46 offen offset:1024 sc1 lds
    s_add_u32 s46, s46, 8192
    v_mfma_f32_16x16x32_bf16 v[36:39], a[208:211], a[196:199], v[36:39]
    ds_read_b128 a[4:7], v21 offset:33792
    v_mfma_f32_16x16x32_bf16 v[36:39], a[240:243], a[228:231], v[36:39]
    ds_read_b128 a[8:11], v21 offset:40960
    v_mfma_f32_16x16x32_bf16 v[40:43], a[208:211], a[200:203], v[40:43]
    ds_read_b128 a[12:15], v21 offset:41984
    s_add_u32 m0, s49, 40960
    v_mfma_f32_16x16x32_bf16 v[40:43], a[240:243], a[232:235], v[40:43]
    buffer_load_dwordx4 v1, s[4:7], s47 offen offset:0 sc1 lds
    v_mfma_f32_16x16x32_bf16 v[44:47], a[208:211], a[204:207], v[44:47]
    ds_read_b128 a[16:19], v25 offset:32768
    v_mfma_f32_16x16x32_bf16 v[44:47], a[240:243], a[236:239], v[44:47]
    ds_read_b128 a[20:23], v25 offset:33792
    v_mfma_f32_16x16x32_bf16 v[60:63], a[212:215], a[204:207], v[60:63]
    ds_read_b128 a[24:27], v25 offset:34816
    v_mfma_f32_16x16x32_bf16 v[60:63], a[244:247], a[236:239], v[60:63]
    buffer_load_dwordx4 v1, s[4:7], s47 offen offset:1024 sc1 lds
    s_add_u32 s47, s47, 8192
    v_mfma_f32_16x16x32_bf16 v[56:59], a[212:215], a[200:203], v[56:59]
    ds_read_b128 a[28:31], v25 offset:35840
    v_mfma_f32_16x16x32_bf16 v[56:59], a[244:247], a[232:235], v[56:59]
    ds_read_b128 a[32:35], v21 offset:36864
    v_mfma_f32_16x16x32_bf16 v[52:55], a[212:215], a[196:199], v[52:55]
    ds_read_b128 a[36:39], v21 offset:37888
    s_add_u32 m0, s50, 49152
    v_mfma_f32_16x16x32_bf16 v[52:55], a[244:247], a[228:231], v[52:55]
    buffer_load_dwordx4 v1, s[4:7], s48 offen offset:0 lds
    v_mfma_f32_16x16x32_bf16 v[48:51], a[212:215], a[192:195], v[48:51]
    ds_read_b128 a[40:43], v21 offset:45056
    v_mfma_f32_16x16x32_bf16 v[48:51], a[244:247], a[224:227], v[48:51]
    ds_read_b128 a[44:47], v21 offset:46080
    v_mfma_f32_16x16x32_bf16 v[144:147], a[216:219], a[192:195], v[144:147]
    ds_read_b128 a[48:51], v25 offset:40960
    v_mfma_f32_16x16x32_bf16 v[144:147], a[248:251], a[224:227], v[144:147]
    buffer_load_dwordx4 v1, s[4:7], s48 offen offset:1024 lds
    v_mfma_f32_16x16x32_bf16 v[148:151], a[216:219], a[196:199], v[148:151]
    ds_read_b128 a[52:55], v25 offset:41984
    v_mfma_f32_16x16x32_bf16 v[148:151], a[248:251], a[228:231], v[148:151]
    ds_read_b128 a[56:59], v25 offset:43008
    v_mfma_f32_16x16x32_bf16 v[152:155], a[216:219], a[200:203], v[152:155]
    ds_read_b128 a[60:63], v25 offset:44032
    v_mfma_f32_16x16x32_bf16 v[152:155], a[248:251], a[232:235], v[152:155]
    buffer_load_dwordx4 v1, s[4:7], s48 offen offset:2048 lds
    v_mfma_f32_16x16x32_bf16 v[156:159], a[216:219], a[204:207], v[156:159]
    v_mfma_f32_16x16x32_bf16 v[156:159], a[248:251], a[236:239], v[156:159]
    v_mfma_f32_16x16x32_bf16 v[172:175], a[220:223], a[204:207], v[172:175]
    v_mfma_f32_16x16x32_bf16 v[172:175], a[252:255], a[236:239], v[172:175]
    buffer_load_dwordx4 v1, s[4:7], s48 offen offset:3072 lds
    s_add_u32 s48, s48, 16384
    v_mfma_f32_16x16x32_bf16 v[168:171], a[220:223], a[200:203], v[168:171]
    v_mfma_f32_16x16x32_bf16 v[168:171], a[252:255], a[232:235], v[168:171]
    v_mfma_f32_16x16x32_bf16 v[164:167], a[220:223], a[196:199], v[164:167]
    v_mfma_f32_16x16x32_bf16 v[164:167], a[252:255], a[228:231], v[164:167]
    v_mfma_f32_16x16x32_bf16 v[160:163], a[220:223], a[192:195], v[160:163]
    v_mfma_f32_16x16x32_bf16 v[160:163], a[252:255], a[224:227], v[160:163]
    s_waitcnt vmcnt(8) lgkmcnt(0)
    s_barrier
    v_mfma_f32_16x16x32_bf16 v[32:35], a[16:19], a[0:3], v[32:35]
    ds_read_b128 a[192:195], v21 offset:0
    v_mfma_f32_16x16x32_bf16 v[32:35], a[48:51], a[32:35], v[32:35]
    s_mul_i32 s46, s44, 458752
    s_add_u32 s46, s46, s49
    s_add_u32 s46, s46, 14057472
    s_add_u32 m0, s49, 0
    s_nop 0
    buffer_load_dwordx4 v1, s[4:7], s46 offen offset:0 sc1 lds
    v_mfma_f32_16x16x32_bf16 v[36:39], a[16:19], a[4:7], v[36:39]
    ds_read_b128 a[196:199], v21 offset:1024
    v_mfma_f32_16x16x32_bf16 v[36:39], a[48:51], a[36:39], v[36:39]
    ds_read_b128 a[200:203], v21 offset:8192
    v_mfma_f32_16x16x32_bf16 v[40:43], a[16:19], a[8:11], v[40:43]
    ds_read_b128 a[204:207], v21 offset:9216
    v_mfma_f32_16x16x32_bf16 v[40:43], a[48:51], a[40:43], v[40:43]
    buffer_load_dwordx4 v1, s[4:7], s46 offen offset:1024 sc1 lds
    s_add_u32 s46, s46, 8192
    v_mfma_f32_16x16x32_bf16 v[44:47], a[16:19], a[12:15], v[44:47]
    ds_read_b128 a[208:211], v25 offset:0
    v_mfma_f32_16x16x32_bf16 v[44:47], a[48:51], a[44:47], v[44:47]
    ds_read_b128 a[212:215], v25 offset:1024
    v_mfma_f32_16x16x32_bf16 v[60:63], a[20:23], a[12:15], v[60:63]
    ds_read_b128 a[216:219], v25 offset:2048
    v_mfma_f32_16x16x32_bf16 v[60:63], a[52:55], a[44:47], v[60:63]
    s_mul_i32 s48, s45, 917504
    s_add_u32 s48, s48, s50
    s_add_u32 s48, s48, 46989312
    s_add_u32 m0, s50, 16384
    s_nop 0
    buffer_load_dwordx4 v1, s[4:7], s48 offen offset:0 lds
    v_mfma_f32_16x16x32_bf16 v[56:59], a[20:23], a[8:11], v[56:59]
    ds_read_b128 a[220:223], v25 offset:3072
    v_mfma_f32_16x16x32_bf16 v[56:59], a[52:55], a[40:43], v[56:59]
    ds_read_b128 a[224:227], v21 offset:4096
    v_mfma_f32_16x16x32_bf16 v[52:55], a[20:23], a[4:7], v[52:55]
    ds_read_b128 a[228:231], v21 offset:5120
    v_mfma_f32_16x16x32_bf16 v[52:55], a[52:55], a[36:39], v[52:55]
    buffer_load_dwordx4 v1, s[4:7], s48 offen offset:1024 lds
    v_mfma_f32_16x16x32_bf16 v[48:51], a[20:23], a[0:3], v[48:51]
    ds_read_b128 a[232:235], v21 offset:12288
    v_mfma_f32_16x16x32_bf16 v[48:51], a[52:55], a[32:35], v[48:51]
    ds_read_b128 a[236:239], v21 offset:13312
    v_mfma_f32_16x16x32_bf16 v[144:147], a[24:27], a[0:3], v[144:147]
    ds_read_b128 a[240:243], v25 offset:8192
    v_mfma_f32_16x16x32_bf16 v[144:147], a[56:59], a[32:35], v[144:147]
    buffer_load_dwordx4 v1, s[4:7], s48 offen offset:2048 lds
    v_mfma_f32_16x16x32_bf16 v[148:151], a[24:27], a[4:7], v[148:151]
    ds_read_b128 a[244:247], v25 offset:9216
    v_mfma_f32_16x16x32_bf16 v[148:151], a[56:59], a[36:39], v[148:151]
    ds_read_b128 a[248:251], v25 offset:10240
    v_mfma_f32_16x16x32_bf16 v[152:155], a[24:27], a[8:11], v[152:155]
    ds_read_b128 a[252:255], v25 offset:11264
    v_mfma_f32_16x16x32_bf16 v[152:155], a[56:59], a[40:43], v[152:155]
    buffer_load_dwordx4 v1, s[4:7], s48 offen offset:3072 lds
    s_add_u32 s48, s48, 16384
    v_mfma_f32_16x16x32_bf16 v[156:159], a[24:27], a[12:15], v[156:159]
    v_mfma_f32_16x16x32_bf16 v[156:159], a[56:59], a[44:47], v[156:159]
    v_mfma_f32_16x16x32_bf16 v[172:175], a[28:31], a[12:15], v[172:175]
    s_add_u32 m0, s49, 131072
    v_mfma_f32_16x16x32_bf16 v[172:175], a[60:63], a[44:47], v[172:175]
    buffer_load_dwordx4 v1, s[4:7], s46 offen offset:0 sc1 lds
    v_mfma_f32_16x16x32_bf16 v[168:171], a[28:31], a[8:11], v[168:171]
    v_mfma_f32_16x16x32_bf16 v[168:171], a[60:63], a[40:43], v[168:171]
    v_mfma_f32_16x16x32_bf16 v[164:167], a[28:31], a[4:7], v[164:167]
    v_mfma_f32_16x16x32_bf16 v[164:167], a[60:63], a[36:39], v[164:167]
    buffer_load_dwordx4 v1, s[4:7], s46 offen offset:1024 sc1 lds
    s_add_u32 s46, s46, 8192
    v_mfma_f32_16x16x32_bf16 v[160:163], a[28:31], a[0:3], v[160:163]
    v_mfma_f32_16x16x32_bf16 v[160:163], a[60:63], a[32:35], v[160:163]
    s_branch L_isl16_over
.p2align 12
L_isl16:
    s_setpc_b64 s[14:15]
L_isl16_over:
    s_waitcnt vmcnt(8) lgkmcnt(0)
    s_barrier
    v_mfma_f32_16x16x32_bf16 v[32:35], a[208:211], a[192:195], v[32:35]
    ds_read_b128 a[0:3], v20 offset:32768
    s_add_u32 m0, s50, 147456
    v_mfma_f32_16x16x32_bf16 v[32:35], a[240:243], a[224:227], v[32:35]
    buffer_load_dwordx4 v1, s[4:7], s48 offen offset:0 lds
    v_mfma_f32_16x16x32_bf16 v[36:39], a[208:211], a[196:199], v[36:39]
    ds_read_b128 a[4:7], v20 offset:33792
    v_mfma_f32_16x16x32_bf16 v[36:39], a[240:243], a[228:231], v[36:39]
    ds_read_b128 a[8:11], v20 offset:40960
    v_mfma_f32_16x16x32_bf16 v[40:43], a[208:211], a[200:203], v[40:43]
    ds_read_b128 a[12:15], v20 offset:41984
    v_mfma_f32_16x16x32_bf16 v[40:43], a[240:243], a[232:235], v[40:43]
    buffer_load_dwordx4 v1, s[4:7], s48 offen offset:1024 lds
    v_mfma_f32_16x16x32_bf16 v[44:47], a[208:211], a[204:207], v[44:47]
    ds_read_b128 a[16:19], v24 offset:32768
    v_mfma_f32_16x16x32_bf16 v[44:47], a[240:243], a[236:239], v[44:47]
    ds_read_b128 a[20:23], v24 offset:33792
    v_mfma_f32_16x16x32_bf16 v[60:63], a[212:215], a[204:207], v[60:63]
    ds_read_b128 a[24:27], v24 offset:34816
    v_mfma_f32_16x16x32_bf16 v[60:63], a[244:247], a[236:239], v[60:63]
    buffer_load_dwordx4 v1, s[4:7], s48 offen offset:2048 lds
    v_mfma_f32_16x16x32_bf16 v[56:59], a[212:215], a[200:203], v[56:59]
    ds_read_b128 a[28:31], v24 offset:35840
    v_mfma_f32_16x16x32_bf16 v[56:59], a[244:247], a[232:235], v[56:59]
    ds_read_b128 a[32:35], v20 offset:36864
    v_mfma_f32_16x16x32_bf16 v[52:55], a[212:215], a[196:199], v[52:55]
    ds_read_b128 a[36:39], v20 offset:37888
    v_mfma_f32_16x16x32_bf16 v[52:55], a[244:247], a[228:231], v[52:55]
    buffer_load_dwordx4 v1, s[4:7], s48 offen offset:3072 lds
    s_add_u32 s48, s48, 16384
    v_mfma_f32_16x16x32_bf16 v[48:51], a[212:215], a[192:195], v[48:51]
    ds_read_b128 a[40:43], v20 offset:45056
    v_mfma_f32_16x16x32_bf16 v[48:51], a[244:247], a[224:227], v[48:51]
    ds_read_b128 a[44:47], v20 offset:46080
    v_mfma_f32_16x16x32_bf16 v[144:147], a[216:219], a[192:195], v[144:147]
    ds_read_b128 a[48:51], v24 offset:40960
    s_add_u32 m0, s49, 98304
    v_mfma_f32_16x16x32_bf16 v[144:147], a[248:251], a[224:227], v[144:147]
    buffer_load_dwordx4 v1, s[4:7], s46 offen offset:0 sc1 lds
    v_mfma_f32_16x16x32_bf16 v[148:151], a[216:219], a[196:199], v[148:151]
    ds_read_b128 a[52:55], v24 offset:41984
    v_mfma_f32_16x16x32_bf16 v[148:151], a[248:251], a[228:231], v[148:151]
    ds_read_b128 a[56:59], v24 offset:43008
    v_mfma_f32_16x16x32_bf16 v[152:155], a[216:219], a[200:203], v[152:155]
    ds_read_b128 a[60:63], v24 offset:44032
    v_mfma_f32_16x16x32_bf16 v[152:155], a[248:251], a[232:235], v[152:155]
    buffer_load_dwordx4 v1, s[4:7], s46 offen offset:1024 sc1 lds
    s_add_u32 s46, s46, 8192
    v_mfma_f32_16x16x32_bf16 v[156:159], a[216:219], a[204:207], v[156:159]
    v_mfma_f32_16x16x32_bf16 v[156:159], a[248:251], a[236:239], v[156:159]
    v_mfma_f32_16x16x32_bf16 v[172:175], a[220:223], a[204:207], v[172:175]
    s_add_u32 m0, s50, 114688
    v_mfma_f32_16x16x32_bf16 v[172:175], a[252:255], a[236:239], v[172:175]
    buffer_load_dwordx4 v1, s[4:7], s48 offen offset:0 lds
    v_mfma_f32_16x16x32_bf16 v[168:171], a[220:223], a[200:203], v[168:171]
    v_mfma_f32_16x16x32_bf16 v[168:171], a[252:255], a[232:235], v[168:171]
    v_mfma_f32_16x16x32_bf16 v[164:167], a[220:223], a[196:199], v[164:167]
    v_mfma_f32_16x16x32_bf16 v[164:167], a[252:255], a[228:231], v[164:167]
    buffer_load_dwordx4 v1, s[4:7], s48 offen offset:1024 lds
    v_mfma_f32_16x16x32_bf16 v[160:163], a[220:223], a[192:195], v[160:163]
    v_mfma_f32_16x16x32_bf16 v[160:163], a[252:255], a[224:227], v[160:163]
    s_waitcnt vmcnt(10) lgkmcnt(0)
    s_barrier
    v_mfma_f32_16x16x32_bf16 v[40:43], a[16:19], a[8:11], v[40:43]
    ds_read_b128 a[192:195], v20 offset:0
    buffer_load_dwordx4 v1, s[4:7], s48 offen offset:2048 lds
    v_mfma_f32_16x16x32_bf16 v[40:43], a[48:51], a[40:43], v[40:43]
    ds_read_b128 a[196:199], v20 offset:1024
    v_mfma_f32_16x16x32_bf16 v[44:47], a[16:19], a[12:15], v[44:47]
    buffer_load_dwordx4 v1, s[4:7], s48 offen offset:3072 lds
    s_add_u32 s48, s48, 16384
    v_mfma_f32_16x16x32_bf16 v[44:47], a[48:51], a[44:47], v[44:47]
    ds_read_b128 a[208:211], v24 offset:0
    s_add_u32 m0, s49, 65536
    v_mfma_f32_16x16x32_bf16 v[60:63], a[20:23], a[12:15], v[60:63]
    buffer_load_dwordx4 v1, s[4:7], s46 offen offset:0 sc1 lds
    v_mfma_f32_16x16x32_bf16 v[60:63], a[52:55], a[44:47], v[60:63]
    ds_read_b128 a[212:215], v24 offset:1024
    v_mfma_f32_16x16x32_bf16 v[56:59], a[20:23], a[8:11], v[56:59]
    ds_read_b128 a[216:219], v24 offset:2048
    buffer_load_dwordx4 v1, s[4:7], s46 offen offset:1024 sc1 lds
    s_add_u32 s46, s46, 8192
    v_mfma_f32_16x16x32_bf16 v[56:59], a[52:55], a[40:43], v[56:59]
    v_mfma_f32_16x16x32_bf16 v[152:155], a[24:27], a[8:11], v[152:155]
    ds_read_b128 a[220:223], v24 offset:3072
    s_add_u32 m0, s50, 81920
    v_mfma_f32_16x16x32_bf16 v[152:155], a[56:59], a[40:43], v[152:155]
    buffer_load_dwordx4 v1, s[4:7], s48 offen offset:0 lds
    v_mfma_f32_16x16x32_bf16 v[156:159], a[24:27], a[12:15], v[156:159]
    ds_read_b128 a[224:227], v20 offset:4096
    v_mfma_f32_16x16x32_bf16 v[156:159], a[56:59], a[44:47], v[156:159]
    ds_read_b128 a[228:231], v20 offset:5120
    buffer_load_dwordx4 v1, s[4:7], s48 offen offset:1024 lds
    v_mfma_f32_16x16x32_bf16 v[172:175], a[28:31], a[12:15], v[172:175]
    v_mfma_f32_16x16x32_bf16 v[172:175], a[60:63], a[44:47], v[172:175]
    ds_read_b128 a[240:243], v24 offset:8192
    buffer_load_dwordx4 v1, s[4:7], s48 offen offset:2048 lds
    v_mfma_f32_16x16x32_bf16 v[168:171], a[28:31], a[8:11], v[168:171]
    v_mfma_f32_16x16x32_bf16 v[168:171], a[60:63], a[40:43], v[168:171]
    ds_read_b128 a[244:247], v24 offset:9216
    buffer_load_dwordx4 v1, s[4:7], s48 offen offset:3072 lds
    s_add_u32 s48, s48, 16384
    v_mfma_f32_16x16x32_bf16 v[32:35], a[16:19], a[0:3], v[32:35]
    ds_read_b128 a[248:251], v24 offset:10240
    v_cvt_pk_bf16_f32 v176, v40, v41
    v_cvt_pk_bf16_f32 v177, v42, v43
    v_mfma_f32_16x16x32_bf16 v[32:35], a[48:51], a[32:35], v[32:35]
    v_cvt_pk_bf16_f32 v178, v56, v57
    v_cvt_pk_bf16_f32 v179, v58, v59
    v_mfma_f32_16x16x32_bf16 v[36:39], a[16:19], a[4:7], v[36:39]
    ds_read_b128 a[252:255], v24 offset:11264
    v_min_u32 v176, -2, v176
    v_min_u32 v177, -2, v177
    v_mfma_f32_16x16x32_bf16 v[36:39], a[48:51], a[36:39], v[36:39]
    v_min_u32 v178, -2, v178
    v_min_u32 v179, -2, v179
    buffer_store_dwordx4 v[176:179], v1, s[4:7], s52 offen offset:0 sc1
    v_mfma_f32_16x16x32_bf16 v[52:55], a[20:23], a[4:7], v[52:55]
    v_cvt_pk_bf16_f32 v184, v44, v45
    v_cvt_pk_bf16_f32 v185, v46, v47
    v_mfma_f32_16x16x32_bf16 v[52:55], a[52:55], a[36:39], v[52:55]
    v_cvt_pk_bf16_f32 v186, v60, v61
    v_cvt_pk_bf16_f32 v187, v62, v63
    v_mfma_f32_16x16x32_bf16 v[48:51], a[20:23], a[0:3], v[48:51]
    v_min_u32 v184, -2, v184
    v_min_u32 v185, -2, v185
    v_mfma_f32_16x16x32_bf16 v[48:51], a[52:55], a[32:35], v[48:51]
    v_min_u32 v186, -2, v186
    v_min_u32 v187, -2, v187
    buffer_store_dwordx4 v[184:187], v1, s[4:7], s52 offen offset:1024 sc1
    v_mfma_f32_16x16x32_bf16 v[144:147], a[24:27], a[0:3], v[144:147]
    v_cvt_pk_bf16_f32 v180, v152, v153
    v_cvt_pk_bf16_f32 v181, v154, v155
    v_mfma_f32_16x16x32_bf16 v[144:147], a[56:59], a[32:35], v[144:147]
    v_cvt_pk_bf16_f32 v182, v168, v169
    v_cvt_pk_bf16_f32 v183, v170, v171
    v_mfma_f32_16x16x32_bf16 v[148:151], a[24:27], a[4:7], v[148:151]
    v_min_u32 v180, -2, v180
    v_min_u32 v181, -2, v181
    v_mfma_f32_16x16x32_bf16 v[148:151], a[56:59], a[36:39], v[148:151]
    v_min_u32 v182, -2, v182
    v_min_u32 v183, -2, v183
    buffer_store_dwordx4 v[180:183], v1, s[4:7], s53 offen offset:0 sc1
    v_mfma_f32_16x16x32_bf16 v[164:167], a[28:31], a[4:7], v[164:167]
    v_cvt_pk_bf16_f32 v188, v156, v157
    v_cvt_pk_bf16_f32 v189, v158, v159
    v_mfma_f32_16x16x32_bf16 v[164:167], a[60:63], a[36:39], v[164:167]
    v_cvt_pk_bf16_f32 v190, v172, v173
    v_cvt_pk_bf16_f32 v191, v174, v175
    v_mfma_f32_16x16x32_bf16 v[160:163], a[28:31], a[0:3], v[160:163]
    v_min_u32 v188, -2, v188
    v_min_u32 v189, -2, v189
    v_mfma_f32_16x16x32_bf16 v[160:163], a[60:63], a[32:35], v[160:163]
    v_min_u32 v190, -2, v190
    v_min_u32 v191, -2, v191
    buffer_store_dwordx4 v[188:191], v1, s[4:7], s53 offen offset:1024 sc1
    s_waitcnt vmcnt(16) lgkmcnt(0)
    s_barrier
    v_mfma_f32_16x16x32_bf16 v[32:35], a[208:211], a[192:195], v[32:35]
    ds_read_b128 a[0:3], v22 offset:0
    ds_read_b128 a[4:7], v22 offset:1024
    s_add_u32 s52, s51, 0
    s_add_u32 s53, s51, 4096
    v_mfma_f32_16x16x32_bf16 v[32:35], a[240:243], a[224:227], v[32:35]
    ds_read_b128 a[16:19], v26 offset:0
    v_mfma_f32_16x16x32_bf16 v[36:39], a[208:211], a[196:199], v[36:39]
    ds_read_b128 a[20:23], v26 offset:1024
    v_mfma_f32_16x16x32_bf16 v[36:39], a[240:243], a[228:231], v[36:39]
    ds_read_b128 a[24:27], v26 offset:2048
    v_mfma_f32_16x16x32_bf16 v[52:55], a[212:215], a[196:199], v[52:55]
    ds_read_b128 a[28:31], v26 offset:3072
    v_mfma_f32_16x16x32_bf16 v[52:55], a[244:247], a[228:231], v[52:55]
    ds_read_b128 a[32:35], v22 offset:4096
    ds_read_b128 a[36:39], v22 offset:5120
    v_mfma_f32_16x16x32_bf16 v[48:51], a[212:215], a[192:195], v[48:51]
    ds_read_b128 a[48:51], v26 offset:8192
    v_mfma_f32_16x16x32_bf16 v[48:51], a[244:247], a[224:227], v[48:51]
    ds_read_b128 a[52:55], v26 offset:9216
    v_mfma_f32_16x16x32_bf16 v[144:147], a[216:219], a[192:195], v[144:147]
    ds_read_b128 a[56:59], v26 offset:10240
    v_mfma_f32_16x16x32_bf16 v[144:147], a[248:251], a[224:227], v[144:147]
    ds_read_b128 a[60:63], v26 offset:11264
    v_mfma_f32_16x16x32_bf16 v[148:151], a[216:219], a[196:199], v[148:151]
    v_mfma_f32_16x16x32_bf16 v[148:151], a[248:251], a[228:231], v[148:151]
    v_mfma_f32_16x16x32_bf16 v[164:167], a[220:223], a[196:199], v[164:167]
    v_mfma_f32_16x16x32_bf16 v[164:167], a[252:255], a[228:231], v[164:167]
    v_mfma_f32_16x16x32_bf16 v[160:163], a[220:223], a[192:195], v[160:163]
    v_mfma_f32_16x16x32_bf16 v[160:163], a[252:255], a[224:227], v[160:163]
    s_waitcnt vmcnt(10) lgkmcnt(0)
    s_barrier
    v_mfma_f32_16x16x32_bf16 v[32:35], a[16:19], a[0:3], v[32:35]
    ds_read_b128 a[192:195], v21 offset:32768
    ds_read_b128 a[196:199], v21 offset:33792
    v_mfma_f32_16x16x32_bf16 v[32:35], a[48:51], a[32:35], v[32:35]
    ds_read_b128 a[208:211], v25 offset:32768
    v_mfma_f32_16x16x32_bf16 v[36:39], a[16:19], a[4:7], v[36:39]
    ds_read_b128 a[212:215], v25 offset:33792
    v_mfma_f32_16x16x32_bf16 v[36:39], a[48:51], a[36:39], v[36:39]
    ds_read_b128 a[216:219], v25 offset:34816
    v_mfma_f32_16x16x32_bf16 v[52:55], a[20:23], a[4:7], v[52:55]
    ds_read_b128 a[220:223], v25 offset:35840
    v_mfma_f32_16x16x32_bf16 v[52:55], a[52:55], a[36:39], v[52:55]
    ds_read_b128 a[224:227], v21 offset:36864
    ds_read_b128 a[228:231], v21 offset:37888
    v_mfma_f32_16x16x32_bf16 v[48:51], a[20:23], a[0:3], v[48:51]
    ds_read_b128 a[240:243], v25 offset:40960
    v_mfma_f32_16x16x32_bf16 v[48:51], a[52:55], a[32:35], v[48:51]
    ds_read_b128 a[244:247], v25 offset:41984
    v_mfma_f32_16x16x32_bf16 v[144:147], a[24:27], a[0:3], v[144:147]
    ds_read_b128 a[248:251], v25 offset:43008
    v_mfma_f32_16x16x32_bf16 v[144:147], a[56:59], a[32:35], v[144:147]
    ds_read_b128 a[252:255], v25 offset:44032
    v_mfma_f32_16x16x32_bf16 v[148:151], a[24:27], a[4:7], v[148:151]
    v_mfma_f32_16x16x32_bf16 v[148:151], a[56:59], a[36:39], v[148:151]
    v_mfma_f32_16x16x32_bf16 v[164:167], a[28:31], a[4:7], v[164:167]
    v_mfma_f32_16x16x32_bf16 v[164:167], a[60:63], a[36:39], v[164:167]
    v_mfma_f32_16x16x32_bf16 v[160:163], a[28:31], a[0:3], v[160:163]
    v_mfma_f32_16x16x32_bf16 v[160:163], a[60:63], a[32:35], v[160:163]
    s_waitcnt vmcnt(4) lgkmcnt(0)
    s_barrier
    v_mfma_f32_16x16x32_bf16 v[32:35], a[208:211], a[192:195], v[32:35]
    ds_read_b128 a[0:3], v21 offset:0
    ds_read_b128 a[4:7], v21 offset:1024
    buffer_load_dwordx4 v[40:43], v1, s[4:7], s52 offen offset:0 sc1
    v_mfma_f32_16x16x32_bf16 v[32:35], a[240:243], a[224:227], v[32:35]
    ds_read_b128 a[16:19], v25 offset:0
    v_mfma_f32_16x16x32_bf16 v[36:39], a[208:211], a[196:199], v[36:39]
    ds_read_b128 a[20:23], v25 offset:1024
    v_mfma_f32_16x16x32_bf16 v[36:39], a[240:243], a[228:231], v[36:39]
    ds_read_b128 a[24:27], v25 offset:2048
    v_mfma_f32_16x16x32_bf16 v[52:55], a[212:215], a[196:199], v[52:55]
    ds_read_b128 a[28:31], v25 offset:3072
    buffer_load_dwordx4 v[152:155], v1, s[4:7], s53 offen offset:0 sc1
    v_mfma_f32_16x16x32_bf16 v[52:55], a[244:247], a[228:231], v[52:55]
    ds_read_b128 a[32:35], v21 offset:4096
    ds_read_b128 a[36:39], v21 offset:5120
    v_mfma_f32_16x16x32_bf16 v[48:51], a[212:215], a[192:195], v[48:51]
    ds_read_b128 a[48:51], v25 offset:8192
    v_mfma_f32_16x16x32_bf16 v[48:51], a[244:247], a[224:227], v[48:51]
    ds_read_b128 a[52:55], v25 offset:9216
    v_mfma_f32_16x16x32_bf16 v[144:147], a[216:219], a[192:195], v[144:147]
    ds_read_b128 a[56:59], v25 offset:10240
    buffer_load_dwordx4 v[44:47], v1, s[4:7], s52 offen offset:1024 sc1
    v_mfma_f32_16x16x32_bf16 v[144:147], a[248:251], a[224:227], v[144:147]
    ds_read_b128 a[60:63], v25 offset:11264
    v_mfma_f32_16x16x32_bf16 v[148:151], a[216:219], a[196:199], v[148:151]
    v_mfma_f32_16x16x32_bf16 v[148:151], a[248:251], a[228:231], v[148:151]
    v_mfma_f32_16x16x32_bf16 v[164:167], a[220:223], a[196:199], v[164:167]
    buffer_load_dwordx4 v[156:159], v1, s[4:7], s53 offen offset:1024 sc1
    v_mfma_f32_16x16x32_bf16 v[164:167], a[252:255], a[228:231], v[164:167]
    v_mfma_f32_16x16x32_bf16 v[160:163], a[220:223], a[192:195], v[160:163]
    v_mfma_f32_16x16x32_bf16 v[160:163], a[252:255], a[224:227], v[160:163]
    s_waitcnt lgkmcnt(0)
    v_mfma_f32_16x16x32_bf16 v[32:35], a[16:19], a[0:3], v[32:35]
    v_mfma_f32_16x16x32_bf16 v[32:35], a[48:51], a[32:35], v[32:35]
    v_mfma_f32_16x16x32_bf16 v[36:39], a[16:19], a[4:7], v[36:39]
    v_mfma_f32_16x16x32_bf16 v[36:39], a[48:51], a[36:39], v[36:39]
    v_mfma_f32_16x16x32_bf16 v[52:55], a[20:23], a[4:7], v[52:55]
    v_mfma_f32_16x16x32_bf16 v[52:55], a[52:55], a[36:39], v[52:55]
    v_mfma_f32_16x16x32_bf16 v[48:51], a[20:23], a[0:3], v[48:51]
    v_mfma_f32_16x16x32_bf16 v[48:51], a[52:55], a[32:35], v[48:51]
    v_mfma_f32_16x16x32_bf16 v[144:147], a[24:27], a[0:3], v[144:147]
    v_mfma_f32_16x16x32_bf16 v[144:147], a[56:59], a[32:35], v[144:147]
    v_mfma_f32_16x16x32_bf16 v[148:151], a[24:27], a[4:7], v[148:151]
    v_mfma_f32_16x16x32_bf16 v[148:151], a[56:59], a[36:39], v[148:151]
    v_mfma_f32_16x16x32_bf16 v[164:167], a[28:31], a[4:7], v[164:167]
    v_mfma_f32_16x16x32_bf16 v[164:167], a[60:63], a[36:39], v[164:167]
    v_mfma_f32_16x16x32_bf16 v[160:163], a[28:31], a[0:3], v[160:163]
    v_mfma_f32_16x16x32_bf16 v[160:163], a[60:63], a[32:35], v[160:163]
    s_nop 0
    s_mov_b32 s31, 1048576
L_ffn_chk:
    s_waitcnt vmcnt(0)
    v_max3_u32 v29, v40, v41, v42
    v_max3_u32 v30, v43, v152, v153
    v_max3_u32 v30, v154, v155, v30
    v_max3_u32 v29, v44, v45, v29
    v_max3_u32 v30, v46, v47, v30
    v_max3_u32 v29, v156, v157, v29
    v_max3_u32 v30, v158, v159, v30
    v_max_u32 v29, v29, v30
    v_cmp_eq_u32 vcc, -1, v29
    s_sub_u32 s31, s31, 1
    s_cbranch_scc1 L_ffn_out
    s_cbranch_vccz L_ffn_out
L_ffn_wait:
    buffer_load_dword v29, off, s[4:7], s53 offset:2044 sc1
    s_waitcnt vmcnt(0)
    v_cmp_eq_u32 vcc, -1, v29
    s_sub_u32 s31, s31, 1
    s_cbranch_scc1 L_ffn_out
    s_cbranch_vccnz L_ffn_wait
    buffer_load_dwordx4 v[40:43], v1, s[4:7], s52 offen offset:0 sc1
    buffer_load_dwordx4 v[152:155], v1, s[4:7], s53 offen offset:0 sc1
    buffer_load_dwordx4 v[44:47], v1, s[4:7], s52 offen offset:1024 sc1
    buffer_load_dwordx4 v[156:159], v1, s[4:7], s53 offen offset:1024 sc1
    s_branch L_ffn_chk
L_ffn_out:
    s_mov_b32 s31, 32768
    v_lshlrev_b32 v80, 16, v40
    v_and_b32 v81, 0xffff0000, v40
    v_lshlrev_b32 v82, 16, v41
    v_and_b32 v83, 0xffff0000, v41
    v_pk_add_f32 v[32:33], v[32:33], v[80:81]
    v_pk_add_f32 v[34:35], v[34:35], v[82:83]
    v_cvt_pk_bf16_f32 v192, v32, v33
    v_cvt_pk_bf16_f32 v193, v34, v35
    v_lshlrev_b32 v80, 16, v42
    v_and_b32 v81, 0xffff0000, v42
    v_lshlrev_b32 v82, 16, v43
    v_and_b32 v83, 0xffff0000, v43
    v_pk_add_f32 v[48:49], v[48:49], v[80:81]
    v_pk_add_f32 v[50:51], v[50:51], v[82:83]
    v_cvt_pk_bf16_f32 v194, v48, v49
    v_cvt_pk_bf16_f32 v195, v50, v51
    buffer_store_dwordx4 v[192:195], v23, s[20:23], 0 offen offset:0 sc1
    v_lshlrev_b32 v80, 16, v152
    v_and_b32 v81, 0xffff0000, v152
    v_lshlrev_b32 v82, 16, v153
    v_and_b32 v83, 0xffff0000, v153
    v_pk_add_f32 v[144:145], v[144:145], v[80:81]
    v_pk_add_f32 v[146:147], v[146:147], v[82:83]
    v_cvt_pk_bf16_f32 v196, v144, v145
    v_cvt_pk_bf16_f32 v197, v146, v147
    v_lshlrev_b32 v80, 16, v154
    v_and_b32 v81, 0xffff0000, v154
    v_lshlrev_b32 v82, 16, v155
    v_and_b32 v83, 0xffff0000, v155
    v_pk_add_f32 v[160:161], v[160:161], v[80:81]
    v_pk_add_f32 v[162:163], v[162:163], v[82:83]
    v_cvt_pk_bf16_f32 v198, v160, v161
    v_cvt_pk_bf16_f32 v199, v162, v163
    buffer_store_dwordx4 v[196:199], v23, s[20:23], 0 offen offset:64 sc1
    v_lshlrev_b32 v80, 16, v44
    v_and_b32 v81, 0xffff0000, v44
    v_lshlrev_b32 v82, 16, v45
    v_and_b32 v83, 0xffff0000, v45
    v_pk_add_f32 v[36:37], v[36:37], v[80:81]
    v_pk_add_f32 v[38:39], v[38:39], v[82:83]
    v_cvt_pk_bf16_f32 v200, v36, v37
    v_cvt_pk_bf16_f32 v201, v38, v39
    v_lshlrev_b32 v80, 16, v46
    v_and_b32 v81, 0xffff0000, v46
    v_lshlrev_b32 v82, 16, v47
    v_and_b32 v83, 0xffff0000, v47
    v_pk_add_f32 v[52:53], v[52:53], v[80:81]
    v_pk_add_f32 v[54:55], v[54:55], v[82:83]
    v_cvt_pk_bf16_f32 v202, v52, v53
    v_cvt_pk_bf16_f32 v203, v54, v55
    buffer_store_dwordx4 v[200:203], v23, s[20:23], s31 offen offset:0 sc1
    v_lshlrev_b32 v80, 16, v156
    v_and_b32 v81, 0xffff0000, v156
    v_lshlrev_b32 v82, 16, v157
    v_and_b32 v83, 0xffff0000, v157
    v_pk_add_f32 v[148:149], v[148:149], v[80:81]
    v_pk_add_f32 v[150:151], v[150:151], v[82:83]
    v_cvt_pk_bf16_f32 v204, v148, v149
    v_cvt_pk_bf16_f32 v205, v150, v151
    v_lshlrev_b32 v80, 16, v158
    v_and_b32 v81, 0xffff0000, v158
    v_lshlrev_b32 v82, 16, v159
    v_and_b32 v83, 0xffff0000, v159
    v_pk_add_f32 v[164:165], v[164:165], v[80:81]
    v_pk_add_f32 v[166:167], v[166:167], v[82:83]
    v_cvt_pk_bf16_f32 v206, v164, v165
    v_cvt_pk_bf16_f32 v207, v166, v167
    buffer_store_dwordx4 v[204:207], v23, s[20:23], s31 offen offset:64 sc1
L_end_ffn_kernel:
    s_endpgm
L_ffn_spin0:
    s_mov_b32 s31, 1048576
L_ffn_spin0b:
    s_mov_b64 exec, 1
    v_mov_b32 v27, 0
    buffer_atomic_add v27, off, s[4:7], s57 offset:0 sc0 sc1
    s_waitcnt vmcnt(0)
    v_cmp_gt_u32 vcc, 16, v27
    s_mov_b64 exec, -1
    s_sub_u32 s31, s31, 1
    s_cbranch_scc1 L_ffn_go0
    s_cbranch_vccnz L_ffn_spin0b
    s_branch L_ffn_go0
L_ffn_spin1:
    s_mov_b32 s31, 1048576
L_ffn_spin1b:
    s_mov_b64 exec, 1
    v_mov_b32 v27, 0
    buffer_atomic_add v27, off, s[4:7], s57 offset:256 sc0 sc1
    s_waitcnt vmcnt(0)
    v_cmp_gt_u32 vcc, 16, v27
    s_mov_b64 exec, -1
    s_sub_u32 s31, s31, 1
    s_cbranch_scc1 L_ffn_go1
    s_cbranch_vccnz L_ffn_spin1b
    s_branch L_ffn_go1
L_ffn_spin2:
    s_mov_b32 s31, 1048576
L_ffn_spin2b:
    s_mov_b64 exec, 1
    v_mov_b32 v27, 0
    buffer_atomic_add v27, off, s[4:7], s57 offset:512 sc0 sc1
    s_waitcnt vmcnt(0)
    v_cmp_gt_u32 vcc, 16, v27
    s_mov_b64 exec, -1
    s_sub_u32 s31, s31, 1
    s_cbranch_scc1 L_ffn_go2
    s_cbranch_vccnz L_ffn_spin2b
    s_branch L_ffn_go2
L_ffn_spin3:
    s_mov_b32 s31, 1048576
L_ffn_spin3b:
    s_mov_b64 exec, 1
    v_mov_b32 v27, 0
    buffer_atomic_add v27, off, s[4:7], s55 offset:768 sc0 sc1
    s_waitcnt vmcnt(0)
    v_cmp_gt_u32 vcc, 32, v27
    s_mov_b64 exec, -1
    s_sub_u32 s31, s31, 1
    s_cbranch_scc1 L_ffn_go3
    s_cbranch_vccnz L_ffn_spin3b
    s_branch L_ffn_go3
L_code_end:
.section .rodata,"a"
.p2align 6
.amdhsa_kernel attn_kernel
  .amdhsa_next_free_vgpr 256
  .amdhsa_next_free_sgpr 102
  .amdhsa_accum_offset 256
  .amdhsa_group_segment_fixed_size 0
  .amdhsa_kernarg_size 96
  .amdhsa_user_sgpr_count 2
  .amdhsa_user_sgpr_kernarg_segment_ptr 1
  .amdhsa_system_sgpr_workgroup_id_x 1
.end_amdhsa_kernel
.p2align 6
.amdhsa_kernel ffn_kernel
  .amdhsa_next_free_vgpr 512
  .amdhsa_next_free_sgpr 102
  .amdhsa_accum_offset 256
  .amdhsa_group_segment_fixed_size 0
  .amdhsa_kernarg_size 96
  .amdhsa_user_sgpr_count 2
  .amdhsa_user_sgpr_kernarg_segment_ptr 1
  .amdhsa_system_sgpr_workgroup_id_x 1
.end_amdhsa_kernel
```
